```python
import torch

def _softmax(x, axis=-1):
    return torch.softmax(x, dim=axis)
def _gelu(x):
    return torch.nn.functional.gelu(x, approximate="tanh")
def _silu(x):
    return torch.nn.functional.silu(x)
def _sigmoid(x):
    return torch.sigmoid(x)
def _layernorm(x, axis=-1, eps=1e-5):
    m = x.mean(dim=axis, keepdim=True)
    v = x.var(dim=axis, keepdim=True, unbiased=False)
    return (x - m) / torch.sqrt(v + eps)
def _scatter_add(tgt, idx, src, axis=0):
    return tgt.clone().index_add_(axis, idx, src)
def _segment_sum(src, seg, n):
    out = torch.zeros((n,) + src.shape[1:], dtype=src.dtype)
    return out.index_add_(0, seg, src)
def _pad(x, pw):
    flat = tuple(v for pair in reversed(pw) for v in pair)
    return torch.nn.functional.pad(x, flat)

kernel_name = 'interleave_layers__linear_attn_block__glu_gated_geglu__prompt'

def setup_inputs():

    _w = (lambda a: (lambda t: t.to(torch.bfloat16) if t.is_floating_point() else t)(torch.as_tensor(a)))
    def _A_setup():
        B, S, D = 1, 2048, 512
        return {
            "x": _w((lambda *s: torch.randn(*s, dtype=torch.bfloat16) * 0.05)(B, S, D)),
            "wqkv": _w((lambda *s: torch.randn(*s, dtype=torch.bfloat16) * 0.05)(D, 3 * D)),
            "wo": _w((lambda *s: torch.randn(*s, dtype=torch.bfloat16) * 0.05)(D, D)),
        }
    _A_in = _A_setup()

    def _B_setup():
        B, S, Dm, Df = 1, 2048, 512, 1792
        return {
            "x": _w((lambda *s: torch.randn(*s, dtype=torch.bfloat16) * 0.05)(B, S, Dm)),
            "w_gate": _w((lambda *s: torch.randn(*s, dtype=torch.bfloat16) * 0.8)(Dm, Df) * (Dm ** -0.5)),
            "w_up": _w((lambda *s: torch.randn(*s, dtype=torch.bfloat16) * 0.8)(Dm, Df) * (Dm ** -0.5)),
            "w_down": _w((lambda *s: torch.randn(*s, dtype=torch.bfloat16) * 0.8)(Df, Dm) * (Df ** -0.5)),
        }
    _B_in = _B_setup()

    return {
        "A_x": _A_in["x"],
        "A_wqkv": _A_in["wqkv"],
        "A_wo": _A_in["wo"],
        "B_x": _B_in["x"],
        "B_w_gate": _B_in["w_gate"],
        "B_w_up": _B_in["w_up"],
        "B_w_down": _B_in["w_down"],
    }

def reference(A_x, A_wqkv, A_wo, B_x, B_w_gate, B_w_up, B_w_down):
    def _A_ref(x, wqkv, wo):
        B, S, D = x.shape
        H = 32; Dh = D // H
        qkv = (lambda x, *d: x.permute(*d))((x @ wqkv).reshape(B, S, 3, H, Dh), 2, 0, 3, 1, 4)
        q, k, v = qkv[0], qkv[1], qkv[2]
        phi = lambda t: torch.where(t > 0, t + 1, torch.exp(t)) + 1e-6
        pq, pk = phi(q), phi(k)
        kv = torch.einsum("bhsd,bhse->bhde", pk, v)
        z = torch.einsum("bhsd->bhd", pk)
        num = torch.einsum("bhqd,bhde->bhqe", pq, kv)
        den = torch.einsum("bhqd,bhd->bhq", pq, z)[..., None] + 1e-6
        o = num / den
        return (lambda x, *d: x.permute(*d))(o, 0, 2, 1, 3).reshape(B, S, D) @ wo

    def _B_ref(x, w_gate, w_up, w_down):
        g = torch.einsum("bsd,df->bsf", x, w_gate)
        u = torch.einsum("bsd,df->bsf", x, w_up)
        h = _gelu(g) * u
        return torch.einsum("bsf,fd->bsd", h, w_down)

    x = A_x
    x = x + _A_ref(_layernorm(x, axis=-1), A_wqkv, A_wo)
    x = x + _B_ref(_layernorm(x, axis=-1), B_w_gate, B_w_up, B_w_down)
    x = x + _A_ref(_layernorm(x, axis=-1), A_wqkv, A_wo)
    x = x + _B_ref(_layernorm(x, axis=-1), B_w_gate, B_w_up, B_w_down)
    return x
```

```asm
; @launch kernel=mega_kernel grid=(256,1,1) block=(256,1,1) lds=163840
.amdgcn_target "amdgcn-amd-amdhsa--gfx950"
.text
.globl mega_kernel
.p2align 8
.type mega_kernel,@function
mega_kernel:
    s_cmp_ge_u32 s2, 256
    s_cbranch_scc1 mega_done
    s_load_dwordx16 s[16:31], s[0:1], 0
    s_load_dwordx4 s[32:35], s[0:1], 64
    v_lshrrev_b32 v3, 6, v0
    v_and_b32 v0, 63, v0
    v_readfirstlane_b32 s3, v3
    v_lshlrev_b32 v1, 4, v0
    v_and_b32 v2, 31, v0
    v_lshrrev_b32 v3, 5, v0
    v_add_u32 v5, 0x10000, v1
    s_lshl_b32 s50, s3, 12
    s_mov_b32 s52, -1
    s_mov_b32 s53, 0
    s_and_b32 s4, s2, 7
    s_lshr_b32 s5, s2, 3
    s_lshr_b32 s44, s4, 1
    s_lshl_b32 s44, s44, 2
    s_lshr_b32 s6, s5, 3
    s_add_u32 s44, s44, s6
    s_and_b32 s45, s4, 1
    s_lshl_b32 s45, s45, 3
    s_and_b32 s6, s5, 7
    s_add_u32 s45, s45, s6
    s_getpc_b64 s[12:13]
kf_pc:
    s_sub_u32 s12, s12, kf_pc-mega_kernel
    s_subb_u32 s13, s13, 0
    s_mov_b32 s14, mega_end-mega_kernel
    s_mov_b32 s15, 0x20000
    s_lshr_b32 s4, s2, 3
    s_lshl_b32 s4, s4, 12
    s_lshl_b32 s5, s3, 10
    s_add_u32 s4, s4, s5
    buffer_load_dwordx4 v[240:243], v1, s[12:15], s4 offen
    s_lshl_b32 s8, s44, 2
    s_add_u32 s8, s8, s3
    s_lshl_b32 s46, s8, 15
    s_lshl_b32 s47, s44, 1
    s_add_u32 s47, s47, s45
    s_and_b32 s47, s47, 7
    s_mul_i32 s48, s3, 12288
    s_add_u32 s48, s48, 98304
    v_lshrrev_b32 v8, 3, v0
    v_and_b32 v9, 7, v0
    v_lshrrev_b32 v10, 4, v0
    v_add_u32 v11, 0, v10
    v_and_b32 v11, 7, v11
    v_xor_b32 v11, v11, v9
    v_lshlrev_b32 v11, 4, v11
    v_lshl_add_u32 v224, v8, 10, v11
    v_add_u32 v224, 0, v224
    v_add_u32 v11, 4, v10
    v_and_b32 v11, 7, v11
    v_xor_b32 v11, v11, v9
    v_lshlrev_b32 v11, 4, v11
    v_lshl_add_u32 v225, v8, 10, v11
    v_add_u32 v225, 7168, v225
    v_add_u32 v11, 8, v10
    v_and_b32 v11, 7, v11
    v_xor_b32 v11, v11, v9
    v_lshlrev_b32 v11, 4, v11
    v_lshl_add_u32 v226, v8, 10, v11
    v_add_u32 v226, 14336, v226
    v_add_u32 v11, 12, v10
    v_and_b32 v11, 7, v11
    v_xor_b32 v11, v11, v9
    v_lshlrev_b32 v11, 4, v11
    v_lshl_add_u32 v227, v8, 10, v11
    v_add_u32 v227, 21504, v227
    v_lshrrev_b32 v8, 2, v0
    v_mul_u32_u24 v8, 3072, v8
    v_and_b32 v9, 3, v0
    v_lshl_add_u32 v232, v9, 4, v8
    s_lshl_b32 s49, s45, 6
    s_waitcnt lgkmcnt(0)
    s_mov_b32 s36, s34
    s_mov_b32 s37, s35
    s_mov_b32 s38, 41943040
    s_mov_b32 s39, 0x20000
    s_mov_b32 s40, s16
    s_mov_b32 s41, s17
    s_mov_b32 s42, 2097152
    s_mov_b32 s43, 0x20000
    s_mov_b32 s56, s18
    s_mov_b32 s57, s19
    s_mov_b32 s58, 1572864
    s_mov_b32 s59, 0x20000
    s_add_u32 s4, s47, 0
    s_and_b32 s4, s4, 7
    s_lshl_b32 s4, s4, 7
    s_add_u32 s4, s4, s46
    s_add_u32 m0, s48, 0
    s_nop 0
    buffer_load_dwordx4 v224, s[40:43], s4 offen offset:0 lds
    buffer_load_dwordx4 v225, s[40:43], s4 offen offset:1024 lds
    buffer_load_dwordx4 v226, s[40:43], s4 offen offset:2048 lds
    buffer_load_dwordx4 v227, s[40:43], s4 offen offset:3072 lds
    s_lshr_b32 s51, s3, 1
    s_add_u32 s51, s51, s47
    s_add_u32 s51, s51, 0
    s_and_b32 s51, s51, 7
    s_lshl_b32 s51, s51, 2
    s_and_b32 s4, s3, 1
    s_lshl_b32 s4, s4, 1
    s_add_u32 s51, s51, s4
    s_mul_i32 s51, s51, 49152
    s_add_u32 s51, s51, s49
    s_add_u32 s51, s51, 1024
    s_add_u32 m0, s50, 0
    s_nop 0
    buffer_load_dwordx4 v232, s[56:59], s51 offen lds
    s_add_u32 s51, s51, 1024
    s_add_u32 m0, s50, 1024
    s_nop 0
    buffer_load_dwordx4 v232, s[56:59], s51 offen lds
    s_add_u32 s51, s51, 48128
    s_add_u32 m0, s50, 2048
    s_nop 0
    buffer_load_dwordx4 v232, s[56:59], s51 offen lds
    s_add_u32 s51, s51, 1024
    s_add_u32 m0, s50, 3072
    s_nop 0
    buffer_load_dwordx4 v232, s[56:59], s51 offen lds
    s_mov_b32 s64, s32
    s_mov_b32 s65, s33
    s_mov_b32 s66, 256
    s_mov_b32 s67, 0x20000
    s_lshl_b32 s4, s2, 1
    s_lshr_b32 s5, s3, 1
    s_add_u32 s4, s4, s5
    s_and_b32 s5, s3, 1
    s_lshl_b32 s6, s5, 1
    s_mov_b32 s63, 0x20000
    s_mov_b32 s78, 32
    s_lshl_b32 s76, s5, 13
    s_add_u32 s77, s76, 64
    s_lshl_b32 s7, s5, 7
    s_cmp_ge_u32 s4, 352
    s_cbranch_scc1 pp_wd
    s_cmp_ge_u32 s4, 320
    s_cbranch_scc1 pp_wo
    s_cmp_ge_u32 s4, 224
    s_cbranch_scc1 pp_qkv
    s_cmp_eq_u32 s5, 0
    s_cselect_b32 s60, s24, s26
    s_cselect_b32 s61, s25, s27
    s_mov_b32 s62, 1835008
    s_lshr_b32 s8, s4, 3
    s_and_b32 s9, s4, 7
    s_mov_b32 s79, 3584
    s_mul_i32 s68, s9, 229376
    s_lshl_b32 s10, s8, 7
    s_add_u32 s68, s68, s10
    s_mov_b32 s78, 8192
    s_lshl_b32 s76, s6, 5
    s_add_u32 s77, s76, 32
    s_mul_i32 s11, s8, 9363
    s_lshr_b32 s11, s11, 16
    s_mul_i32 s12, s11, 7
    s_sub_u32 s12, s8, s12
    s_lshl_b32 s11, s11, 2
    s_add_u32 s11, s11, s6
    s_add_u32 s11, s11, 0
    s_mul_i32 s10, s11, 7
    s_add_u32 s10, s10, s12
    s_sub_u32 s13, s9, s11
    s_and_b32 s13, s13, 7
    s_mul_i32 s14, s13, 8
    s_add_u32 s14, s14, s12
    s_lshl_b32 s15, s12, 5
    s_lshl_b32 s13, s13, 2
    s_add_u32 s15, s15, s13
    s_cmp_lt_u32 s12, 2
    s_cselect_b32 s14, s14, s15
    s_cselect_b32 s72, 2, 1
    s_lshl_b32 s72, s72, 10
    s_lshl_b32 s14, s14, 10
    s_mul_i32 s11, s11, 229376
    s_add_u32 s14, s14, s11
    s_add_u32 s70, s14, 2097152
    s_mul_i32 s14, s9, 14336
    s_lshl_b32 s10, s10, 7
    s_add_u32 s14, s14, s10
    s_add_u32 s74, s14, 7667712
    s_mul_i32 s11, s8, 9363
    s_lshr_b32 s11, s11, 16
    s_mul_i32 s12, s11, 7
    s_sub_u32 s12, s8, s12
    s_lshl_b32 s11, s11, 2
    s_add_u32 s11, s11, s6
    s_add_u32 s11, s11, 1
    s_mul_i32 s10, s11, 7
    s_add_u32 s10, s10, s12
    s_sub_u32 s13, s9, s11
    s_and_b32 s13, s13, 7
    s_mul_i32 s14, s13, 8
    s_add_u32 s14, s14, s12
    s_lshl_b32 s15, s12, 5
    s_lshl_b32 s13, s13, 2
    s_add_u32 s15, s15, s13
    s_cmp_lt_u32 s12, 2
    s_cselect_b32 s14, s14, s15
    s_cselect_b32 s73, 2, 1
    s_lshl_b32 s73, s73, 10
    s_lshl_b32 s14, s14, 10
    s_mul_i32 s11, s11, 229376
    s_add_u32 s14, s14, s11
    s_add_u32 s71, s14, 2097152
    s_mul_i32 s14, s9, 14336
    s_lshl_b32 s10, s10, 7
    s_add_u32 s14, s14, s10
    s_add_u32 s75, s14, 7667712
    s_branch pp_done
pp_qkv:
    s_mov_b32 s60, s18
    s_mov_b32 s61, s19
    s_mov_b32 s62, 1572864
    s_sub_u32 s4, s4, 224
    s_lshr_b32 s8, s4, 3
    s_and_b32 s9, s4, 7
    s_mov_b32 s79, 3072
    s_mul_i32 s68, s9, 196608
    s_lshl_b32 s10, s8, 8
    s_add_u32 s68, s68, s10
    s_add_u32 s68, s68, s7
    s_lshr_b32 s11, s8, 2
    s_and_b32 s8, s8, 3
    s_sub_u32 s12, s11, 1
    s_lshl_b32 s13, s12, 7
    s_cmp_eq_u32 s11, 0
    s_cselect_b32 s11, 1, 2
    s_cselect_b32 s13, 256, s13
    s_cselect_b32 s12, 64, s12
    s_mul_i32 s14, s9, 6144
    s_add_u32 s13, s13, s14
    s_lshl_b32 s10, s8, 2
    s_add_u32 s10, s10, s6
    s_add_u32 s10, s10, 0
    s_sub_u32 s14, s9, s10
    s_and_b32 s14, s14, 7
    s_lshl_b32 s14, s14, 2
    s_mul_i32 s14, s14, s11
    s_add_u32 s14, s14, s12
    s_lshl_b32 s14, s14, 10
    s_mul_i32 s15, s10, 98304
    s_add_u32 s14, s14, s15
    s_add_u32 s70, s14, 0
    s_lshl_b32 s72, s11, 10
    s_mul_i32 s15, s10, 384
    s_add_u32 s15, s15, s13
    s_add_u32 s74, s15, 7602176
    s_lshl_b32 s10, s8, 2
    s_add_u32 s10, s10, s6
    s_add_u32 s10, s10, 1
    s_sub_u32 s14, s9, s10
    s_and_b32 s14, s14, 7
    s_lshl_b32 s14, s14, 2
    s_mul_i32 s14, s14, s11
    s_add_u32 s14, s14, s12
    s_lshl_b32 s14, s14, 10
    s_mul_i32 s15, s10, 98304
    s_add_u32 s14, s14, s15
    s_add_u32 s71, s14, 0
    s_lshl_b32 s73, s11, 10
    s_mul_i32 s15, s10, 384
    s_add_u32 s15, s15, s13
    s_add_u32 s75, s15, 7602176
    s_branch pp_done
pp_wo:
    s_mov_b32 s60, s20
    s_mov_b32 s61, s21
    s_mov_b32 s62, 524288
    s_sub_u32 s4, s4, 320
    s_lshr_b32 s8, s4, 3
    s_and_b32 s9, s4, 7
    s_mov_b32 s79, 1024
    s_lshl_b32 s68, s9, 16
    s_lshl_b32 s10, s8, 8
    s_add_u32 s68, s68, s10
    s_add_u32 s68, s68, s7
    s_lshl_b32 s10, s8, 17
    s_lshl_b32 s11, s9, 14
    s_add_u32 s10, s10, s11
    s_lshl_b32 s11, s6, 10
    s_add_u32 s10, s10, s11
    s_add_u32 s70, s10, 1572864
    s_add_u32 s71, s70, 1024
    s_mov_b32 s72, 4096
    s_mov_b32 s73, 4096
    s_mov_b32 s74, 536870912
    s_mov_b32 s75, 536870912
    s_branch pp_done
pp_wd:
    s_mov_b32 s60, s28
    s_mov_b32 s61, s29
    s_mov_b32 s62, 1835008
    s_sub_u32 s4, s4, 352
    s_and_b32 s8, s4, 3
    s_lshr_b32 s9, s4, 2
    s_mov_b32 s79, 1024
    s_lshl_b32 s68, s9, 16
    s_lshl_b32 s10, s8, 8
    s_add_u32 s68, s68, s10
    s_add_u32 s68, s68, s7
    s_mul_i32 s10, s9, 9363
    s_lshr_b32 s10, s10, 16
    s_mul_i32 s10, s10, 7
    s_sub_u32 s11, s9, s10
    s_lshl_b32 s12, s8, 1
    s_add_u32 s12, s12, s5
    s_sub_u32 s13, s11, s12
    s_and_b32 s13, s13, 3
    s_cmp_lt_u32 s11, 4
    s_cselect_b32 s13, s13, s11
    s_add_u32 s13, s13, s10
    s_lshl_b32 s13, s13, 13
    s_mul_i32 s12, s12, 229376
    s_add_u32 s13, s13, s12
    s_add_u32 s70, s13, 5767168
    s_cmp_ge_u32 s4, 112
    s_cselect_b32 s70, 0x20000000, s70
    s_add_u32 s71, s70, 1024
    s_mov_b32 s72, 2048
    s_mov_b32 s73, 2048
    s_mov_b32 s74, 536870912
    s_mov_b32 s75, 536870912
pp_done:
    v_mov_b32 v8, 0
    v_mov_b32 v9, 0
    v_mov_b32 v10, 0
    v_mov_b32 v11, 0
    s_mul_i32 s4, s45, 2176
    s_add_u32 s4, s4, 7864320
    s_or_b32 s5, s44, s3
    s_cmp_eq_u32 s5, 0
    s_cselect_b32 s4, s4, 0x20000000
    s_lshl_b32 s54, s45, 2
    s_cmp_eq_u32 s5, 0
    s_cselect_b32 s55, s54, 0x1000
    buffer_store_dwordx4 v[8:11], v1, s[36:39], s4 offen sc1
    buffer_store_dwordx4 v[8:11], v1, s[36:39], s4 offen offset:1024 sc1
    s_mov_b64 exec, 0xff
    buffer_store_dwordx4 v[8:11], v1, s[36:39], s4 offen offset:2048 sc1
    s_lshl_b32 s4, s45, 8
    s_add_u32 s4, s4, 7831552
    s_cmp_eq_u32 s5, 0
    s_cselect_b32 s4, s4, 0x20000000
    v_lshlrev_b32 v12, 12, v0
    s_mov_b64 exec, 0x1f
    buffer_store_dword v8, v12, s[36:39], s4 offen sc1
    s_mov_b64 exec, 0xff
    s_lshl_b32 s4, s2, 7
    s_add_u32 s4, s4, 7798784
    buffer_store_dwordx4 v[8:11], v1, s[36:39], s4 offen sc1
    s_mov_b64 exec, 0x1ffff
    s_mul_i32 s4, s2, 136
    s_add_u32 s4, s4, 7929856
    v_lshlrev_b32 v12, 3, v0
    buffer_store_dwordx2 v[8:9], v12, s[36:39], s4 offen sc1
    s_mov_b64 exec, -1
    v_bfe_u32 v8, v2, 1, 3
    v_lshlrev_b32 v9, 7, v2
    v_add_u32 v9, s48, v9
    v_add_u32 v10, 0, v3
    v_xor_b32 v10, v10, v8
    v_lshl_add_u32 v228, v10, 4, v9
    v_add_u32 v10, 2, v3
    v_xor_b32 v10, v10, v8
    v_lshl_add_u32 v229, v10, 4, v9
    v_add_u32 v10, 4, v3
    v_xor_b32 v10, v10, v8
    v_lshl_add_u32 v230, v10, 4, v9
    v_add_u32 v10, 6, v3
    v_xor_b32 v10, v10, v8
    v_lshl_add_u32 v231, v10, 4, v9
    v_bfe_u32 v8, v0, 4, 1
    v_lshlrev_b32 v8, 5, v8
    v_lshlrev_b32 v9, 3, v3
    v_bfe_u32 v10, v0, 2, 2
    v_add_u32 v9, v9, v10
    v_lshl_add_u32 v8, v9, 6, v8
    v_and_b32 v10, 3, v0
    v_lshl_add_u32 v233, v10, 3, v8
    v_add_u32 v234, 0x10000, v233
    v_mov_b32 v235, 0x3f803f80
    v_bfe_u32 v8, v0, 2, 1
    v_bfe_u32 v9, v0, 4, 1
    v_cmp_eq_u32 vcc, v8, v9
    s_nop 1
    v_cndmask_b32 v236, 0, v235, vcc
    v_mov_b32 v237, v236
    v_mov_b32 v238, v236
    v_mov_b32 v239, v236
    s_add_u32 s4, s47, 1
    s_and_b32 s4, s4, 7
    s_lshl_b32 s4, s4, 7
    s_add_u32 s4, s4, s46
    s_add_u32 m0, s48, 4096
    s_nop 0
    buffer_load_dwordx4 v224, s[40:43], s4 offen offset:0 lds
    buffer_load_dwordx4 v225, s[40:43], s4 offen offset:1024 lds
    buffer_load_dwordx4 v226, s[40:43], s4 offen offset:2048 lds
    buffer_load_dwordx4 v227, s[40:43], s4 offen offset:3072 lds
    s_waitcnt vmcnt(14)
    ds_read_b128 v[192:195], v228 offset:0
    ds_read_b128 v[196:199], v229 offset:0
    ds_read_b128 v[200:203], v230 offset:0
    ds_read_b128 v[204:207], v231 offset:0
    ds_read_b128 a[0:3], v228 offset:0
    ds_read_b128 a[4:7], v229 offset:0
    ds_read_b128 a[8:11], v230 offset:0
    ds_read_b128 a[12:15], v231 offset:0
    s_waitcnt vmcnt(10)
    s_barrier
    ds_read_b64_tr_b16 v[160:161], v233 offset:0
    ds_read_b64_tr_b16 v[162:163], v233 offset:256
    ds_read_b64_tr_b16 v[164:165], v233 offset:1024
    ds_read_b64_tr_b16 v[166:167], v233 offset:1280
    ds_read_b64_tr_b16 v[168:169], v233 offset:2048
    ds_read_b64_tr_b16 v[170:171], v233 offset:2304
    ds_read_b64_tr_b16 v[172:173], v233 offset:3072
    ds_read_b64_tr_b16 v[174:175], v233 offset:3328
    s_waitcnt lgkmcnt(6)
    s_add_u32 s4, s47, 3
    s_and_b32 s4, s4, 7
    s_lshl_b32 s4, s4, 7
    s_add_u32 s4, s4, s46
    s_add_u32 m0, s48, 0
    s_nop 0
    buffer_load_dwordx4 v224, s[40:43], s4 offen offset:0 lds
    buffer_load_dwordx4 v225, s[40:43], s4 offen offset:1024 lds
    buffer_load_dwordx4 v226, s[40:43], s4 offen offset:2048 lds
    buffer_load_dwordx4 v227, s[40:43], s4 offen offset:3072 lds
    v_mfma_f32_32x32x16_bf16 v[64:79], a[0:3], v[160:163], 0
    ds_read_b64_tr_b16 v[176:177], v233 offset:4096
    ds_read_b64_tr_b16 v[178:179], v233 offset:4352
    v_mfma_f32_16x16x32_bf16 v[208:211], v[236:239], v[160:163], 0
    v_mfma_f32_32x32x16_bf16 v[144:159], a[0:3], a[0:3], 0
    s_add_u32 s4, s47, 2
    s_and_b32 s4, s4, 7
    s_lshl_b32 s4, s4, 7
    s_add_u32 s4, s4, s46
    s_add_u32 m0, s48, 8192
    s_nop 0
    buffer_load_dwordx4 v224, s[40:43], s4 offen offset:0 lds
    buffer_load_dwordx4 v225, s[40:43], s4 offen offset:1024 lds
    buffer_load_dwordx4 v226, s[40:43], s4 offen offset:2048 lds
    buffer_load_dwordx4 v227, s[40:43], s4 offen offset:3072 lds
    s_waitcnt lgkmcnt(6)
    v_mfma_f32_32x32x16_bf16 v[80:95], a[0:3], v[164:167], 0
    ds_read_b64_tr_b16 v[180:181], v233 offset:5120
    ds_read_b64_tr_b16 v[182:183], v233 offset:5376
    v_mfma_f32_16x16x32_bf16 v[212:215], v[236:239], v[164:167], 0
    v_mfma_f32_16x16x32_bf16 v[220:223], v[236:239], a[0:3], 0
    s_lshr_b32 s51, s3, 1
    s_add_u32 s51, s51, s47
    s_add_u32 s51, s51, 2
    s_and_b32 s51, s51, 7
    s_lshl_b32 s51, s51, 2
    s_and_b32 s4, s3, 1
    s_lshl_b32 s4, s4, 1
    s_add_u32 s51, s51, s4
    s_mul_i32 s51, s51, 49152
    s_add_u32 s51, s51, s49
    s_add_u32 s51, s51, 1024
    s_add_u32 m0, s50, 16384
    s_nop 0
    buffer_load_dwordx4 v232, s[56:59], s51 offen lds
    s_waitcnt lgkmcnt(6)
    v_mfma_f32_32x32x16_bf16 v[64:79], a[4:7], v[168:171], v[64:79]
    ds_read_b64_tr_b16 v[184:185], v233 offset:6144
    ds_read_b64_tr_b16 v[186:187], v233 offset:6400
    v_mfma_f32_16x16x32_bf16 v[208:211], v[236:239], v[168:171], v[208:211]
    v_mfma_f32_32x32x16_bf16 v[144:159], a[4:7], a[4:7], v[144:159]
    s_add_u32 s51, s51, 1024
    s_add_u32 m0, s50, 17408
    s_nop 0
    buffer_load_dwordx4 v232, s[56:59], s51 offen lds
    s_waitcnt lgkmcnt(6)
    v_mfma_f32_32x32x16_bf16 v[80:95], a[4:7], v[172:175], v[80:95]
    ds_read_b64_tr_b16 v[188:189], v233 offset:7168
    ds_read_b64_tr_b16 v[190:191], v233 offset:7424
    v_mfma_f32_16x16x32_bf16 v[212:215], v[236:239], v[172:175], v[212:215]
    v_mfma_f32_16x16x32_bf16 v[220:223], v[236:239], a[4:7], v[220:223]
    s_add_u32 s51, s51, 48128
    s_add_u32 m0, s50, 18432
    s_nop 0
    buffer_load_dwordx4 v232, s[56:59], s51 offen lds
    s_waitcnt lgkmcnt(6)
    v_mfma_f32_32x32x16_bf16 v[64:79], a[8:11], v[176:179], v[64:79]
    ds_read_b64_tr_b16 v[160:161], v233 offset:8192
    ds_read_b64_tr_b16 v[162:163], v233 offset:8448
    v_mfma_f32_16x16x32_bf16 v[208:211], v[236:239], v[176:179], v[208:211]
    v_mfma_f32_32x32x16_bf16 v[144:159], a[8:11], a[8:11], v[144:159]
    s_waitcnt vmcnt(11)
    ds_read_b128 a[16:19], v228 offset:4096
    ds_read_b128 a[20:23], v229 offset:4096
    ds_read_b128 a[24:27], v230 offset:4096
    ds_read_b128 a[28:31], v231 offset:4096
    s_add_u32 s51, s51, 1024
    s_add_u32 m0, s50, 19456
    s_nop 0
    buffer_load_dwordx4 v232, s[56:59], s51 offen lds
    s_waitcnt lgkmcnt(10)
    v_mfma_f32_32x32x16_bf16 v[80:95], a[8:11], v[180:183], v[80:95]
    ds_read_b64_tr_b16 v[164:165], v233 offset:9216
    ds_read_b64_tr_b16 v[166:167], v233 offset:9472
    v_mfma_f32_16x16x32_bf16 v[212:215], v[236:239], v[180:183], v[212:215]
    v_mfma_f32_16x16x32_bf16 v[220:223], v[236:239], a[8:11], v[220:223]
    s_lshr_b32 s51, s3, 1
    s_add_u32 s51, s51, s47
    s_add_u32 s51, s51, 4
    s_and_b32 s51, s51, 7
    s_lshl_b32 s51, s51, 2
    s_and_b32 s4, s3, 1
    s_lshl_b32 s4, s4, 1
    s_add_u32 s51, s51, s4
    s_mul_i32 s51, s51, 49152
    s_add_u32 s51, s51, s49
    s_add_u32 s51, s51, 1024
    s_add_u32 m0, s50, 32768
    s_nop 0
    buffer_load_dwordx4 v232, s[56:59], s51 offen lds
    s_waitcnt lgkmcnt(10)
    v_mfma_f32_32x32x16_bf16 v[64:79], a[12:15], v[184:187], v[64:79]
    ds_read_b64_tr_b16 v[168:169], v233 offset:10240
    ds_read_b64_tr_b16 v[170:171], v233 offset:10496
    v_mfma_f32_16x16x32_bf16 v[208:211], v[236:239], v[184:187], v[208:211]
    v_mfma_f32_32x32x16_bf16 v[144:159], a[12:15], a[12:15], v[144:159]
    s_add_u32 s51, s51, 1024
    s_add_u32 m0, s50, 33792
    s_nop 0
    buffer_load_dwordx4 v232, s[56:59], s51 offen lds
    s_waitcnt lgkmcnt(10)
    v_mfma_f32_32x32x16_bf16 v[80:95], a[12:15], v[188:191], v[80:95]
    ds_read_b64_tr_b16 v[172:173], v233 offset:11264
    ds_read_b64_tr_b16 v[174:175], v233 offset:11520
    v_mfma_f32_16x16x32_bf16 v[212:215], v[236:239], v[188:191], v[212:215]
    v_mfma_f32_16x16x32_bf16 v[220:223], v[236:239], a[12:15], v[220:223]
    s_add_u32 s51, s51, 48128
    s_add_u32 m0, s50, 34816
    s_nop 0
    buffer_load_dwordx4 v232, s[56:59], s51 offen lds
    s_waitcnt lgkmcnt(10)
    s_waitcnt lgkmcnt(6)
    s_add_u32 s4, s47, 4
    s_and_b32 s4, s4, 7
    s_lshl_b32 s4, s4, 7
    s_add_u32 s4, s4, s46
    s_add_u32 m0, s48, 4096
    s_nop 0
    buffer_load_dwordx4 v224, s[40:43], s4 offen offset:0 lds
    buffer_load_dwordx4 v225, s[40:43], s4 offen offset:1024 lds
    buffer_load_dwordx4 v226, s[40:43], s4 offen offset:2048 lds
    buffer_load_dwordx4 v227, s[40:43], s4 offen offset:3072 lds
    v_mfma_f32_32x32x16_bf16 v[64:79], a[16:19], v[160:163], v[64:79]
    ds_read_b64_tr_b16 v[176:177], v233 offset:12288
    ds_read_b64_tr_b16 v[178:179], v233 offset:12544
    v_mfma_f32_16x16x32_bf16 v[208:211], v[236:239], v[160:163], v[208:211]
    v_mfma_f32_32x32x16_bf16 v[144:159], a[16:19], a[16:19], v[144:159]
    s_add_u32 s51, s51, 1024
    s_add_u32 m0, s50, 35840
    s_nop 0
    buffer_load_dwordx4 v232, s[56:59], s51 offen lds
    s_waitcnt lgkmcnt(6)
    v_mfma_f32_32x32x16_bf16 v[80:95], a[16:19], v[164:167], v[80:95]
    ds_read_b64_tr_b16 v[180:181], v233 offset:13312
    ds_read_b64_tr_b16 v[182:183], v233 offset:13568
    v_mfma_f32_16x16x32_bf16 v[212:215], v[236:239], v[164:167], v[212:215]
    v_mfma_f32_16x16x32_bf16 v[220:223], v[236:239], a[16:19], v[220:223]
    s_waitcnt lgkmcnt(6)
    v_mfma_f32_32x32x16_bf16 v[64:79], a[20:23], v[168:171], v[64:79]
    ds_read_b64_tr_b16 v[184:185], v233 offset:14336
    ds_read_b64_tr_b16 v[186:187], v233 offset:14592
    v_mfma_f32_16x16x32_bf16 v[208:211], v[236:239], v[168:171], v[208:211]
    v_mfma_f32_32x32x16_bf16 v[144:159], a[20:23], a[20:23], v[144:159]
    s_waitcnt lgkmcnt(6)
    v_mfma_f32_32x32x16_bf16 v[80:95], a[20:23], v[172:175], v[80:95]
    ds_read_b64_tr_b16 v[188:189], v233 offset:15360
    ds_read_b64_tr_b16 v[190:191], v233 offset:15616
    v_mfma_f32_16x16x32_bf16 v[212:215], v[236:239], v[172:175], v[212:215]
    v_mfma_f32_16x16x32_bf16 v[220:223], v[236:239], a[20:23], v[220:223]
    s_waitcnt lgkmcnt(6)
    v_mfma_f32_32x32x16_bf16 v[64:79], a[24:27], v[176:179], v[64:79]
    s_waitcnt vmcnt(8)
    s_barrier
    ds_read_b64_tr_b16 v[160:161], v233 offset:16384
    ds_read_b64_tr_b16 v[162:163], v233 offset:16640
    v_mfma_f32_16x16x32_bf16 v[208:211], v[236:239], v[176:179], v[208:211]
    v_mfma_f32_32x32x16_bf16 v[144:159], a[24:27], a[24:27], v[144:159]
    ds_read_b128 a[32:35], v228 offset:8192
    ds_read_b128 a[36:39], v229 offset:8192
    ds_read_b128 a[40:43], v230 offset:8192
    ds_read_b128 a[44:47], v231 offset:8192
    s_lshr_b32 s51, s3, 1
    s_add_u32 s51, s51, s47
    s_add_u32 s51, s51, 6
    s_and_b32 s51, s51, 7
    s_lshl_b32 s51, s51, 2
    s_and_b32 s4, s3, 1
    s_lshl_b32 s4, s4, 1
    s_add_u32 s51, s51, s4
    s_mul_i32 s51, s51, 49152
    s_add_u32 s51, s51, s49
    s_add_u32 s51, s51, 1024
    s_add_u32 m0, s50, 49152
    s_nop 0
    buffer_load_dwordx4 v232, s[56:59], s51 offen lds
    s_waitcnt lgkmcnt(10)
    v_mfma_f32_32x32x16_bf16 v[80:95], a[24:27], v[180:183], v[80:95]
    ds_read_b64_tr_b16 v[164:165], v233 offset:17408
    ds_read_b64_tr_b16 v[166:167], v233 offset:17664
    v_mfma_f32_16x16x32_bf16 v[212:215], v[236:239], v[180:183], v[212:215]
    v_mfma_f32_16x16x32_bf16 v[220:223], v[236:239], a[24:27], v[220:223]
    s_add_u32 s51, s51, 1024
    s_add_u32 m0, s50, 50176
    s_nop 0
    buffer_load_dwordx4 v232, s[56:59], s51 offen lds
    s_waitcnt lgkmcnt(10)
    v_mfma_f32_32x32x16_bf16 v[64:79], a[28:31], v[184:187], v[64:79]
    ds_read_b64_tr_b16 v[168:169], v233 offset:18432
    ds_read_b64_tr_b16 v[170:171], v233 offset:18688
    v_mfma_f32_16x16x32_bf16 v[208:211], v[236:239], v[184:187], v[208:211]
    v_mfma_f32_32x32x16_bf16 v[144:159], a[28:31], a[28:31], v[144:159]
    s_add_u32 s51, s51, 48128
    s_add_u32 m0, s50, 51200
    s_nop 0
    buffer_load_dwordx4 v232, s[56:59], s51 offen lds
    s_waitcnt lgkmcnt(10)
    v_mfma_f32_32x32x16_bf16 v[80:95], a[28:31], v[188:191], v[80:95]
    ds_read_b64_tr_b16 v[172:173], v233 offset:19456
    ds_read_b64_tr_b16 v[174:175], v233 offset:19712
    v_mfma_f32_16x16x32_bf16 v[212:215], v[236:239], v[188:191], v[212:215]
    v_mfma_f32_16x16x32_bf16 v[220:223], v[236:239], a[28:31], v[220:223]
    s_add_u32 s51, s51, 1024
    s_add_u32 m0, s50, 52224
    s_nop 0
    buffer_load_dwordx4 v232, s[56:59], s51 offen lds
    s_waitcnt lgkmcnt(10)
    s_waitcnt lgkmcnt(6)
    s_add_u32 s4, s47, 5
    s_and_b32 s4, s4, 7
    s_lshl_b32 s4, s4, 7
    s_add_u32 s4, s4, s46
    s_add_u32 m0, s48, 8192
    s_nop 0
    buffer_load_dwordx4 v224, s[40:43], s4 offen offset:0 lds
    buffer_load_dwordx4 v225, s[40:43], s4 offen offset:1024 lds
    buffer_load_dwordx4 v226, s[40:43], s4 offen offset:2048 lds
    buffer_load_dwordx4 v227, s[40:43], s4 offen offset:3072 lds
    v_mfma_f32_32x32x16_bf16 v[64:79], a[32:35], v[160:163], v[64:79]
    ds_read_b64_tr_b16 v[176:177], v233 offset:20480
    ds_read_b64_tr_b16 v[178:179], v233 offset:20736
    v_mfma_f32_16x16x32_bf16 v[208:211], v[236:239], v[160:163], v[208:211]
    v_mfma_f32_32x32x16_bf16 v[144:159], a[32:35], a[32:35], v[144:159]
    s_waitcnt lgkmcnt(6)
    v_mfma_f32_32x32x16_bf16 v[80:95], a[32:35], v[164:167], v[80:95]
    ds_read_b64_tr_b16 v[180:181], v233 offset:21504
    ds_read_b64_tr_b16 v[182:183], v233 offset:21760
    v_mfma_f32_16x16x32_bf16 v[212:215], v[236:239], v[164:167], v[212:215]
    v_mfma_f32_16x16x32_bf16 v[220:223], v[236:239], a[32:35], v[220:223]
    s_waitcnt lgkmcnt(6)
    v_mfma_f32_32x32x16_bf16 v[64:79], a[36:39], v[168:171], v[64:79]
    ds_read_b64_tr_b16 v[184:185], v233 offset:22528
    ds_read_b64_tr_b16 v[186:187], v233 offset:22784
    v_mfma_f32_16x16x32_bf16 v[208:211], v[236:239], v[168:171], v[208:211]
    v_mfma_f32_32x32x16_bf16 v[144:159], a[36:39], a[36:39], v[144:159]
    s_waitcnt lgkmcnt(6)
    v_mfma_f32_32x32x16_bf16 v[80:95], a[36:39], v[172:175], v[80:95]
    ds_read_b64_tr_b16 v[188:189], v233 offset:23552
    ds_read_b64_tr_b16 v[190:191], v233 offset:23808
    v_mfma_f32_16x16x32_bf16 v[212:215], v[236:239], v[172:175], v[212:215]
    v_mfma_f32_16x16x32_bf16 v[220:223], v[236:239], a[36:39], v[220:223]
    s_waitcnt lgkmcnt(6)
    v_mfma_f32_32x32x16_bf16 v[64:79], a[40:43], v[176:179], v[64:79]
    ds_read_b64_tr_b16 v[160:161], v233 offset:24576
    ds_read_b64_tr_b16 v[162:163], v233 offset:24832
    v_mfma_f32_16x16x32_bf16 v[208:211], v[236:239], v[176:179], v[208:211]
    v_mfma_f32_32x32x16_bf16 v[144:159], a[40:43], a[40:43], v[144:159]
    ds_read_b128 a[48:51], v228 offset:0
    ds_read_b128 a[52:55], v229 offset:0
    ds_read_b128 a[56:59], v230 offset:0
    ds_read_b128 a[60:63], v231 offset:0
    s_waitcnt lgkmcnt(10)
    v_mfma_f32_32x32x16_bf16 v[80:95], a[40:43], v[180:183], v[80:95]
    ds_read_b64_tr_b16 v[164:165], v233 offset:25600
    ds_read_b64_tr_b16 v[166:167], v233 offset:25856
    v_mfma_f32_16x16x32_bf16 v[212:215], v[236:239], v[180:183], v[212:215]
    v_mfma_f32_16x16x32_bf16 v[220:223], v[236:239], a[40:43], v[220:223]
    s_waitcnt lgkmcnt(10)
    v_mfma_f32_32x32x16_bf16 v[64:79], a[44:47], v[184:187], v[64:79]
    ds_read_b64_tr_b16 v[168:169], v233 offset:26624
    ds_read_b64_tr_b16 v[170:171], v233 offset:26880
    v_mfma_f32_16x16x32_bf16 v[208:211], v[236:239], v[184:187], v[208:211]
    v_mfma_f32_32x32x16_bf16 v[144:159], a[44:47], a[44:47], v[144:159]
    s_waitcnt lgkmcnt(10)
    v_mfma_f32_32x32x16_bf16 v[80:95], a[44:47], v[188:191], v[80:95]
    ds_read_b64_tr_b16 v[172:173], v233 offset:27648
    ds_read_b64_tr_b16 v[174:175], v233 offset:27904
    v_mfma_f32_16x16x32_bf16 v[212:215], v[236:239], v[188:191], v[212:215]
    v_mfma_f32_16x16x32_bf16 v[220:223], v[236:239], a[44:47], v[220:223]
    s_waitcnt lgkmcnt(10)
    s_waitcnt lgkmcnt(6)
    s_add_u32 s4, s47, 6
    s_and_b32 s4, s4, 7
    s_lshl_b32 s4, s4, 7
    s_add_u32 s4, s4, s46
    s_add_u32 m0, s48, 0
    s_nop 0
    buffer_load_dwordx4 v224, s[40:43], s4 offen offset:0 lds
    buffer_load_dwordx4 v225, s[40:43], s4 offen offset:1024 lds
    buffer_load_dwordx4 v226, s[40:43], s4 offen offset:2048 lds
    buffer_load_dwordx4 v227, s[40:43], s4 offen offset:3072 lds
    v_mfma_f32_32x32x16_bf16 v[64:79], a[48:51], v[160:163], v[64:79]
    ds_read_b64_tr_b16 v[176:177], v233 offset:28672
    ds_read_b64_tr_b16 v[178:179], v233 offset:28928
    v_mfma_f32_16x16x32_bf16 v[208:211], v[236:239], v[160:163], v[208:211]
    v_mfma_f32_32x32x16_bf16 v[144:159], a[48:51], a[48:51], v[144:159]
    s_waitcnt lgkmcnt(6)
    v_mfma_f32_32x32x16_bf16 v[80:95], a[48:51], v[164:167], v[80:95]
    ds_read_b64_tr_b16 v[180:181], v233 offset:29696
    ds_read_b64_tr_b16 v[182:183], v233 offset:29952
    v_mfma_f32_16x16x32_bf16 v[212:215], v[236:239], v[164:167], v[212:215]
    v_mfma_f32_16x16x32_bf16 v[220:223], v[236:239], a[48:51], v[220:223]
    s_waitcnt lgkmcnt(6)
    v_mfma_f32_32x32x16_bf16 v[64:79], a[52:55], v[168:171], v[64:79]
    ds_read_b64_tr_b16 v[184:185], v233 offset:30720
    ds_read_b64_tr_b16 v[186:187], v233 offset:30976
    v_mfma_f32_16x16x32_bf16 v[208:211], v[236:239], v[168:171], v[208:211]
    v_mfma_f32_32x32x16_bf16 v[144:159], a[52:55], a[52:55], v[144:159]
    s_waitcnt lgkmcnt(6)
    v_mfma_f32_32x32x16_bf16 v[80:95], a[52:55], v[172:175], v[80:95]
    ds_read_b64_tr_b16 v[188:189], v233 offset:31744
    ds_read_b64_tr_b16 v[190:191], v233 offset:32000
    v_mfma_f32_16x16x32_bf16 v[212:215], v[236:239], v[172:175], v[212:215]
    v_mfma_f32_16x16x32_bf16 v[220:223], v[236:239], a[52:55], v[220:223]
    s_waitcnt lgkmcnt(6)
    v_mfma_f32_32x32x16_bf16 v[64:79], a[56:59], v[176:179], v[64:79]
    s_waitcnt vmcnt(12)
    s_barrier
    v_mov_b32 v8, 1
    v_mov_b32 v9, 0
    s_mov_b64 exec, 1
    buffer_store_dword v8, v9, s[64:67], s55 offen offset:0 sc1
    s_mov_b64 exec, -1
    ds_read_b64_tr_b16 v[160:161], v233 offset:32768
    ds_read_b64_tr_b16 v[162:163], v233 offset:33024
    v_mfma_f32_16x16x32_bf16 v[208:211], v[236:239], v[176:179], v[208:211]
    v_mfma_f32_32x32x16_bf16 v[144:159], a[56:59], a[56:59], v[144:159]
    ds_read_b128 a[64:67], v228 offset:4096
    ds_read_b128 a[68:71], v229 offset:4096
    ds_read_b128 a[72:75], v230 offset:4096
    ds_read_b128 a[76:79], v231 offset:4096
    s_add_u32 s51, s3, s47
    s_add_u32 s51, s51, 0
    s_and_b32 s51, s51, 7
    s_mul_i32 s51, s51, 196608
    s_add_u32 s51, s51, s49
    s_add_u32 m0, s50, 65536
    s_nop 0
    buffer_load_dwordx4 v232, s[56:59], s51 offen lds
    s_waitcnt lgkmcnt(10)
    v_mfma_f32_32x32x16_bf16 v[80:95], a[56:59], v[180:183], v[80:95]
    ds_read_b64_tr_b16 v[164:165], v233 offset:33792
    ds_read_b64_tr_b16 v[166:167], v233 offset:34048
    v_mfma_f32_16x16x32_bf16 v[212:215], v[236:239], v[180:183], v[212:215]
    v_mfma_f32_16x16x32_bf16 v[220:223], v[236:239], a[56:59], v[220:223]
    s_add_u32 s51, s51, 49152
    s_add_u32 m0, s50, 66560
    s_nop 0
    buffer_load_dwordx4 v232, s[56:59], s51 offen lds
    s_waitcnt lgkmcnt(10)
    v_mfma_f32_32x32x16_bf16 v[64:79], a[60:63], v[184:187], v[64:79]
    ds_read_b64_tr_b16 v[168:169], v233 offset:34816
    ds_read_b64_tr_b16 v[170:171], v233 offset:35072
    v_mfma_f32_16x16x32_bf16 v[208:211], v[236:239], v[184:187], v[208:211]
    v_mfma_f32_32x32x16_bf16 v[144:159], a[60:63], a[60:63], v[144:159]
    s_add_u32 s51, s51, 49152
    s_add_u32 m0, s50, 67584
    s_nop 0
    buffer_load_dwordx4 v232, s[56:59], s51 offen lds
    s_waitcnt lgkmcnt(10)
    v_mfma_f32_32x32x16_bf16 v[80:95], a[60:63], v[188:191], v[80:95]
    ds_read_b64_tr_b16 v[172:173], v233 offset:35840
    ds_read_b64_tr_b16 v[174:175], v233 offset:36096
    v_mfma_f32_16x16x32_bf16 v[212:215], v[236:239], v[188:191], v[212:215]
    v_mfma_f32_16x16x32_bf16 v[220:223], v[236:239], a[60:63], v[220:223]
    s_add_u32 s51, s51, 49152
    s_add_u32 m0, s50, 68608
    s_nop 0
    buffer_load_dwordx4 v232, s[56:59], s51 offen lds
    s_waitcnt lgkmcnt(10)
    s_waitcnt lgkmcnt(6)
    s_add_u32 s4, s47, 7
    s_and_b32 s4, s4, 7
    s_lshl_b32 s4, s4, 7
    s_add_u32 s4, s4, s46
    s_add_u32 m0, s48, 4096
    s_nop 0
    buffer_load_dwordx4 v224, s[40:43], s4 offen offset:0 lds
    buffer_load_dwordx4 v225, s[40:43], s4 offen offset:1024 lds
    buffer_load_dwordx4 v226, s[40:43], s4 offen offset:2048 lds
    buffer_load_dwordx4 v227, s[40:43], s4 offen offset:3072 lds
    v_mfma_f32_32x32x16_bf16 v[64:79], a[64:67], v[160:163], v[64:79]
    ds_read_b64_tr_b16 v[176:177], v233 offset:36864
    ds_read_b64_tr_b16 v[178:179], v233 offset:37120
    v_mfma_f32_16x16x32_bf16 v[208:211], v[236:239], v[160:163], v[208:211]
    v_mfma_f32_32x32x16_bf16 v[144:159], a[64:67], a[64:67], v[144:159]
    s_waitcnt lgkmcnt(6)
    v_mfma_f32_32x32x16_bf16 v[80:95], a[64:67], v[164:167], v[80:95]
    ds_read_b64_tr_b16 v[180:181], v233 offset:37888
    ds_read_b64_tr_b16 v[182:183], v233 offset:38144
    v_mfma_f32_16x16x32_bf16 v[212:215], v[236:239], v[164:167], v[212:215]
    v_mfma_f32_16x16x32_bf16 v[220:223], v[236:239], a[64:67], v[220:223]
    s_waitcnt lgkmcnt(6)
    v_mfma_f32_32x32x16_bf16 v[64:79], a[68:71], v[168:171], v[64:79]
    ds_read_b64_tr_b16 v[184:185], v233 offset:38912
    ds_read_b64_tr_b16 v[186:187], v233 offset:39168
    v_mfma_f32_16x16x32_bf16 v[208:211], v[236:239], v[168:171], v[208:211]
    v_mfma_f32_32x32x16_bf16 v[144:159], a[68:71], a[68:71], v[144:159]
    s_waitcnt lgkmcnt(6)
    v_mfma_f32_32x32x16_bf16 v[80:95], a[68:71], v[172:175], v[80:95]
    ds_read_b64_tr_b16 v[188:189], v233 offset:39936
    ds_read_b64_tr_b16 v[190:191], v233 offset:40192
    v_mfma_f32_16x16x32_bf16 v[212:215], v[236:239], v[172:175], v[212:215]
    v_mfma_f32_16x16x32_bf16 v[220:223], v[236:239], a[68:71], v[220:223]
    s_waitcnt lgkmcnt(6)
    v_mfma_f32_32x32x16_bf16 v[64:79], a[72:75], v[176:179], v[64:79]
    ds_read_b64_tr_b16 v[160:161], v233 offset:40960
    ds_read_b64_tr_b16 v[162:163], v233 offset:41216
    v_mfma_f32_16x16x32_bf16 v[208:211], v[236:239], v[176:179], v[208:211]
    v_mfma_f32_32x32x16_bf16 v[144:159], a[72:75], a[72:75], v[144:159]
    s_waitcnt vmcnt(13)
    ds_read_b128 a[80:83], v228 offset:8192
    ds_read_b128 a[84:87], v229 offset:8192
    ds_read_b128 a[88:91], v230 offset:8192
    ds_read_b128 a[92:95], v231 offset:8192
    s_waitcnt lgkmcnt(10)
    v_mfma_f32_32x32x16_bf16 v[80:95], a[72:75], v[180:183], v[80:95]
    ds_read_b64_tr_b16 v[164:165], v233 offset:41984
    ds_read_b64_tr_b16 v[166:167], v233 offset:42240
    v_mfma_f32_16x16x32_bf16 v[212:215], v[236:239], v[180:183], v[212:215]
    v_mfma_f32_16x16x32_bf16 v[220:223], v[236:239], a[72:75], v[220:223]
    s_waitcnt lgkmcnt(10)
    v_mfma_f32_32x32x16_bf16 v[64:79], a[76:79], v[184:187], v[64:79]
    ds_read_b64_tr_b16 v[168:169], v233 offset:43008
    ds_read_b64_tr_b16 v[170:171], v233 offset:43264
    v_mfma_f32_16x16x32_bf16 v[208:211], v[236:239], v[184:187], v[208:211]
    v_mfma_f32_32x32x16_bf16 v[144:159], a[76:79], a[76:79], v[144:159]
    s_waitcnt lgkmcnt(10)
    v_mfma_f32_32x32x16_bf16 v[80:95], a[76:79], v[188:191], v[80:95]
    ds_read_b64_tr_b16 v[172:173], v233 offset:44032
    ds_read_b64_tr_b16 v[174:175], v233 offset:44288
    v_mfma_f32_16x16x32_bf16 v[212:215], v[236:239], v[188:191], v[212:215]
    v_mfma_f32_16x16x32_bf16 v[220:223], v[236:239], a[76:79], v[220:223]
    s_waitcnt lgkmcnt(10)
    s_waitcnt lgkmcnt(6)
    v_mfma_f32_32x32x16_bf16 v[64:79], a[80:83], v[160:163], v[64:79]
    ds_read_b64_tr_b16 v[176:177], v233 offset:45056
    ds_read_b64_tr_b16 v[178:179], v233 offset:45312
    v_mfma_f32_16x16x32_bf16 v[208:211], v[236:239], v[160:163], v[208:211]
    v_mfma_f32_32x32x16_bf16 v[144:159], a[80:83], a[80:83], v[144:159]
    s_waitcnt lgkmcnt(6)
    v_mfma_f32_32x32x16_bf16 v[80:95], a[80:83], v[164:167], v[80:95]
    ds_read_b64_tr_b16 v[180:181], v233 offset:46080
    ds_read_b64_tr_b16 v[182:183], v233 offset:46336
    v_mfma_f32_16x16x32_bf16 v[212:215], v[236:239], v[164:167], v[212:215]
    v_mfma_f32_16x16x32_bf16 v[220:223], v[236:239], a[80:83], v[220:223]
    s_waitcnt lgkmcnt(6)
    v_mfma_f32_32x32x16_bf16 v[64:79], a[84:87], v[168:171], v[64:79]
    ds_read_b64_tr_b16 v[184:185], v233 offset:47104
    ds_read_b64_tr_b16 v[186:187], v233 offset:47360
    v_mfma_f32_16x16x32_bf16 v[208:211], v[236:239], v[168:171], v[208:211]
    v_mfma_f32_32x32x16_bf16 v[144:159], a[84:87], a[84:87], v[144:159]
    s_waitcnt lgkmcnt(6)
    v_mfma_f32_32x32x16_bf16 v[80:95], a[84:87], v[172:175], v[80:95]
    ds_read_b64_tr_b16 v[188:189], v233 offset:48128
    ds_read_b64_tr_b16 v[190:191], v233 offset:48384
    v_mfma_f32_16x16x32_bf16 v[212:215], v[236:239], v[172:175], v[212:215]
    v_mfma_f32_16x16x32_bf16 v[220:223], v[236:239], a[84:87], v[220:223]
    s_waitcnt lgkmcnt(6)
    v_mfma_f32_32x32x16_bf16 v[64:79], a[88:91], v[176:179], v[64:79]
    s_barrier
    ds_read_b64_tr_b16 v[160:161], v233 offset:49152
    ds_read_b64_tr_b16 v[162:163], v233 offset:49408
    v_mfma_f32_16x16x32_bf16 v[208:211], v[236:239], v[176:179], v[208:211]
    v_mfma_f32_32x32x16_bf16 v[144:159], a[88:91], a[88:91], v[144:159]
    s_waitcnt vmcnt(9)
    ds_read_b128 a[96:99], v228 offset:0
    ds_read_b128 a[100:103], v229 offset:0
    ds_read_b128 a[104:107], v230 offset:0
    ds_read_b128 a[108:111], v231 offset:0
    s_add_u32 s51, s3, s47
    s_add_u32 s51, s51, 4
    s_and_b32 s51, s51, 7
    s_mul_i32 s51, s51, 196608
    s_add_u32 s51, s51, s49
    s_add_u32 m0, s50, 81920
    s_nop 0
    buffer_load_dwordx4 v232, s[56:59], s51 offen lds
    s_waitcnt lgkmcnt(10)
    v_mfma_f32_32x32x16_bf16 v[80:95], a[88:91], v[180:183], v[80:95]
    ds_read_b64_tr_b16 v[164:165], v233 offset:50176
    ds_read_b64_tr_b16 v[166:167], v233 offset:50432
    v_mfma_f32_16x16x32_bf16 v[212:215], v[236:239], v[180:183], v[212:215]
    v_mfma_f32_16x16x32_bf16 v[220:223], v[236:239], a[88:91], v[220:223]
    s_add_u32 s51, s51, 49152
    s_add_u32 m0, s50, 82944
    s_nop 0
    buffer_load_dwordx4 v232, s[56:59], s51 offen lds
    s_waitcnt lgkmcnt(10)
    v_mfma_f32_32x32x16_bf16 v[64:79], a[92:95], v[184:187], v[64:79]
    ds_read_b64_tr_b16 v[168:169], v233 offset:51200
    ds_read_b64_tr_b16 v[170:171], v233 offset:51456
    v_mfma_f32_16x16x32_bf16 v[208:211], v[236:239], v[184:187], v[208:211]
    v_mfma_f32_32x32x16_bf16 v[144:159], a[92:95], a[92:95], v[144:159]
    s_add_u32 s51, s51, 49152
    s_add_u32 m0, s50, 83968
    s_nop 0
    buffer_load_dwordx4 v232, s[56:59], s51 offen lds
    s_waitcnt lgkmcnt(10)
    v_mfma_f32_32x32x16_bf16 v[80:95], a[92:95], v[188:191], v[80:95]
    ds_read_b64_tr_b16 v[172:173], v233 offset:52224
    ds_read_b64_tr_b16 v[174:175], v233 offset:52480
    v_mfma_f32_16x16x32_bf16 v[212:215], v[236:239], v[188:191], v[212:215]
    v_mfma_f32_16x16x32_bf16 v[220:223], v[236:239], a[92:95], v[220:223]
    s_add_u32 s51, s51, 49152
    s_add_u32 m0, s50, 84992
    s_nop 0
    buffer_load_dwordx4 v232, s[56:59], s51 offen lds
    s_waitcnt lgkmcnt(10)
    s_waitcnt lgkmcnt(6)
    v_mfma_f32_32x32x16_bf16 v[64:79], a[96:99], v[160:163], v[64:79]
    ds_read_b64_tr_b16 v[176:177], v233 offset:53248
    ds_read_b64_tr_b16 v[178:179], v233 offset:53504
    v_mfma_f32_16x16x32_bf16 v[208:211], v[236:239], v[160:163], v[208:211]
    v_mfma_f32_32x32x16_bf16 v[144:159], a[96:99], a[96:99], v[144:159]
    s_waitcnt lgkmcnt(6)
    v_mfma_f32_32x32x16_bf16 v[80:95], a[96:99], v[164:167], v[80:95]
    ds_read_b64_tr_b16 v[180:181], v233 offset:54272
    ds_read_b64_tr_b16 v[182:183], v233 offset:54528
    v_mfma_f32_16x16x32_bf16 v[212:215], v[236:239], v[164:167], v[212:215]
    v_mfma_f32_16x16x32_bf16 v[220:223], v[236:239], a[96:99], v[220:223]
    s_waitcnt lgkmcnt(6)
    v_mfma_f32_32x32x16_bf16 v[64:79], a[100:103], v[168:171], v[64:79]
    ds_read_b64_tr_b16 v[184:185], v233 offset:55296
    ds_read_b64_tr_b16 v[186:187], v233 offset:55552
    v_mfma_f32_16x16x32_bf16 v[208:211], v[236:239], v[168:171], v[208:211]
    v_mfma_f32_32x32x16_bf16 v[144:159], a[100:103], a[100:103], v[144:159]
    s_waitcnt lgkmcnt(6)
    v_mfma_f32_32x32x16_bf16 v[80:95], a[100:103], v[172:175], v[80:95]
    ds_read_b64_tr_b16 v[188:189], v233 offset:56320
    ds_read_b64_tr_b16 v[190:191], v233 offset:56576
    v_mfma_f32_16x16x32_bf16 v[212:215], v[236:239], v[172:175], v[212:215]
    v_mfma_f32_16x16x32_bf16 v[220:223], v[236:239], a[100:103], v[220:223]
    s_waitcnt lgkmcnt(6)
    v_mfma_f32_32x32x16_bf16 v[64:79], a[104:107], v[176:179], v[64:79]
    ds_read_b64_tr_b16 v[160:161], v233 offset:57344
    ds_read_b64_tr_b16 v[162:163], v233 offset:57600
    v_mfma_f32_16x16x32_bf16 v[208:211], v[236:239], v[176:179], v[208:211]
    v_mfma_f32_32x32x16_bf16 v[144:159], a[104:107], a[104:107], v[144:159]
    s_waitcnt vmcnt(4)
    ds_read_b128 a[112:115], v228 offset:4096
    ds_read_b128 a[116:119], v229 offset:4096
    ds_read_b128 a[120:123], v230 offset:4096
    ds_read_b128 a[124:127], v231 offset:4096
    s_waitcnt lgkmcnt(10)
    v_mfma_f32_32x32x16_bf16 v[80:95], a[104:107], v[180:183], v[80:95]
    ds_read_b64_tr_b16 v[164:165], v233 offset:58368
    ds_read_b64_tr_b16 v[166:167], v233 offset:58624
    v_mfma_f32_16x16x32_bf16 v[212:215], v[236:239], v[180:183], v[212:215]
    v_mfma_f32_16x16x32_bf16 v[220:223], v[236:239], a[104:107], v[220:223]
    s_waitcnt lgkmcnt(10)
    v_mfma_f32_32x32x16_bf16 v[64:79], a[108:111], v[184:187], v[64:79]
    ds_read_b64_tr_b16 v[168:169], v233 offset:59392
    ds_read_b64_tr_b16 v[170:171], v233 offset:59648
    v_mfma_f32_16x16x32_bf16 v[208:211], v[236:239], v[184:187], v[208:211]
    v_mfma_f32_32x32x16_bf16 v[144:159], a[108:111], a[108:111], v[144:159]
    s_waitcnt lgkmcnt(10)
    v_mfma_f32_32x32x16_bf16 v[80:95], a[108:111], v[188:191], v[80:95]
    ds_read_b64_tr_b16 v[172:173], v233 offset:60416
    ds_read_b64_tr_b16 v[174:175], v233 offset:60672
    v_mfma_f32_16x16x32_bf16 v[212:215], v[236:239], v[188:191], v[212:215]
    v_mfma_f32_16x16x32_bf16 v[220:223], v[236:239], a[108:111], v[220:223]
    s_waitcnt lgkmcnt(10)
    s_waitcnt lgkmcnt(6)
    v_mfma_f32_32x32x16_bf16 v[64:79], a[112:115], v[160:163], v[64:79]
    ds_read_b64_tr_b16 v[176:177], v233 offset:61440
    ds_read_b64_tr_b16 v[178:179], v233 offset:61696
    v_mfma_f32_16x16x32_bf16 v[208:211], v[236:239], v[160:163], v[208:211]
    v_mfma_f32_32x32x16_bf16 v[144:159], a[112:115], a[112:115], v[144:159]
    s_waitcnt lgkmcnt(6)
    v_mfma_f32_32x32x16_bf16 v[80:95], a[112:115], v[164:167], v[80:95]
    ds_read_b64_tr_b16 v[180:181], v233 offset:62464
    ds_read_b64_tr_b16 v[182:183], v233 offset:62720
    v_mfma_f32_16x16x32_bf16 v[212:215], v[236:239], v[164:167], v[212:215]
    v_mfma_f32_16x16x32_bf16 v[220:223], v[236:239], a[112:115], v[220:223]
    s_waitcnt lgkmcnt(6)
    v_mfma_f32_32x32x16_bf16 v[64:79], a[116:119], v[168:171], v[64:79]
    ds_read_b64_tr_b16 v[184:185], v233 offset:63488
    ds_read_b64_tr_b16 v[186:187], v233 offset:63744
    v_mfma_f32_16x16x32_bf16 v[208:211], v[236:239], v[168:171], v[208:211]
    v_mfma_f32_32x32x16_bf16 v[144:159], a[116:119], a[116:119], v[144:159]
    s_waitcnt lgkmcnt(6)
    v_mfma_f32_32x32x16_bf16 v[80:95], a[116:119], v[172:175], v[80:95]
    ds_read_b64_tr_b16 v[188:189], v233 offset:64512
    ds_read_b64_tr_b16 v[190:191], v233 offset:64768
    v_mfma_f32_16x16x32_bf16 v[212:215], v[236:239], v[172:175], v[212:215]
    v_mfma_f32_16x16x32_bf16 v[220:223], v[236:239], a[116:119], v[220:223]
    s_waitcnt lgkmcnt(6)
    v_mfma_f32_32x32x16_bf16 v[64:79], a[120:123], v[176:179], v[64:79]
    v_mfma_f32_16x16x32_bf16 v[208:211], v[236:239], v[176:179], v[208:211]
    v_mfma_f32_32x32x16_bf16 v[144:159], a[120:123], a[120:123], v[144:159]
    s_waitcnt lgkmcnt(4)
    v_mfma_f32_32x32x16_bf16 v[80:95], a[120:123], v[180:183], v[80:95]
    v_mfma_f32_16x16x32_bf16 v[212:215], v[236:239], v[180:183], v[212:215]
    v_mfma_f32_16x16x32_bf16 v[220:223], v[236:239], a[120:123], v[220:223]
    s_waitcnt lgkmcnt(2)
    v_mfma_f32_32x32x16_bf16 v[64:79], a[124:127], v[184:187], v[64:79]
    s_barrier
    v_lshlrev_b32 v33, 2, v0
    buffer_load_dword v32, v33, s[64:67], 0 offen offset:0 sc1
    ds_read_b64_tr_b16 v[168:169], v234 offset:0
    ds_read_b64_tr_b16 v[170:171], v234 offset:256
    v_mfma_f32_16x16x32_bf16 v[208:211], v[236:239], v[184:187], v[208:211]
    v_mfma_f32_32x32x16_bf16 v[144:159], a[124:127], a[124:127], v[144:159]
    v_lshrrev_b32 v244, 3, v0
    v_mul_lo_u32 v244, v244, s79
    v_and_b32 v245, 7, v0
    v_lshl_add_u32 v244, v245, 4, v244
    s_lshl_b32 s69, s79, 3
    s_lshl_b32 s80, s3, 13
    s_add_u32 s80, s80, 98304
    s_waitcnt lgkmcnt(2)
    v_mfma_f32_32x32x16_bf16 v[80:95], a[124:127], v[188:191], v[80:95]
    ds_read_b64_tr_b16 v[172:173], v234 offset:1024
    ds_read_b64_tr_b16 v[174:175], v234 offset:1280
    v_mfma_f32_16x16x32_bf16 v[212:215], v[236:239], v[188:191], v[212:215]
    v_mfma_f32_16x16x32_bf16 v[220:223], v[236:239], a[124:127], v[220:223]
    s_add_u32 m0, s80, 0
    s_nop 0
    buffer_load_dwordx4 v244, s[60:63], s68 offen lds
    s_add_u32 s68, s68, s69
    s_lshl_b32 s81, s47, 12
    s_add_u32 s81, s81, s46
    s_add_u32 s81, s81, 9437184
    s_and_b32 s55, s45, 8
    s_lshl_b32 s55, s55, 26
    s_xor_b32 s81, s81, s55
    v_permlane32_swap_b32 v192, v194
    v_permlane32_swap_b32 v193, v195
    buffer_store_dwordx4 v[192:195], v1, s[36:39], s81 offen offset:0 sc1
    v_permlane32_swap_b32 v196, v198
    v_permlane32_swap_b32 v197, v199
    buffer_store_dwordx4 v[196:199], v1, s[36:39], s81 offen offset:1024 sc1
    s_xor_b32 s81, s81, 0x20000000
    v_permlane32_swap_b32 v200, v202
    v_permlane32_swap_b32 v201, v203
    buffer_store_dwordx4 v[200:203], v1, s[36:39], s81 offen offset:2048 sc1
    v_permlane32_swap_b32 v204, v206
    v_permlane32_swap_b32 v205, v207
    buffer_store_dwordx4 v[204:207], v1, s[36:39], s81 offen offset:3072 sc1
    v_and_b32 v8, 3, v2
    v_lshrrev_b32 v9, 3, v2
    v_lshl_add_u32 v8, v9, 2, v8
    v_bfe_u32 v9, v2, 2, 1
    v_xor_b32 v9, v9, v3
    v_lshl_add_u32 v8, v9, 4, v8
    v_mov_b32 v17, 0
    v_cmp_eq_u32 s[4:5], 0, v8
    v_cmp_eq_u32 s[6:7], 1, v8
    v_cmp_eq_u32 s[8:9], 2, v8
    v_cndmask_b32 v17, v17, v144, s[4:5]
    v_cmp_eq_u32 s[10:11], 3, v8
    v_cndmask_b32 v17, v17, v145, s[6:7]
    v_cmp_eq_u32 s[4:5], 4, v8
    v_cndmask_b32 v17, v17, v146, s[8:9]
    v_cmp_eq_u32 s[6:7], 5, v8
    v_cndmask_b32 v17, v17, v147, s[10:11]
    v_cmp_eq_u32 s[8:9], 6, v8
    v_cndmask_b32 v17, v17, v148, s[4:5]
    v_cmp_eq_u32 s[10:11], 7, v8
    v_cndmask_b32 v17, v17, v149, s[6:7]
    v_cmp_eq_u32 s[4:5], 8, v8
    v_cndmask_b32 v17, v17, v150, s[8:9]
    v_cmp_eq_u32 s[6:7], 9, v8
    v_cndmask_b32 v17, v17, v151, s[10:11]
    v_cmp_eq_u32 s[8:9], 10, v8
    v_cndmask_b32 v17, v17, v152, s[4:5]
    v_cmp_eq_u32 s[10:11], 11, v8
    v_cndmask_b32 v17, v17, v153, s[6:7]
    v_cmp_eq_u32 s[4:5], 12, v8
    v_cndmask_b32 v17, v17, v154, s[8:9]
    v_cmp_eq_u32 s[6:7], 13, v8
    v_cndmask_b32 v17, v17, v155, s[10:11]
    v_cmp_eq_u32 s[8:9], 14, v8
    v_cndmask_b32 v17, v17, v156, s[4:5]
    v_cmp_eq_u32 s[10:11], 15, v8
    v_cndmask_b32 v17, v17, v157, s[6:7]
    v_cndmask_b32 v17, v17, v158, s[8:9]
    v_cndmask_b32 v17, v17, v159, s[10:11]
    v_mov_b32 v8, v17
    v_mov_b32 v9, v17
    s_nop 1
    v_permlane32_swap_b32 v8, v9
    v_add_f32 v17, v8, v9
    v_mul_f32 v6, 0x3b000000, v220
    v_mul_f32 v17, 0x3b000000, v17
    v_fma_f32 v17, -v6, v6, v17
    v_max_f32 v17, 0, v17
    v_add_f32 v17, 0x3727c5ac, v17
    v_rsq_f32 v7, v17
    v_sub_f32 v42, 0, v6
    v_cndmask_b32 v42, 0, v42, s[52:53]
    v_cvt_pk_bf16_f32 v40, v42, v42
    v_lshlrev_b32 v43, 16, v40
    v_sub_f32 v43, v42, v43
    v_cvt_pk_bf16_f32 v41, v43, 0
    v_mov_b32 v42, 0
    v_mov_b32 v43, 0
    s_lshl_b32 s13, s3, 8
    s_add_u32 s13, s13, 150528
    v_lshl_add_u32 v8, v2, 2, s13
    v_lshl_add_u32 v9, v3, 4, s13
    ds_write_b32 v8, v7
    ds_read_b128 v[48:51], v9 offset:0
    ds_read_b128 v[52:55], v9 offset:32
    ds_read_b128 v[56:59], v9 offset:64
    ds_read_b128 v[60:63], v9 offset:96
    v_mul_f32 v13, 0x3fb8aa3b, v7
    v_cvt_pk_bf16_f32 v21, v208, 0
    v_mov_b32 v23, 0
    v_lshlrev_b32 v22, 16, v21
    v_sub_f32 v22, v208, v22
    v_cvt_pk_bf16_f32 v20, v208, v22
    v_mov_b32 v22, 0
    v_cvt_pk_bf16_f32 v25, v212, 0
    v_mov_b32 v27, 0
    v_lshlrev_b32 v26, 16, v25
    v_sub_f32 v26, v212, v26
    v_cvt_pk_bf16_f32 v24, v212, v26
    v_mov_b32 v26, 0
    v_mfma_f32_32x32x16_bf16 v[64:79], v[40:43], v[20:23], v[64:79]
    ds_read_b64_tr_b16 v[176:177], v234 offset:2048
    ds_read_b64_tr_b16 v[178:179], v234 offset:2304
    s_add_u32 m0, s80, 1024
    s_nop 0
    buffer_load_dwordx4 v244, s[60:63], s68 offen lds
    s_add_u32 s68, s68, s69
    v_mfma_f32_32x32x16_bf16 v[80:95], v[40:43], v[24:27], v[80:95]
    ds_read_b64_tr_b16 v[180:181], v234 offset:3072
    ds_read_b64_tr_b16 v[182:183], v234 offset:3328
    s_add_u32 m0, s80, 2048
    s_nop 0
    buffer_load_dwordx4 v244, s[60:63], s68 offen lds
    s_add_u32 s68, s68, s69
    s_waitcnt lgkmcnt(11)
    v_mfma_f32_32x32x16_bf16 v[96:111], v[168:171], a[0:3], 0
    ds_read_b64_tr_b16 v[184:185], v234 offset:4096
    ds_read_b64_tr_b16 v[186:187], v234 offset:4352
    v_mfma_f32_16x16x32_bf16 v[216:219], v[236:239], v[168:171], 0
    s_add_u32 m0, s80, 3072
    s_nop 0
    buffer_load_dwordx4 v244, s[60:63], s68 offen lds
    s_add_u32 s68, s68, s69
    s_waitcnt lgkmcnt(11)
    v_mfma_f32_32x32x16_bf16 v[96:111], v[172:175], a[4:7], v[96:111]
    ds_read_b64_tr_b16 v[188:189], v234 offset:5120
    ds_read_b64_tr_b16 v[190:191], v234 offset:5376
    v_mfma_f32_16x16x32_bf16 v[216:219], v[236:239], v[172:175], v[216:219]
    s_add_u32 m0, s80, 4096
    s_nop 0
    buffer_load_dwordx4 v244, s[60:63], s68 offen lds
    s_add_u32 s68, s68, s69
    s_waitcnt lgkmcnt(6)
    v_mfma_f32_32x32x16_bf16 v[96:111], v[176:179], a[8:11], v[96:111]
    ds_read_b64_tr_b16 v[160:161], v234 offset:6144
    ds_read_b64_tr_b16 v[162:163], v234 offset:6400
    v_mfma_f32_16x16x32_bf16 v[216:219], v[236:239], v[176:179], v[216:219]
    s_add_u32 m0, s80, 5120
    s_nop 0
    buffer_load_dwordx4 v244, s[60:63], s68 offen lds
    s_add_u32 s68, s68, s69
    s_mul_i32 s13, s3, 2176
    s_add_u32 s13, s13, 151552
    v_and_b32 v8, 15, v0
    v_lshlrev_b32 v8, 5, v8
    v_lshl_add_u32 v8, v3, 4, v8
    v_add_u32 v8, s13, v8
    s_waitcnt lgkmcnt(6)
    v_mfma_f32_32x32x16_bf16 v[96:111], v[180:183], a[12:15], v[96:111]
    ds_read_b64_tr_b16 v[164:165], v234 offset:7168
    ds_read_b64_tr_b16 v[166:167], v234 offset:7424
    v_mfma_f32_16x16x32_bf16 v[216:219], v[236:239], v[180:183], v[216:219]
    s_add_u32 m0, s80, 6144
    s_nop 0
    buffer_load_dwordx4 v244, s[60:63], s68 offen lds
    s_add_u32 s68, s68, s69
    v_bfe_u32 v4, v0, 3, 2
    v_mul_u32_u24 v4, 544, v4
    v_bfe_u32 v9, v0, 2, 1
    v_lshl_add_u32 v4, v9, 4, v4
    v_and_b32 v9, 3, v0
    v_lshl_add_u32 v4, v9, 2, v4
    v_add_u32 v4, s13, v4
    s_waitcnt lgkmcnt(6)
    v_mfma_f32_32x32x16_bf16 v[96:111], v[184:187], a[16:19], v[96:111]
    ds_read_b64_tr_b16 v[168:169], v234 offset:8192
    ds_read_b64_tr_b16 v[170:171], v234 offset:8448
    v_mfma_f32_16x16x32_bf16 v[216:219], v[236:239], v[184:187], v[216:219]
    s_add_u32 m0, s80, 7168
    s_nop 0
    buffer_load_dwordx4 v244, s[60:63], s68 offen lds
    s_add_u32 s68, s68, s69
    v_mul_f32 v64, v64, v48
    v_mul_f32 v65, v65, v49
    v_mul_f32 v128, 0x3fb8aa3b, v64
    v_mul_f32 v129, 0x3fb8aa3b, v65
    v_min_f32 v128, 0, v128
    v_min_f32 v129, 0, v129
    s_waitcnt lgkmcnt(6)
    v_mfma_f32_32x32x16_bf16 v[96:111], v[188:191], a[20:23], v[96:111]
    ds_read_b64_tr_b16 v[172:173], v234 offset:9216
    ds_read_b64_tr_b16 v[174:175], v234 offset:9472
    v_mfma_f32_16x16x32_bf16 v[216:219], v[236:239], v[188:191], v[216:219]
    v_exp_f32 v128, v128
    v_exp_f32 v129, v129
    v_max_f32 v64, 0, v64
    v_max_f32 v65, 0, v65
    v_add_f32 v128, 0x358637bd, v128
    v_add_f32 v129, 0x358637bd, v129
    v_add_f32 v64, v64, v128
    v_add_f32 v65, v65, v129
    v_cvt_pk_bf16_f32 v112, v64, v65
    s_waitcnt lgkmcnt(6)
    v_mfma_f32_32x32x16_bf16 v[96:111], v[160:163], a[24:27], v[96:111]
    ds_read_b64_tr_b16 v[176:177], v234 offset:10240
    ds_read_b64_tr_b16 v[178:179], v234 offset:10496
    v_mfma_f32_16x16x32_bf16 v[216:219], v[236:239], v[160:163], v[216:219]
    v_mul_f32 v80, v80, v48
    v_mul_f32 v81, v81, v49
    v_cvt_pk_bf16_f32 v120, v80, v81
    v_mul_f32 v66, v66, v50
    v_mul_f32 v67, v67, v51
    v_mul_f32 v128, 0x3fb8aa3b, v66
    v_mul_f32 v129, 0x3fb8aa3b, v67
    v_min_f32 v128, 0, v128
    v_min_f32 v129, 0, v129
    v_exp_f32 v128, v128
    s_waitcnt lgkmcnt(6)
    v_mfma_f32_32x32x16_bf16 v[96:111], v[164:167], a[28:31], v[96:111]
    ds_read_b64_tr_b16 v[180:181], v234 offset:11264
    ds_read_b64_tr_b16 v[182:183], v234 offset:11520
    v_mfma_f32_16x16x32_bf16 v[216:219], v[236:239], v[164:167], v[216:219]
    v_exp_f32 v129, v129
    v_max_f32 v66, 0, v66
    v_max_f32 v67, 0, v67
    v_add_f32 v128, 0x358637bd, v128
    v_add_f32 v129, 0x358637bd, v129
    v_add_f32 v66, v66, v128
    v_add_f32 v67, v67, v129
    v_cvt_pk_bf16_f32 v113, v66, v67
    v_mul_f32 v82, v82, v50
    v_mul_f32 v83, v83, v51
    s_waitcnt lgkmcnt(6)
    v_mfma_f32_32x32x16_bf16 v[96:111], v[168:171], a[32:35], v[96:111]
    ds_read_b64_tr_b16 v[184:185], v234 offset:12288
    ds_read_b64_tr_b16 v[186:187], v234 offset:12544
    v_mfma_f32_16x16x32_bf16 v[216:219], v[236:239], v[168:171], v[216:219]
    v_cvt_pk_bf16_f32 v121, v82, v83
    v_mul_f32 v68, v68, v52
    v_mul_f32 v69, v69, v53
    v_mul_f32 v128, 0x3fb8aa3b, v68
    v_mul_f32 v129, 0x3fb8aa3b, v69
    v_min_f32 v128, 0, v128
    v_min_f32 v129, 0, v129
    v_exp_f32 v128, v128
    v_exp_f32 v129, v129
    s_waitcnt lgkmcnt(6)
    v_mfma_f32_32x32x16_bf16 v[96:111], v[172:175], a[36:39], v[96:111]
    ds_read_b64_tr_b16 v[188:189], v234 offset:13312
    ds_read_b64_tr_b16 v[190:191], v234 offset:13568
    v_mfma_f32_16x16x32_bf16 v[216:219], v[236:239], v[172:175], v[216:219]
    v_max_f32 v68, 0, v68
    v_max_f32 v69, 0, v69
    v_add_f32 v128, 0x358637bd, v128
    v_add_f32 v129, 0x358637bd, v129
    v_add_f32 v68, v68, v128
    v_add_f32 v69, v69, v129
    v_cvt_pk_bf16_f32 v114, v68, v69
    v_mul_f32 v84, v84, v52
    v_mul_f32 v85, v85, v53
    v_cvt_pk_bf16_f32 v122, v84, v85
    v_mul_f32 v70, v70, v54
    s_waitcnt lgkmcnt(6)
    v_mfma_f32_32x32x16_bf16 v[96:111], v[176:179], a[40:43], v[96:111]
    ds_read_b64_tr_b16 v[160:161], v234 offset:14336
    ds_read_b64_tr_b16 v[162:163], v234 offset:14592
    v_mfma_f32_16x16x32_bf16 v[216:219], v[236:239], v[176:179], v[216:219]
    v_mul_f32 v71, v71, v55
    v_mul_f32 v128, 0x3fb8aa3b, v70
    v_mul_f32 v129, 0x3fb8aa3b, v71
    v_min_f32 v128, 0, v128
    v_min_f32 v129, 0, v129
    v_exp_f32 v128, v128
    v_exp_f32 v129, v129
    v_max_f32 v70, 0, v70
    v_max_f32 v71, 0, v71
    s_waitcnt lgkmcnt(6)
    v_mfma_f32_32x32x16_bf16 v[96:111], v[180:183], a[44:47], v[96:111]
    ds_read_b64_tr_b16 v[164:165], v234 offset:15360
    ds_read_b64_tr_b16 v[166:167], v234 offset:15616
    v_mfma_f32_16x16x32_bf16 v[216:219], v[236:239], v[180:183], v[216:219]
    v_add_f32 v128, 0x358637bd, v128
    v_add_f32 v129, 0x358637bd, v129
    v_add_f32 v70, v70, v128
    v_add_f32 v71, v71, v129
    v_cvt_pk_bf16_f32 v115, v70, v71
    v_mul_f32 v86, v86, v54
    v_mul_f32 v87, v87, v55
    v_cvt_pk_bf16_f32 v123, v86, v87
    v_mul_f32 v72, v72, v56
    v_mul_f32 v73, v73, v57
    v_mul_f32 v128, 0x3fb8aa3b, v72
    s_waitcnt lgkmcnt(6)
    v_mfma_f32_32x32x16_bf16 v[96:111], v[184:187], a[48:51], v[96:111]
    s_waitcnt vmcnt(13)
    s_barrier
    ds_read_b64_tr_b16 v[168:169], v234 offset:16384
    ds_read_b64_tr_b16 v[170:171], v234 offset:16640
    v_mfma_f32_16x16x32_bf16 v[216:219], v[236:239], v[184:187], v[216:219]
    v_mul_f32 v129, 0x3fb8aa3b, v73
    v_min_f32 v128, 0, v128
    v_min_f32 v129, 0, v129
    v_exp_f32 v128, v128
    v_exp_f32 v129, v129
    v_max_f32 v72, 0, v72
    v_max_f32 v73, 0, v73
    s_waitcnt lgkmcnt(6)
    v_mfma_f32_32x32x16_bf16 v[96:111], v[188:191], a[52:55], v[96:111]
    ds_read_b64_tr_b16 v[172:173], v234 offset:17408
    ds_read_b64_tr_b16 v[174:175], v234 offset:17664
    v_mfma_f32_16x16x32_bf16 v[216:219], v[236:239], v[188:191], v[216:219]
    v_add_f32 v128, 0x358637bd, v128
    v_add_f32 v129, 0x358637bd, v129
    v_add_f32 v72, v72, v128
    v_add_f32 v73, v73, v129
    v_cvt_pk_bf16_f32 v116, v72, v73
    v_mul_f32 v88, v88, v56
    v_mul_f32 v89, v89, v57
    v_cvt_pk_bf16_f32 v124, v88, v89
    v_mul_f32 v74, v74, v58
    v_mul_f32 v75, v75, v59
    v_mul_f32 v128, 0x3fb8aa3b, v74
    s_waitcnt lgkmcnt(6)
    v_mfma_f32_32x32x16_bf16 v[96:111], v[160:163], a[56:59], v[96:111]
    ds_read_b64_tr_b16 v[176:177], v234 offset:18432
    ds_read_b64_tr_b16 v[178:179], v234 offset:18688
    v_mfma_f32_16x16x32_bf16 v[216:219], v[236:239], v[160:163], v[216:219]
    v_mul_f32 v129, 0x3fb8aa3b, v75
    v_min_f32 v128, 0, v128
    v_min_f32 v129, 0, v129
    v_exp_f32 v128, v128
    v_exp_f32 v129, v129
    v_max_f32 v74, 0, v74
    v_max_f32 v75, 0, v75
    v_add_f32 v128, 0x358637bd, v128
    v_add_f32 v129, 0x358637bd, v129
    s_waitcnt lgkmcnt(6)
    v_mfma_f32_32x32x16_bf16 v[96:111], v[164:167], a[60:63], v[96:111]
    ds_read_b64_tr_b16 v[180:181], v234 offset:19456
    ds_read_b64_tr_b16 v[182:183], v234 offset:19712
    v_mfma_f32_16x16x32_bf16 v[216:219], v[236:239], v[164:167], v[216:219]
    v_add_f32 v74, v74, v128
    v_add_f32 v75, v75, v129
    v_cvt_pk_bf16_f32 v117, v74, v75
    v_mul_f32 v90, v90, v58
    v_mul_f32 v91, v91, v59
    v_cvt_pk_bf16_f32 v125, v90, v91
    v_mul_f32 v76, v76, v60
    v_mul_f32 v77, v77, v61
    v_mul_f32 v128, 0x3fb8aa3b, v76
    v_mul_f32 v129, 0x3fb8aa3b, v77
    v_min_f32 v128, 0, v128
    s_waitcnt lgkmcnt(6)
    v_mfma_f32_32x32x16_bf16 v[96:111], v[168:171], a[64:67], v[96:111]
    ds_read_b64_tr_b16 v[184:185], v234 offset:20480
    ds_read_b64_tr_b16 v[186:187], v234 offset:20736
    v_mfma_f32_16x16x32_bf16 v[216:219], v[236:239], v[168:171], v[216:219]
    v_min_f32 v129, 0, v129
    v_exp_f32 v128, v128
    v_exp_f32 v129, v129
    v_max_f32 v76, 0, v76
    v_max_f32 v77, 0, v77
    v_add_f32 v128, 0x358637bd, v128
    v_add_f32 v129, 0x358637bd, v129
    v_add_f32 v76, v76, v128
    v_add_f32 v77, v77, v129
    s_waitcnt lgkmcnt(6)
    v_mfma_f32_32x32x16_bf16 v[96:111], v[172:175], a[68:71], v[96:111]
    ds_read_b64_tr_b16 v[188:189], v234 offset:21504
    ds_read_b64_tr_b16 v[190:191], v234 offset:21760
    v_mfma_f32_16x16x32_bf16 v[216:219], v[236:239], v[172:175], v[216:219]
    v_cvt_pk_bf16_f32 v118, v76, v77
    v_mul_f32 v92, v92, v60
    v_mul_f32 v93, v93, v61
    v_cvt_pk_bf16_f32 v126, v92, v93
    v_mul_f32 v78, v78, v62
    v_mul_f32 v79, v79, v63
    v_mul_f32 v128, 0x3fb8aa3b, v78
    v_mul_f32 v129, 0x3fb8aa3b, v79
    v_min_f32 v128, 0, v128
    v_min_f32 v129, 0, v129
    v_exp_f32 v128, v128
    s_waitcnt lgkmcnt(6)
    v_mfma_f32_32x32x16_bf16 v[96:111], v[176:179], a[72:75], v[96:111]
    ds_read_b64_tr_b16 v[160:161], v234 offset:22528
    ds_read_b64_tr_b16 v[162:163], v234 offset:22784
    v_mfma_f32_16x16x32_bf16 v[216:219], v[236:239], v[176:179], v[216:219]
    v_exp_f32 v129, v129
    v_max_f32 v78, 0, v78
    v_max_f32 v79, 0, v79
    v_add_f32 v128, 0x358637bd, v128
    v_add_f32 v129, 0x358637bd, v129
    v_add_f32 v78, v78, v128
    v_add_f32 v79, v79, v129
    v_cvt_pk_bf16_f32 v119, v78, v79
    v_mul_f32 v94, v94, v62
    v_mul_f32 v95, v95, v63
    s_waitcnt lgkmcnt(6)
    v_mfma_f32_32x32x16_bf16 v[96:111], v[180:183], a[76:79], v[96:111]
    ds_read_b64_tr_b16 v[164:165], v234 offset:23552
    ds_read_b64_tr_b16 v[166:167], v234 offset:23808
    v_mfma_f32_16x16x32_bf16 v[216:219], v[236:239], v[180:183], v[216:219]
    v_cvt_pk_bf16_f32 v127, v94, v95
    v_mfma_f32_32x32x16_bf16 v[144:159], v[112:115], v[120:123], 0
    v_mfma_f32_16x16x32_bf16 v[44:47], v[236:239], v[112:115], 0
    v_mfma_f32_32x32x16_bf16 v[144:159], v[116:119], v[124:127], v[144:159]
    v_mfma_f32_16x16x32_bf16 v[44:47], v[236:239], v[116:119], v[44:47]
    s_mul_i32 s14, s45, 2176
    s_add_u32 s14, s14, 7864320
    s_lshl_b32 s13, s3, 8
    v_lshl_add_u32 v10, v0, 2, s13
    v_add_u32 v9, 151552, v10
    s_waitcnt lgkmcnt(6)
    v_mfma_f32_32x32x16_bf16 v[96:111], v[184:187], a[80:83], v[96:111]
    ds_read_b64_tr_b16 v[168:169], v234 offset:24576
    ds_read_b64_tr_b16 v[170:171], v234 offset:24832
    v_mfma_f32_16x16x32_bf16 v[216:219], v[236:239], v[184:187], v[216:219]
    s_waitcnt lgkmcnt(6)
    v_mfma_f32_32x32x16_bf16 v[96:111], v[188:191], a[84:87], v[96:111]
    ds_read_b64_tr_b16 v[172:173], v234 offset:25600
    ds_read_b64_tr_b16 v[174:175], v234 offset:25856
    v_mfma_f32_16x16x32_bf16 v[216:219], v[236:239], v[188:191], v[216:219]
    s_waitcnt lgkmcnt(6)
    v_mfma_f32_32x32x16_bf16 v[96:111], v[160:163], a[88:91], v[96:111]
    ds_read_b64_tr_b16 v[176:177], v234 offset:26624
    ds_read_b64_tr_b16 v[178:179], v234 offset:26880
    v_mfma_f32_16x16x32_bf16 v[216:219], v[236:239], v[160:163], v[216:219]
    s_mov_b32 exec_lo, 0x0000ffff
    s_mov_b32 exec_hi, 0x0000ffff
    ds_write_b128 v8, v[144:147]
    ds_write_b128 v8, v[148:151] offset:544
    s_mov_b32 exec_lo, 0xffff0000
    s_mov_b32 exec_hi, 0xffff0000
    ds_write_b128 v8, v[152:155] offset:1088
    ds_write_b128 v8, v[156:159] offset:1632
    s_mov_b64 exec, -1
    ds_write_b32 v4, v44 offset:512
    s_waitcnt lgkmcnt(11)
    v_mfma_f32_32x32x16_bf16 v[96:111], v[164:167], a[92:95], v[96:111]
    ds_read_b64_tr_b16 v[180:181], v234 offset:27648
    ds_read_b64_tr_b16 v[182:183], v234 offset:27904
    v_mfma_f32_16x16x32_bf16 v[216:219], v[236:239], v[164:167], v[216:219]
    s_waitcnt vmcnt(12)
    s_mov_b64 exec, 0xffff
    s_mov_b32 s5, 0
kfz1_loop:
    v_cmp_eq_u32 vcc, 0, v32
    s_add_u32 s5, s5, 1
    s_cmp_gt_u32 s5, 0x40000
    s_cbranch_scc1 kfz1_out
    s_nop 1
    s_cbranch_vccz kfz1_out
    buffer_load_dword v32, v33, s[64:67], 0 offen offset:0 sc1
    s_waitcnt vmcnt(0)
    s_branch kfz1_loop
kfz1_out:
    s_mov_b64 exec, -1
    s_waitcnt lgkmcnt(0)
    s_barrier
    ds_read_b32 v16, v9 offset:0
    ds_read_b32 v17, v9 offset:2176
    ds_read_b32 v18, v9 offset:4352
    ds_read_b32 v19, v9 offset:6528
    ds_read_b32 v20, v9 offset:1024
    ds_read_b32 v21, v9 offset:3200
    ds_read_b32 v22, v9 offset:5376
    ds_read_b32 v23, v9 offset:7552
    ds_read_b32 v24, v9 offset:2048
    ds_read_b32 v25, v9 offset:4224
    ds_read_b32 v26, v9 offset:6400
    ds_read_b32 v27, v9 offset:8576
    v_mfma_f32_32x32x16_bf16 v[96:111], v[168:171], a[96:99], v[96:111]
    ds_read_b64_tr_b16 v[184:185], v234 offset:28672
    ds_read_b64_tr_b16 v[186:187], v234 offset:28928
    v_mfma_f32_16x16x32_bf16 v[216:219], v[236:239], v[168:171], v[216:219]
    v_mfma_f32_32x32x16_bf16 v[96:111], v[172:175], a[100:103], v[96:111]
    ds_read_b64_tr_b16 v[188:189], v234 offset:29696
    ds_read_b64_tr_b16 v[190:191], v234 offset:29952
    v_mfma_f32_16x16x32_bf16 v[216:219], v[236:239], v[172:175], v[216:219]
    s_waitcnt lgkmcnt(4)
    v_add_f32 v16, v16, v17
    v_add_f32 v18, v18, v19
    v_add_f32 v20, v20, v21
    v_add_f32 v22, v22, v23
    v_add_f32 v24, v24, v25
    v_add_f32 v26, v26, v27
    v_add_f32 v16, v16, v18
    v_add_f32 v20, v20, v22
    v_add_f32 v24, v24, v26
    buffer_atomic_add_f32 v16, v10, s[36:39], s14 offen sc1
    buffer_atomic_add_f32 v20, v10, s[36:39], s14 offen offset:1024 sc1
    s_cmp_eq_u32 s3, 0
    s_cselect_b32 exec_lo, -1, 1
    s_mov_b32 exec_hi, 0
    s_cselect_b32 s15, 0, 0x10000000
    s_add_u32 s14, s14, s15
    buffer_atomic_add_f32 v24, v10, s[36:39], s14 offen offset:2048 sc1
    s_mov_b64 exec, -1
    v_mfma_f32_32x32x16_bf16 v[96:111], v[176:179], a[104:107], v[96:111]
    ds_read_b64_tr_b16 v[160:161], v234 offset:30720
    ds_read_b64_tr_b16 v[162:163], v234 offset:30976
    v_mfma_f32_16x16x32_bf16 v[216:219], v[236:239], v[176:179], v[216:219]
    v_mfma_f32_32x32x16_bf16 v[96:111], v[180:183], a[108:111], v[96:111]
    ds_read_b64_tr_b16 v[164:165], v234 offset:31744
    ds_read_b64_tr_b16 v[166:167], v234 offset:32000
    v_mfma_f32_16x16x32_bf16 v[216:219], v[236:239], v[180:183], v[216:219]
    s_waitcnt lgkmcnt(6)
    v_mfma_f32_32x32x16_bf16 v[96:111], v[184:187], a[112:115], v[96:111]
    v_mfma_f32_16x16x32_bf16 v[216:219], v[236:239], v[184:187], v[216:219]
    s_waitcnt lgkmcnt(4)
    v_mfma_f32_32x32x16_bf16 v[96:111], v[188:191], a[116:119], v[96:111]
    v_mfma_f32_16x16x32_bf16 v[216:219], v[236:239], v[188:191], v[216:219]
    s_waitcnt lgkmcnt(2)
    v_mfma_f32_32x32x16_bf16 v[96:111], v[160:163], a[120:123], v[96:111]
    v_mfma_f32_16x16x32_bf16 v[216:219], v[236:239], v[160:163], v[216:219]
    s_waitcnt lgkmcnt(0)
    v_mfma_f32_32x32x16_bf16 v[96:111], v[164:167], a[124:127], v[96:111]
    v_mfma_f32_16x16x32_bf16 v[216:219], v[236:239], v[164:167], v[216:219]
    s_nop 7
    v_cvt_pk_bf16_f32 v29, v216, 0
    v_mov_b32 v31, 0
    v_lshlrev_b32 v30, 16, v29
    v_sub_f32 v30, v216, v30
    v_cvt_pk_bf16_f32 v28, v216, v30
    v_mov_b32 v30, 0
    s_nop 1
    v_mfma_f32_32x32x16_bf16 v[96:111], v[28:31], v[40:43], v[96:111]
    s_nop 11
    v_mul_f32 v128, v96, v13
    v_mul_f32 v129, v97, v13
    v_mul_f32 v96, v96, v7
    v_mul_f32 v97, v97, v7
    v_min_f32 v128, 0, v128
    v_min_f32 v129, 0, v129
    v_exp_f32 v128, v128
    v_exp_f32 v129, v129
    v_max_f32 v96, 0, v96
    v_max_f32 v97, 0, v97
    v_add_f32 v128, 0x358637bd, v128
    v_add_f32 v129, 0x358637bd, v129
    v_add_f32 v96, v96, v128
    v_add_f32 v97, v97, v129
    v_cvt_pk_bf16_f32 v136, v96, v97
    v_mul_f32 v128, v98, v13
    v_mul_f32 v129, v99, v13
    v_mul_f32 v98, v98, v7
    v_mul_f32 v99, v99, v7
    v_min_f32 v128, 0, v128
    v_min_f32 v129, 0, v129
    v_exp_f32 v128, v128
    v_exp_f32 v129, v129
    v_max_f32 v98, 0, v98
    v_max_f32 v99, 0, v99
    v_add_f32 v128, 0x358637bd, v128
    v_add_f32 v129, 0x358637bd, v129
    v_add_f32 v98, v98, v128
    v_add_f32 v99, v99, v129
    v_cvt_pk_bf16_f32 v137, v98, v99
    s_waitcnt vmcnt(0)
    s_barrier
    s_cmp_lg_u32 s3, 0
    s_cbranch_scc1 kvs2_a
    s_lshl_b32 s4, s44, 8
    s_add_u32 s4, s4, 7831552
    v_mov_b32 v8, 1
    s_mov_b64 exec, 1
    buffer_atomic_add v8, off, s[36:39], s4 sc0 sc1
    s_mov_b64 exec, -1
kvs2_a:
    s_lshl_b32 s13, s44, 2
    s_add_u32 s13, s13, s3
    s_lshl_b32 s13, s13, 15
    s_lshl_b32 s14, s45, 11
    s_add_u32 s13, s13, s14
    s_add_u32 s13, s13, 17825792
    s_mov_b32 s40, s20
    s_mov_b32 s41, s21
    s_mov_b32 s42, 524288
    s_mov_b32 s43, 0x20000
    v_bfe_u32 v224, v0, 2, 2
    v_lshlrev_b32 v224, 10, v224
    v_lshrrev_b32 v225, 4, v0
    v_lshl_add_u32 v224, v225, 6, v224
    v_and_b32 v225, 3, v0
    v_lshl_add_u32 v224, v225, 4, v224
    s_lshl_b32 s46, s3, 17
    s_and_b32 s4, s45, 3
    s_lshl_b32 s4, s4, 8
    s_add_u32 s46, s46, s4
    s_lshl_b32 s48, s44, 1
    s_lshr_b32 s4, s45, 2
    s_add_u32 s48, s48, s4
    s_and_b32 s48, s48, 7
    s_lshl_b32 s48, s48, 14
    s_lshl_b32 s49, s3, 12
    v_lshlrev_b32 v226, 10, v3
    v_bfe_u32 v225, v0, 2, 2
    v_lshl_add_u32 v226, v225, 6, v226
    v_bfe_u32 v225, v0, 4, 1
    v_lshl_add_u32 v226, v225, 5, v226
    v_and_b32 v225, 3, v0
    v_lshl_add_u32 v226, v225, 3, v226
    s_lshl_b32 s4, s3, 8
    v_add_u32 v228, s4, v226
    v_add_u32 v229, 0x10000, v228
    s_add_u32 s51, s46, s48
    s_add_u32 m0, s49, 0
    s_nop 0
    buffer_load_dwordx4 v224, s[40:43], s51 offen lds
    s_add_u32 s51, s51, 4096
    s_add_u32 m0, s49, 1024
    s_nop 0
    buffer_load_dwordx4 v224, s[40:43], s51 offen lds
    s_add_u32 s51, s51, 4096
    s_add_u32 m0, s49, 2048
    s_nop 0
    buffer_load_dwordx4 v224, s[40:43], s51 offen lds
    s_add_u32 s51, s51, 4096
    s_add_u32 m0, s49, 3072
    s_nop 0
    buffer_load_dwordx4 v224, s[40:43], s51 offen lds
    s_add_u32 s48, s48, 16384
    s_and_b32 s48, s48, 0x1ffff
    s_add_u32 s51, s46, s48
    s_add_u32 m0, s49, 16384
    s_nop 0
    buffer_load_dwordx4 v224, s[40:43], s51 offen lds
    s_add_u32 s51, s51, 4096
    s_add_u32 m0, s49, 17408
    s_nop 0
    buffer_load_dwordx4 v224, s[40:43], s51 offen lds
    s_add_u32 s51, s51, 4096
    s_add_u32 m0, s49, 18432
    s_nop 0
    buffer_load_dwordx4 v224, s[40:43], s51 offen lds
    s_add_u32 s51, s51, 4096
    s_add_u32 m0, s49, 19456
    s_nop 0
    buffer_load_dwordx4 v224, s[40:43], s51 offen lds
    s_add_u32 s48, s48, 16384
    s_and_b32 s48, s48, 0x1ffff
    v_bfe_u32 v244, v0, 4, 1
    v_mul_lo_u32 v244, v244, s78
    v_lshlrev_b32 v245, 2, v3
    v_bfe_u32 v246, v0, 2, 2
    v_add_u32 v245, v245, v246
    v_lshl_add_u32 v244, v245, 7, v244
    v_and_b32 v246, 3, v0
    v_lshl_add_u32 v244, v246, 3, v244
    s_lshr_b32 s81, s3, 1
    s_lshl_b32 s81, s81, 14
    s_add_u32 s81, s81, 98304
    v_add_u32 v244, s81, v244
    v_add_u32 v245, s77, v244
    v_add_u32 v244, s76, v244
    v_lshlrev_b32 v246, 2, v2
    ds_read_b64_tr_b16 a[128:129], v244 offset:0
    ds_read_b64_tr_b16 a[130:131], v244 offset:1024
    ds_read_b64_tr_b16 a[132:133], v244 offset:2048
    ds_read_b64_tr_b16 a[134:135], v244 offset:3072
    ds_read_b64_tr_b16 a[136:137], v244 offset:4096
    ds_read_b64_tr_b16 a[138:139], v244 offset:5120
    ds_read_b64_tr_b16 a[140:141], v244 offset:6144
    ds_read_b64_tr_b16 a[142:143], v244 offset:7168
    ds_read_b64_tr_b16 a[144:145], v245 offset:0
    ds_read_b64_tr_b16 a[146:147], v245 offset:1024
    ds_read_b64_tr_b16 a[148:149], v245 offset:2048
    ds_read_b64_tr_b16 a[150:151], v245 offset:3072
    ds_read_b64_tr_b16 a[152:153], v245 offset:4096
    ds_read_b64_tr_b16 a[154:155], v245 offset:5120
    ds_read_b64_tr_b16 a[156:157], v245 offset:6144
    ds_read_b64_tr_b16 a[158:159], v245 offset:7168
    v_mul_f32 v128, v100, v13
    v_mul_f32 v129, v101, v13
    v_mul_f32 v100, v100, v7
    v_mul_f32 v101, v101, v7
    v_min_f32 v128, 0, v128
    v_min_f32 v129, 0, v129
    v_exp_f32 v128, v128
    v_exp_f32 v129, v129
    v_max_f32 v100, 0, v100
    v_max_f32 v101, 0, v101
    v_add_f32 v128, 0x358637bd, v128
    v_add_f32 v129, 0x358637bd, v129
    v_add_f32 v100, v100, v128
    v_add_f32 v101, v101, v129
    v_cvt_pk_bf16_f32 v138, v100, v101
    v_mul_f32 v128, v102, v13
    v_mul_f32 v129, v103, v13
    v_mul_f32 v102, v102, v7
    v_mul_f32 v103, v103, v7
    v_min_f32 v128, 0, v128
    v_min_f32 v129, 0, v129
    v_exp_f32 v128, v128
    v_exp_f32 v129, v129
    v_max_f32 v102, 0, v102
    v_max_f32 v103, 0, v103
    v_add_f32 v128, 0x358637bd, v128
    v_add_f32 v129, 0x358637bd, v129
    v_add_f32 v102, v102, v128
    v_add_f32 v103, v103, v129
    v_cvt_pk_bf16_f32 v139, v102, v103
    v_mul_f32 v128, v104, v13
    v_mul_f32 v129, v105, v13
    v_mul_f32 v104, v104, v7
    v_mul_f32 v105, v105, v7
    v_min_f32 v128, 0, v128
    v_min_f32 v129, 0, v129
    v_exp_f32 v128, v128
    v_exp_f32 v129, v129
    v_max_f32 v104, 0, v104
    v_max_f32 v105, 0, v105
    v_add_f32 v128, 0x358637bd, v128
    v_add_f32 v129, 0x358637bd, v129
    v_add_f32 v104, v104, v128
    v_add_f32 v105, v105, v129
    v_cvt_pk_bf16_f32 v140, v104, v105
    v_mul_f32 v128, v106, v13
    v_mul_f32 v129, v107, v13
    v_mul_f32 v106, v106, v7
    v_mul_f32 v107, v107, v7
    v_min_f32 v128, 0, v128
    v_min_f32 v129, 0, v129
    v_exp_f32 v128, v128
    v_exp_f32 v129, v129
    v_max_f32 v106, 0, v106
    v_max_f32 v107, 0, v107
    v_add_f32 v128, 0x358637bd, v128
    v_add_f32 v129, 0x358637bd, v129
    v_add_f32 v106, v106, v128
    v_add_f32 v107, v107, v129
    v_cvt_pk_bf16_f32 v141, v106, v107
    v_mul_f32 v128, v108, v13
    v_mul_f32 v129, v109, v13
    v_mul_f32 v108, v108, v7
    v_mul_f32 v109, v109, v7
    v_min_f32 v128, 0, v128
    v_min_f32 v129, 0, v129
    v_exp_f32 v128, v128
    v_exp_f32 v129, v129
    v_max_f32 v108, 0, v108
    v_max_f32 v109, 0, v109
    v_add_f32 v128, 0x358637bd, v128
    v_add_f32 v129, 0x358637bd, v129
    v_add_f32 v108, v108, v128
    v_add_f32 v109, v109, v129
    v_cvt_pk_bf16_f32 v142, v108, v109
    v_mul_f32 v128, v110, v13
    v_mul_f32 v129, v111, v13
    v_mul_f32 v110, v110, v7
    v_mul_f32 v111, v111, v7
    v_min_f32 v128, 0, v128
    v_min_f32 v129, 0, v129
    v_exp_f32 v128, v128
    v_exp_f32 v129, v129
    v_max_f32 v110, 0, v110
    v_max_f32 v111, 0, v111
    v_add_f32 v128, 0x358637bd, v128
    v_add_f32 v129, 0x358637bd, v129
    v_add_f32 v110, v110, v128
    v_add_f32 v111, v111, v129
    v_cvt_pk_bf16_f32 v143, v110, v111
    buffer_store_dwordx4 v[136:139], v1, s[36:39], s13 offen sc1
    buffer_store_dwordx4 v[140:143], v1, s[36:39], s13 offen offset:1024 sc1
    s_waitcnt lgkmcnt(14)
    buffer_store_dwordx4 a[128:131], v1, s[36:39], s70 offen sc1
    s_add_u32 s70, s70, s72
    v_mfma_f32_16x16x32_bf16 v[248:251], v[236:239], a[128:131], 0
    s_waitcnt lgkmcnt(12)
    buffer_store_dwordx4 a[132:135], v1, s[36:39], s70 offen sc1
    s_add_u32 s70, s70, s72
    v_mfma_f32_16x16x32_bf16 v[248:251], v[236:239], a[132:135], v[248:251]
    s_waitcnt lgkmcnt(10)
    buffer_store_dwordx4 a[136:139], v1, s[36:39], s70 offen sc1
    s_add_u32 s70, s70, s72
    v_mfma_f32_16x16x32_bf16 v[248:251], v[236:239], a[136:139], v[248:251]
    s_waitcnt lgkmcnt(8)
    buffer_store_dwordx4 a[140:143], v1, s[36:39], s70 offen sc1
    v_mfma_f32_16x16x32_bf16 v[248:251], v[236:239], a[140:143], v[248:251]
    s_waitcnt lgkmcnt(6)
    buffer_store_dwordx4 a[144:147], v1, s[36:39], s71 offen sc1
    s_add_u32 s71, s71, s73
    v_mfma_f32_16x16x32_bf16 v[252:255], v[236:239], a[144:147], 0
    s_waitcnt lgkmcnt(4)
    buffer_store_dwordx4 a[148:151], v1, s[36:39], s71 offen sc1
    s_add_u32 s71, s71, s73
    v_mfma_f32_16x16x32_bf16 v[252:255], v[236:239], a[148:151], v[252:255]
    s_waitcnt lgkmcnt(2)
    buffer_store_dwordx4 a[152:155], v1, s[36:39], s71 offen sc1
    s_add_u32 s71, s71, s73
    v_mfma_f32_16x16x32_bf16 v[252:255], v[236:239], a[152:155], v[252:255]
    s_waitcnt lgkmcnt(0)
    buffer_store_dwordx4 a[156:159], v1, s[36:39], s71 offen sc1
    v_mfma_f32_16x16x32_bf16 v[252:255], v[236:239], a[156:159], v[252:255]
    s_mov_b32 exec_hi, 0
    buffer_store_dword v248, v246, s[36:39], s74 offen sc1
    s_nop 5
    buffer_store_dword v252, v246, s[36:39], s75 offen sc1
    s_mov_b64 exec, -1
    s_cmp_lg_u32 s3, 0
    s_cbranch_scc1 kvs2_b
    s_waitcnt vmcnt(20)
    v_readfirstlane_b32 s5, v8
    s_nop 0
    s_cmp_lg_u32 s5, 15
    s_cbranch_scc1 kvs2_b
    s_mov_b32 s4, 7835648
    v_mov_b32 v8, 1
    v_lshlrev_b32 v9, 8, v0
    s_mov_b64 exec, 0xffff
    buffer_atomic_add v8, v9, s[36:39], s4 offen sc1
    s_mov_b64 exec, -1
kvs2_b:
    s_waitcnt vmcnt(10)
    s_barrier
    s_cmp_lg_u32 s3, 0
    s_cbranch_scc1 sig3
    s_lshl_b32 s4, s44, 8
    s_add_u32 s4, s4, 7847936
    v_mov_b32 v8, 1
    v_mov_b32 v9, 0
    s_mov_b64 exec, 1
    buffer_atomic_add v8, v9, s[36:39], s4 offen sc1
    s_mov_b64 exec, -1
sig3:
    s_add_u32 s51, s46, s48
    s_add_u32 m0, s49, 32768
    s_nop 0
    buffer_load_dwordx4 v224, s[40:43], s51 offen lds
    s_add_u32 s51, s51, 4096
    s_add_u32 m0, s49, 33792
    s_nop 0
    buffer_load_dwordx4 v224, s[40:43], s51 offen lds
    s_add_u32 s51, s51, 4096
    s_add_u32 m0, s49, 34816
    s_nop 0
    buffer_load_dwordx4 v224, s[40:43], s51 offen lds
    s_add_u32 s51, s51, 4096
    s_add_u32 m0, s49, 35840
    s_nop 0
    buffer_load_dwordx4 v224, s[40:43], s51 offen lds
    s_add_u32 s48, s48, 16384
    s_and_b32 s48, s48, 0x1ffff
    s_add_u32 s51, s46, s48
    s_add_u32 m0, s49, 49152
    s_nop 0
    buffer_load_dwordx4 v224, s[40:43], s51 offen lds
    s_add_u32 s51, s51, 4096
    s_add_u32 m0, s49, 50176
    s_nop 0
    buffer_load_dwordx4 v224, s[40:43], s51 offen lds
    s_add_u32 s51, s51, 4096
    s_add_u32 m0, s49, 51200
    s_nop 0
    buffer_load_dwordx4 v224, s[40:43], s51 offen lds
    s_add_u32 s51, s51, 4096
    s_add_u32 m0, s49, 52224
    s_nop 0
    buffer_load_dwordx4 v224, s[40:43], s51 offen lds
    s_add_u32 s48, s48, 16384
    s_and_b32 s48, s48, 0x1ffff
    s_add_u32 s51, s46, s48
    s_add_u32 m0, s49, 65536
    s_nop 0
    buffer_load_dwordx4 v224, s[40:43], s51 offen lds
    s_add_u32 s51, s51, 4096
    s_add_u32 m0, s49, 66560
    s_nop 0
    buffer_load_dwordx4 v224, s[40:43], s51 offen lds
    s_add_u32 s51, s51, 4096
    s_add_u32 m0, s49, 67584
    s_nop 0
    buffer_load_dwordx4 v224, s[40:43], s51 offen lds
    s_add_u32 s51, s51, 4096
    s_add_u32 m0, s49, 68608
    s_nop 0
    buffer_load_dwordx4 v224, s[40:43], s51 offen lds
    s_add_u32 s48, s48, 16384
    s_and_b32 s48, s48, 0x1ffff
    s_add_u32 s51, s46, s48
    s_add_u32 m0, s49, 81920
    s_nop 0
    buffer_load_dwordx4 v224, s[40:43], s51 offen lds
    s_add_u32 s51, s51, 4096
    s_add_u32 m0, s49, 82944
    s_nop 0
    buffer_load_dwordx4 v224, s[40:43], s51 offen lds
    s_add_u32 s51, s51, 4096
    s_add_u32 m0, s49, 83968
    s_nop 0
    buffer_load_dwordx4 v224, s[40:43], s51 offen lds
    s_add_u32 s51, s51, 4096
    s_add_u32 m0, s49, 84992
    s_nop 0
    buffer_load_dwordx4 v224, s[40:43], s51 offen lds
    s_add_u32 s48, s48, 16384
    s_and_b32 s48, s48, 0x1ffff
    s_add_u32 s51, s46, s48
    s_add_u32 m0, s49, 98304
    s_nop 0
    buffer_load_dwordx4 v224, s[40:43], s51 offen lds
    s_add_u32 s51, s51, 4096
    s_add_u32 m0, s49, 99328
    s_nop 0
    buffer_load_dwordx4 v224, s[40:43], s51 offen lds
    s_add_u32 s51, s51, 4096
    s_add_u32 m0, s49, 100352
    s_nop 0
    buffer_load_dwordx4 v224, s[40:43], s51 offen lds
    s_add_u32 s51, s51, 4096
    s_add_u32 m0, s49, 101376
    s_nop 0
    buffer_load_dwordx4 v224, s[40:43], s51 offen lds
    s_add_u32 s48, s48, 16384
    s_and_b32 s48, s48, 0x1ffff
    s_add_u32 s51, s46, s48
    s_add_u32 m0, s49, 114688
    s_nop 0
    buffer_load_dwordx4 v224, s[40:43], s51 offen lds
    s_add_u32 s51, s51, 4096
    s_add_u32 m0, s49, 115712
    s_nop 0
    buffer_load_dwordx4 v224, s[40:43], s51 offen lds
    s_add_u32 s51, s51, 4096
    s_add_u32 m0, s49, 116736
    s_nop 0
    buffer_load_dwordx4 v224, s[40:43], s51 offen lds
    s_add_u32 s51, s51, 4096
    s_add_u32 m0, s49, 117760
    s_nop 0
    buffer_load_dwordx4 v224, s[40:43], s51 offen lds
    s_add_u32 s48, s48, 16384
    s_and_b32 s48, s48, 0x1ffff
    s_waitcnt vmcnt(0)
    s_barrier
    s_cmp_lg_u32 s3, 1
    s_cbranch_scc1 sig4
    s_lshl_b32 s4, s44, 8
    s_add_u32 s4, s4, 7839744
    v_mov_b32 v8, 1
    v_mov_b32 v9, 0
    s_mov_b64 exec, 1
    buffer_atomic_add v8, v9, s[36:39], s4 offen sc0 sc1
    s_waitcnt vmcnt(0)
    v_readfirstlane_b32 s5, v8
    s_mov_b64 exec, -1
    s_cmp_lg_u32 s5, 15
    s_cbranch_scc1 sig4
    s_mov_b32 s4, 7843840
    v_mov_b32 v8, 1
    v_lshlrev_b32 v9, 8, v0
    s_mov_b64 exec, 0xffff
    buffer_atomic_add v8, v9, s[36:39], s4 offen sc1
    s_mov_b64 exec, -1
sig4:
    ds_read_b64_tr_b16 a[0:1], v228 offset:0
    ds_read_b64_tr_b16 a[2:3], v228 offset:2048
    ds_read_b64_tr_b16 a[4:5], v228 offset:4096
    ds_read_b64_tr_b16 a[6:7], v228 offset:6144
    ds_read_b64_tr_b16 a[8:9], v228 offset:8192
    ds_read_b64_tr_b16 a[10:11], v228 offset:10240
    ds_read_b64_tr_b16 a[12:13], v228 offset:12288
    ds_read_b64_tr_b16 a[14:15], v228 offset:14336
    ds_read_b64_tr_b16 a[16:17], v228 offset:16384
    ds_read_b64_tr_b16 a[18:19], v228 offset:18432
    ds_read_b64_tr_b16 a[20:21], v228 offset:20480
    ds_read_b64_tr_b16 a[22:23], v228 offset:22528
    ds_read_b64_tr_b16 a[24:25], v228 offset:24576
    ds_read_b64_tr_b16 a[26:27], v228 offset:26624
    ds_read_b64_tr_b16 a[28:29], v228 offset:28672
    ds_read_b64_tr_b16 a[30:31], v228 offset:30720
    ds_read_b64_tr_b16 a[32:33], v228 offset:32768
    ds_read_b64_tr_b16 a[34:35], v228 offset:34816
    ds_read_b64_tr_b16 a[36:37], v228 offset:36864
    ds_read_b64_tr_b16 a[38:39], v228 offset:38912
    ds_read_b64_tr_b16 a[40:41], v228 offset:40960
    ds_read_b64_tr_b16 a[42:43], v228 offset:43008
    ds_read_b64_tr_b16 a[44:45], v228 offset:45056
    ds_read_b64_tr_b16 a[46:47], v228 offset:47104
    ds_read_b64_tr_b16 a[48:49], v228 offset:49152
    ds_read_b64_tr_b16 a[50:51], v228 offset:51200
    ds_read_b64_tr_b16 a[52:53], v228 offset:53248
    ds_read_b64_tr_b16 a[54:55], v228 offset:55296
    ds_read_b64_tr_b16 a[56:57], v228 offset:57344
    ds_read_b64_tr_b16 a[58:59], v228 offset:59392
    ds_read_b64_tr_b16 a[60:61], v228 offset:61440
    ds_read_b64_tr_b16 a[62:63], v228 offset:63488
    ds_read_b64_tr_b16 a[64:65], v229 offset:0
    ds_read_b64_tr_b16 a[66:67], v229 offset:2048
    ds_read_b64_tr_b16 a[68:69], v229 offset:4096
    ds_read_b64_tr_b16 a[70:71], v229 offset:6144
    ds_read_b64_tr_b16 a[72:73], v229 offset:8192
    ds_read_b64_tr_b16 a[74:75], v229 offset:10240
    ds_read_b64_tr_b16 a[76:77], v229 offset:12288
    ds_read_b64_tr_b16 a[78:79], v229 offset:14336
    ds_read_b64_tr_b16 a[80:81], v229 offset:16384
    ds_read_b64_tr_b16 a[82:83], v229 offset:18432
    ds_read_b64_tr_b16 a[84:85], v229 offset:20480
    ds_read_b64_tr_b16 a[86:87], v229 offset:22528
    ds_read_b64_tr_b16 a[88:89], v229 offset:24576
    ds_read_b64_tr_b16 a[90:91], v229 offset:26624
    ds_read_b64_tr_b16 a[92:93], v229 offset:28672
    ds_read_b64_tr_b16 a[94:95], v229 offset:30720
    ds_read_b64_tr_b16 a[96:97], v229 offset:32768
    ds_read_b64_tr_b16 a[98:99], v229 offset:34816
    ds_read_b64_tr_b16 a[100:101], v229 offset:36864
    ds_read_b64_tr_b16 a[102:103], v229 offset:38912
    ds_read_b64_tr_b16 a[104:105], v229 offset:40960
    ds_read_b64_tr_b16 a[106:107], v229 offset:43008
    ds_read_b64_tr_b16 a[108:109], v229 offset:45056
    ds_read_b64_tr_b16 a[110:111], v229 offset:47104
    ds_read_b64_tr_b16 a[112:113], v229 offset:49152
    ds_read_b64_tr_b16 a[114:115], v229 offset:51200
    ds_read_b64_tr_b16 a[116:117], v229 offset:53248
    ds_read_b64_tr_b16 a[118:119], v229 offset:55296
    ds_read_b64_tr_b16 a[120:121], v229 offset:57344
    ds_read_b64_tr_b16 a[122:123], v229 offset:59392
    ds_read_b64_tr_b16 a[124:125], v229 offset:61440
    ds_read_b64_tr_b16 a[126:127], v229 offset:63488
    s_waitcnt lgkmcnt(0)
    s_mov_b32 s40, s30
    s_mov_b32 s41, s31
    s_mov_b32 s42, 2097152
    s_mov_b32 s43, 0x20000
    s_mul_i32 s48, s45, 229376
    s_add_u32 s48, s48, 2097152
    s_mul_i32 s49, s45, 98304
    s_add_u32 s49, s49, 0
    s_cmp_lg_u32 s3, 0
    s_cbranch_scc1 wt5_done
    s_lshl_b32 s4, s44, 8
    s_add_u32 s4, s4, 7835648
    v_mul_u32_u24 v9, 12288, v0
    s_mov_b64 exec, 3
    s_mov_b32 s5, 0
wt5_loop:
    buffer_load_dword v8, v9, s[36:39], s4 offen sc1
    s_add_u32 s5, s5, 1
    s_waitcnt vmcnt(0)
    v_cmp_gt_u32 vcc, 16, v8
    s_cmp_gt_u32 s5, 0x40000
    s_cbranch_scc1 wt5_out
    s_nop 1
    s_cbranch_vccnz wt5_loop
wt5_out:
    s_mov_b64 exec, -1
wt5_done:
    s_barrier
    s_lshl_b32 s6, s44, 2
    s_lshr_b32 s7, s45, 2
    s_add_u32 s6, s6, s7
    s_and_b32 s7, s45, 3
    s_lshl_b32 s11, s6, 15
    s_lshl_b32 s12, s7, 13
    s_add_u32 s11, s11, s12
    s_lshl_b32 s12, s3, 11
    s_add_u32 s11, s11, s12
    s_add_u32 s12, s11, 9437184
    s_add_u32 s11, s11, 13631488
    buffer_load_dwordx4 v[120:123], v1, s[36:39], s12 offen sc1
    buffer_load_dwordx4 v[124:127], v1, s[36:39], s12 offen offset:1024 sc1
    s_lshl_b32 s13, s7, 2
    s_add_u32 s13, s13, s3
    s_lshl_b32 s13, s13, 14
    s_lshl_b32 s14, s6, 8
    s_add_u32 s13, s13, s14
    s_add_u32 s13, s13, 8912896
    v_min_u32 v7, 16, v2
    v_lshlrev_b32 v7, 5, v7
    v_lshl_add_u32 v7, v3, 4, v7
    s_mul_i32 s8, s3, 8704
    s_add_u32 s8, s8, 7864320
    s_lshl_b32 s9, s6, 15
    s_lshl_b32 s10, s3, 13
    s_add_u32 s9, s9, s10
    s_add_u32 s9, s9, 17825792
    s_lshl_b32 s10, s44, 1
    s_lshr_b32 s12, s45, 2
    s_add_u32 s10, s10, s12
    s_and_b32 s10, s10, 7
    s_mul_i32 s12, s10, 1088
    s_add_u32 s12, s12, s8
    buffer_load_dwordx4 v[16:19], v7, s[36:39], s12 offen sc1
    buffer_load_dwordx4 v[20:23], v7, s[36:39], s12 offen offset:544 sc1
    s_lshl_b32 s14, s10, 10
    s_add_u32 s14, s14, s9
    buffer_load_dwordx4 a[128:131], v1, s[36:39], s14 offen sc1
    s_add_u32 s10, s10, 1
    s_and_b32 s10, s10, 7
    s_mul_i32 s12, s10, 1088
    s_add_u32 s12, s12, s8
    buffer_load_dwordx4 v[24:27], v7, s[36:39], s12 offen sc1
    buffer_load_dwordx4 v[28:31], v7, s[36:39], s12 offen offset:544 sc1
    s_lshl_b32 s14, s10, 10
    s_add_u32 s14, s14, s9
    buffer_load_dwordx4 a[132:135], v1, s[36:39], s14 offen sc1
    s_add_u32 s10, s10, 1
    s_and_b32 s10, s10, 7
    s_mul_i32 s12, s10, 1088
    s_add_u32 s12, s12, s8
    buffer_load_dwordx4 v[32:35], v7, s[36:39], s12 offen sc1
    buffer_load_dwordx4 v[36:39], v7, s[36:39], s12 offen offset:544 sc1
    s_lshl_b32 s14, s10, 10
    s_add_u32 s14, s14, s9
    buffer_load_dwordx4 a[136:139], v1, s[36:39], s14 offen sc1
    s_add_u32 s10, s10, 1
    s_and_b32 s10, s10, 7
    s_mul_i32 s12, s10, 1088
    s_add_u32 s12, s12, s8
    buffer_load_dwordx4 v[40:43], v7, s[36:39], s12 offen sc1
    buffer_load_dwordx4 v[44:47], v7, s[36:39], s12 offen offset:544 sc1
    s_lshl_b32 s14, s10, 10
    s_add_u32 s14, s14, s9
    buffer_load_dwordx4 a[140:143], v1, s[36:39], s14 offen sc1
    s_add_u32 s10, s10, 1
    s_and_b32 s10, s10, 7
    s_mul_i32 s12, s10, 1088
    s_add_u32 s12, s12, s8
    buffer_load_dwordx4 v[48:51], v7, s[36:39], s12 offen sc1
    buffer_load_dwordx4 v[52:55], v7, s[36:39], s12 offen offset:544 sc1
    s_lshl_b32 s14, s10, 10
    s_add_u32 s14, s14, s9
    buffer_load_dwordx4 a[144:147], v1, s[36:39], s14 offen sc1
    s_add_u32 s10, s10, 1
    s_and_b32 s10, s10, 7
    s_mul_i32 s12, s10, 1088
    s_add_u32 s12, s12, s8
    buffer_load_dwordx4 v[56:59], v7, s[36:39], s12 offen sc1
    buffer_load_dwordx4 v[60:63], v7, s[36:39], s12 offen offset:544 sc1
    s_lshl_b32 s14, s10, 10
    s_add_u32 s14, s14, s9
    buffer_load_dwordx4 a[148:151], v1, s[36:39], s14 offen sc1
    s_add_u32 s10, s10, 1
    s_and_b32 s10, s10, 7
    s_lshl_b32 s4, s3, 10
    s_add_u32 s4, s4, 98304
    v_add_u32 v4, s4, v1
    v_add_u32 v6, 98304, v1
    s_waitcnt vmcnt(15)
    s_mul_i32 s12, s10, 1088
    s_add_u32 s12, s12, s8
    buffer_load_dwordx4 v[64:67], v7, s[36:39], s12 offen sc1
    buffer_load_dwordx4 v[68:71], v7, s[36:39], s12 offen offset:544 sc1
    s_lshl_b32 s14, s10, 10
    s_add_u32 s14, s14, s9
    buffer_load_dwordx4 a[152:155], v1, s[36:39], s14 offen sc1
    s_add_u32 s10, s10, 1
    s_and_b32 s10, s10, 7
    v_cvt_pk_bf16_f32 v8, v16, v17
    v_cvt_pk_bf16_f32 v9, v18, v19
    v_cvt_pk_bf16_f32 v10, v20, v21
    v_cvt_pk_bf16_f32 v11, v22, v23
    s_nop 1
    v_mfma_f32_32x32x16_bf16 v[144:159], v[8:11], a[128:131], 0
    s_waitcnt vmcnt(15)
    s_mul_i32 s12, s10, 1088
    s_add_u32 s12, s12, s8
    buffer_load_dwordx4 v[72:75], v7, s[36:39], s12 offen sc1
    buffer_load_dwordx4 v[76:79], v7, s[36:39], s12 offen offset:544 sc1
    s_lshl_b32 s14, s10, 10
    s_add_u32 s14, s14, s9
    buffer_load_dwordx4 a[156:159], v1, s[36:39], s14 offen sc1
    v_cvt_pk_bf16_f32 v12, v24, v25
    v_cvt_pk_bf16_f32 v13, v26, v27
    v_cvt_pk_bf16_f32 v14, v28, v29
    v_cvt_pk_bf16_f32 v15, v30, v31
    s_nop 1
    v_mfma_f32_32x32x16_bf16 v[160:175], v[12:15], a[132:135], 0
    s_waitcnt vmcnt(15)
    v_cvt_pk_bf16_f32 v8, v32, v33
    v_cvt_pk_bf16_f32 v9, v34, v35
    v_cvt_pk_bf16_f32 v10, v36, v37
    v_cvt_pk_bf16_f32 v11, v38, v39
    v_add_f32 v152, 0x358637bd, v152
    v_rcp_f32 v152, v152
    s_nop 0
    v_mul_f32 v144, v144, v152
    v_mul_f32 v145, v145, v152
    v_mul_f32 v146, v146, v152
    v_mul_f32 v147, v147, v152
    v_mul_f32 v148, v148, v152
    v_mul_f32 v149, v149, v152
    v_mul_f32 v150, v150, v152
    v_mul_f32 v151, v151, v152
    v_cvt_pk_bf16_f32 v112, v144, v145
    v_cvt_pk_bf16_f32 v113, v146, v147
    v_cvt_pk_bf16_f32 v114, v148, v149
    v_cvt_pk_bf16_f32 v115, v150, v151
    ds_write_b128 v4, v[112:115] offset:0
    v_mfma_f32_32x32x16_bf16 v[144:159], v[8:11], a[136:139], 0
    s_waitcnt vmcnt(12)
    v_cvt_pk_bf16_f32 v12, v40, v41
    v_cvt_pk_bf16_f32 v13, v42, v43
    v_cvt_pk_bf16_f32 v14, v44, v45
    v_cvt_pk_bf16_f32 v15, v46, v47
    v_add_f32 v168, 0x358637bd, v168
    v_rcp_f32 v168, v168
    s_nop 0
    v_mul_f32 v160, v160, v168
    v_mul_f32 v161, v161, v168
    v_mul_f32 v162, v162, v168
    v_mul_f32 v163, v163, v168
    v_mul_f32 v164, v164, v168
    v_mul_f32 v165, v165, v168
    v_mul_f32 v166, v166, v168
    v_mul_f32 v167, v167, v168
    v_cvt_pk_bf16_f32 v116, v160, v161
    v_cvt_pk_bf16_f32 v117, v162, v163
    v_cvt_pk_bf16_f32 v118, v164, v165
    v_cvt_pk_bf16_f32 v119, v166, v167
    ds_write_b128 v4, v[116:119] offset:4096
    v_mfma_f32_32x32x16_bf16 v[160:175], v[12:15], a[140:143], 0
    s_waitcnt vmcnt(9)
    v_cvt_pk_bf16_f32 v8, v48, v49
    v_cvt_pk_bf16_f32 v9, v50, v51
    v_cvt_pk_bf16_f32 v10, v52, v53
    v_cvt_pk_bf16_f32 v11, v54, v55
    v_add_f32 v152, 0x358637bd, v152
    v_rcp_f32 v152, v152
    s_nop 0
    v_mul_f32 v144, v144, v152
    v_mul_f32 v145, v145, v152
    v_mul_f32 v146, v146, v152
    v_mul_f32 v147, v147, v152
    v_mul_f32 v148, v148, v152
    v_mul_f32 v149, v149, v152
    v_mul_f32 v150, v150, v152
    v_mul_f32 v151, v151, v152
    v_cvt_pk_bf16_f32 v112, v144, v145
    v_cvt_pk_bf16_f32 v113, v146, v147
    v_cvt_pk_bf16_f32 v114, v148, v149
    v_cvt_pk_bf16_f32 v115, v150, v151
    ds_write_b128 v4, v[112:115] offset:8192
    v_mfma_f32_32x32x16_bf16 v[144:159], v[8:11], a[144:147], 0
    s_waitcnt vmcnt(6)
    v_cvt_pk_bf16_f32 v12, v56, v57
    v_cvt_pk_bf16_f32 v13, v58, v59
    v_cvt_pk_bf16_f32 v14, v60, v61
    v_cvt_pk_bf16_f32 v15, v62, v63
    v_add_f32 v168, 0x358637bd, v168
    v_rcp_f32 v168, v168
    s_nop 0
    v_mul_f32 v160, v160, v168
    v_mul_f32 v161, v161, v168
    v_mul_f32 v162, v162, v168
    v_mul_f32 v163, v163, v168
    v_mul_f32 v164, v164, v168
    v_mul_f32 v165, v165, v168
    v_mul_f32 v166, v166, v168
    v_mul_f32 v167, v167, v168
    v_cvt_pk_bf16_f32 v116, v160, v161
    v_cvt_pk_bf16_f32 v117, v162, v163
    v_cvt_pk_bf16_f32 v118, v164, v165
    v_cvt_pk_bf16_f32 v119, v166, v167
    ds_write_b128 v4, v[116:119] offset:12288
    v_mfma_f32_32x32x16_bf16 v[160:175], v[12:15], a[148:151], 0
    s_waitcnt vmcnt(3)
    v_cvt_pk_bf16_f32 v8, v64, v65
    v_cvt_pk_bf16_f32 v9, v66, v67
    v_cvt_pk_bf16_f32 v10, v68, v69
    v_cvt_pk_bf16_f32 v11, v70, v71
    s_waitcnt lgkmcnt(0)
    s_barrier
    ds_read_b128 v[80:83], v6 offset:0
    ds_read_b128 v[84:87], v6 offset:1024
    ds_read_b128 v[88:91], v6 offset:2048
    ds_read_b128 v[92:95], v6 offset:3072
    ds_read_b128 v[96:99], v6 offset:4096
    ds_read_b128 v[100:103], v6 offset:5120
    s_waitcnt lgkmcnt(5)
    v_mfma_f32_32x32x16_bf16 v[128:143], a[0:3], v[80:83], 0
    ds_read_b128 v[104:107], v6 offset:6144
    v_add_f32 v152, 0x358637bd, v152
    v_rcp_f32 v152, v152
    s_nop 0
    v_mul_f32 v144, v144, v152
    s_waitcnt lgkmcnt(5)
    v_mfma_f32_32x32x16_bf16 v[128:143], a[4:7], v[84:87], v[128:143]
    ds_read_b128 v[108:111], v6 offset:7168
    v_mul_f32 v145, v145, v152
    v_mul_f32 v146, v146, v152
    v_mul_f32 v147, v147, v152
    v_mul_f32 v148, v148, v152
    v_mul_f32 v149, v149, v152
    s_waitcnt lgkmcnt(5)
    v_mfma_f32_32x32x16_bf16 v[128:143], a[8:11], v[88:91], v[128:143]
    ds_read_b128 v[80:83], v6 offset:8192
    v_mul_f32 v150, v150, v152
    v_mul_f32 v151, v151, v152
    v_cvt_pk_bf16_f32 v112, v144, v145
    v_cvt_pk_bf16_f32 v113, v146, v147
    v_cvt_pk_bf16_f32 v114, v148, v149
    s_waitcnt lgkmcnt(5)
    v_mfma_f32_32x32x16_bf16 v[128:143], a[12:15], v[92:95], v[128:143]
    ds_read_b128 v[84:87], v6 offset:9216
    v_cvt_pk_bf16_f32 v115, v150, v151
    ds_write_b128 v4, v[112:115] offset:16384
    v_mfma_f32_32x32x16_bf16 v[144:159], v[8:11], a[152:155], 0
    s_waitcnt vmcnt(0)
    v_cvt_pk_bf16_f32 v12, v72, v73
    v_cvt_pk_bf16_f32 v13, v74, v75
    v_cvt_pk_bf16_f32 v14, v76, v77
    v_cvt_pk_bf16_f32 v15, v78, v79
    v_add_f32 v168, 0x358637bd, v168
    s_waitcnt lgkmcnt(6)
    v_mfma_f32_32x32x16_bf16 v[128:143], a[16:19], v[96:99], v[128:143]
    ds_read_b128 v[88:91], v6 offset:10240
    s_lshl_b32 s54, s44, 8
    s_lshl_b32 s4, s3, 5
    s_add_u32 s54, s54, 0
    s_add_u32 s54, s54, 7843840
    buffer_load_dword v221, off, s[36:39], s54 sc1
    s_waitcnt lgkmcnt(6)
    v_mfma_f32_32x32x16_bf16 v[128:143], a[20:23], v[100:103], v[128:143]
    ds_read_b128 v[92:95], v6 offset:11264
    v_rcp_f32 v168, v168
    s_nop 0
    v_mul_f32 v160, v160, v168
    v_mul_f32 v161, v161, v168
    s_waitcnt lgkmcnt(6)
    v_mfma_f32_32x32x16_bf16 v[128:143], a[24:27], v[104:107], v[128:143]
    ds_read_b128 v[96:99], v6 offset:12288
    v_mul_f32 v162, v162, v168
    v_mul_f32 v163, v163, v168
    v_mul_f32 v164, v164, v168
    v_mul_f32 v165, v165, v168
    v_mul_f32 v166, v166, v168
    s_waitcnt lgkmcnt(6)
    v_mfma_f32_32x32x16_bf16 v[128:143], a[28:31], v[108:111], v[128:143]
    ds_read_b128 v[100:103], v6 offset:13312
    v_mul_f32 v167, v167, v168
    v_cvt_pk_bf16_f32 v116, v160, v161
    v_cvt_pk_bf16_f32 v117, v162, v163
    v_cvt_pk_bf16_f32 v118, v164, v165
    v_cvt_pk_bf16_f32 v119, v166, v167
    s_waitcnt lgkmcnt(6)
    v_mfma_f32_32x32x16_bf16 v[128:143], a[32:35], v[80:83], v[128:143]
    ds_read_b128 v[104:107], v6 offset:14336
    ds_write_b128 v4, v[116:119] offset:20480
    v_mfma_f32_32x32x16_bf16 v[160:175], v[12:15], a[156:159], 0
    v_add_f32 v152, 0x358637bd, v152
    v_rcp_f32 v152, v152
    s_nop 0
    v_mul_f32 v144, v144, v152
    v_mul_f32 v145, v145, v152
    s_waitcnt lgkmcnt(7)
    v_mfma_f32_32x32x16_bf16 v[128:143], a[36:39], v[84:87], v[128:143]
    ds_read_b128 v[108:111], v6 offset:15360
    v_mul_f32 v146, v146, v152
    v_mul_f32 v147, v147, v152
    v_mul_f32 v148, v148, v152
    v_mul_f32 v149, v149, v152
    v_mul_f32 v150, v150, v152
    s_waitcnt lgkmcnt(6)
    v_mfma_f32_32x32x16_bf16 v[128:143], a[40:43], v[88:91], v[128:143]
    v_mul_f32 v151, v151, v152
    v_cvt_pk_bf16_f32 v112, v144, v145
    v_cvt_pk_bf16_f32 v113, v146, v147
    v_cvt_pk_bf16_f32 v114, v148, v149
    v_cvt_pk_bf16_f32 v115, v150, v151
    ds_write_b128 v4, v[112:115] offset:24576
    s_waitcnt lgkmcnt(6)
    v_mfma_f32_32x32x16_bf16 v[128:143], a[44:47], v[92:95], v[128:143]
    s_waitcnt lgkmcnt(5)
    v_mfma_f32_32x32x16_bf16 v[128:143], a[48:51], v[96:99], v[128:143]
    v_add_f32 v168, 0x358637bd, v168
    v_rcp_f32 v168, v168
    s_nop 0
    v_mul_f32 v160, v160, v168
    v_mul_f32 v161, v161, v168
    s_waitcnt lgkmcnt(4)
    v_mfma_f32_32x32x16_bf16 v[128:143], a[52:55], v[100:103], v[128:143]
    v_mul_f32 v162, v162, v168
    v_mul_f32 v163, v163, v168
    v_mul_f32 v164, v164, v168
    v_mul_f32 v165, v165, v168
    v_mul_f32 v166, v166, v168
    v_mul_f32 v167, v167, v168
    v_cvt_pk_bf16_f32 v116, v160, v161
    v_cvt_pk_bf16_f32 v117, v162, v163
    v_cvt_pk_bf16_f32 v118, v164, v165
    v_cvt_pk_bf16_f32 v119, v166, v167
    ds_write_b128 v4, v[116:119] offset:28672
    s_waitcnt lgkmcnt(0)
    s_barrier
    ds_read_b128 v[80:83], v6 offset:16384
    ds_read_b128 v[84:87], v6 offset:17408
    ds_read_b128 v[88:91], v6 offset:18432
    ds_read_b128 v[92:95], v6 offset:19456
    s_waitcnt vmcnt(0)
    v_readfirstlane_b32 s4, v221
    s_mov_b32 s5, 0
    s_cmp_ge_u32 s4, 16
    s_cbranch_scc1 pc6_ok
pc6_loop:
    buffer_load_dword v221, off, s[36:39], s54 sc1
    s_add_u32 s5, s5, 1
    s_waitcnt vmcnt(0)
    v_readfirstlane_b32 s4, v221
    s_cmp_gt_u32 s5, 0x40000
    s_cbranch_scc1 pc6_ok
    s_cmp_lt_u32 s4, 16
    s_cbranch_scc1 pc6_loop
pc6_ok:
    v_mfma_f32_32x32x16_bf16 v[128:143], a[56:59], v[104:107], v[128:143]
    ds_read_b128 v[96:99], v6 offset:20480
    s_mul_i32 s9, s45, 896
    s_lshl_b32 s10, s3, 8
    s_add_u32 s9, s9, s10
    s_add_u32 s9, s9, 7667712
    v_lshlrev_b32 v220, 2, v0
    buffer_load_dword v64, v220, s[36:39], s9 offen sc1
    s_add_u32 s9, s9, 14336
    buffer_load_dword v65, v220, s[36:39], s9 offen sc1
    s_add_u32 s9, s9, 14336
    buffer_load_dword v66, v220, s[36:39], s9 offen sc1
    s_add_u32 s9, s9, 14336
    buffer_load_dword v67, v220, s[36:39], s9 offen sc1
    s_add_u32 s9, s9, 14336
    buffer_load_dword v68, v220, s[36:39], s9 offen sc1
    s_add_u32 s9, s9, 14336
    buffer_load_dword v69, v220, s[36:39], s9 offen sc1
    s_add_u32 s9, s9, 14336
    buffer_load_dword v70, v220, s[36:39], s9 offen sc1
    s_add_u32 s9, s9, 14336
    buffer_load_dword v71, v220, s[36:39], s9 offen sc1
    s_mul_i32 s9, s45, 384
    s_and_b32 s10, s3, 1
    s_lshl_b32 s10, s10, 8
    s_add_u32 s9, s9, s10
    s_add_u32 s9, s9, 7602176
    v_lshlrev_b32 v220, 2, v0
    buffer_load_dword v72, v220, s[36:39], s9 offen sc1
    s_add_u32 s9, s9, 6144
    buffer_load_dword v73, v220, s[36:39], s9 offen sc1
    s_add_u32 s9, s9, 6144
    buffer_load_dword v74, v220, s[36:39], s9 offen sc1
    s_add_u32 s9, s9, 6144
    buffer_load_dword v75, v220, s[36:39], s9 offen sc1
    s_add_u32 s9, s9, 6144
    buffer_load_dword v76, v220, s[36:39], s9 offen sc1
    s_add_u32 s9, s9, 6144
    buffer_load_dword v77, v220, s[36:39], s9 offen sc1
    s_add_u32 s9, s9, 6144
    buffer_load_dword v78, v220, s[36:39], s9 offen sc1
    s_add_u32 s9, s9, 6144
    buffer_load_dword v79, v220, s[36:39], s9 offen sc1
    v_mfma_f32_32x32x16_bf16 v[128:143], a[60:63], v[108:111], v[128:143]
    ds_read_b128 v[100:103], v6 offset:21504
    s_waitcnt lgkmcnt(5)
    v_mfma_f32_32x32x16_bf16 v[128:143], a[64:67], v[80:83], v[128:143]
    ds_read_b128 v[104:107], v6 offset:22528
    s_add_u32 s51, s48, s50
    s_add_u32 s51, s51, 0
    s_add_u32 m0, s50, 0
    s_nop 0
    buffer_load_dwordx4 v1, s[36:39], s51 offen sc1 lds
    s_waitcnt lgkmcnt(5)
    v_mfma_f32_32x32x16_bf16 v[128:143], a[68:71], v[84:87], v[128:143]
    ds_read_b128 v[108:111], v6 offset:23552
    buffer_load_dwordx4 v1, s[36:39], s51 offen offset:1024 sc1 lds
    s_waitcnt lgkmcnt(5)
    v_mfma_f32_32x32x16_bf16 v[128:143], a[72:75], v[88:91], v[128:143]
    ds_read_b128 v[80:83], v6 offset:24576
    s_waitcnt lgkmcnt(5)
    v_mfma_f32_32x32x16_bf16 v[128:143], a[76:79], v[92:95], v[128:143]
    ds_read_b128 v[84:87], v6 offset:25600
    buffer_load_dwordx4 v1, s[36:39], s51 offen offset:2048 sc1 lds
    s_waitcnt lgkmcnt(5)
    v_mfma_f32_32x32x16_bf16 v[128:143], a[80:83], v[96:99], v[128:143]
    ds_read_b128 v[88:91], v6 offset:26624
    buffer_load_dwordx4 v1, s[36:39], s51 offen offset:3072 sc1 lds
    s_waitcnt lgkmcnt(5)
    v_mfma_f32_32x32x16_bf16 v[128:143], a[84:87], v[100:103], v[128:143]
    ds_read_b128 v[92:95], v6 offset:27648
    s_waitcnt lgkmcnt(5)
    v_mfma_f32_32x32x16_bf16 v[128:143], a[88:91], v[104:107], v[128:143]
    ds_read_b128 v[96:99], v6 offset:28672
    s_add_u32 s51, s48, s50
    s_add_u32 s51, s51, 16384
    s_add_u32 m0, s50, 16384
    s_nop 0
    buffer_load_dwordx4 v1, s[36:39], s51 offen sc1 lds
    s_waitcnt lgkmcnt(5)
    v_mfma_f32_32x32x16_bf16 v[128:143], a[92:95], v[108:111], v[128:143]
    ds_read_b128 v[100:103], v6 offset:29696
    buffer_load_dwordx4 v1, s[36:39], s51 offen offset:1024 sc1 lds
    s_waitcnt lgkmcnt(5)
    v_mfma_f32_32x32x16_bf16 v[128:143], a[96:99], v[80:83], v[128:143]
    ds_read_b128 v[104:107], v6 offset:30720
    s_waitcnt lgkmcnt(5)
    v_mfma_f32_32x32x16_bf16 v[128:143], a[100:103], v[84:87], v[128:143]
    ds_read_b128 v[108:111], v6 offset:31744
    buffer_load_dwordx4 v1, s[36:39], s51 offen offset:2048 sc1 lds
    s_waitcnt lgkmcnt(5)
    v_mfma_f32_32x32x16_bf16 v[128:143], a[104:107], v[88:91], v[128:143]
    buffer_load_dwordx4 v1, s[36:39], s51 offen offset:3072 sc1 lds
    s_waitcnt lgkmcnt(4)
    v_mfma_f32_32x32x16_bf16 v[128:143], a[108:111], v[92:95], v[128:143]
    s_waitcnt lgkmcnt(3)
    v_mfma_f32_32x32x16_bf16 v[128:143], a[112:115], v[96:99], v[128:143]
    s_add_u32 s51, s48, s50
    s_add_u32 s51, s51, 32768
    s_add_u32 m0, s50, 32768
    s_nop 0
    buffer_load_dwordx4 v1, s[36:39], s51 offen sc1 lds
    s_waitcnt lgkmcnt(2)
    v_mfma_f32_32x32x16_bf16 v[128:143], a[116:119], v[100:103], v[128:143]
    buffer_load_dwordx4 v1, s[36:39], s51 offen offset:1024 sc1 lds
    s_waitcnt lgkmcnt(1)
    v_mfma_f32_32x32x16_bf16 v[128:143], a[120:123], v[104:107], v[128:143]
    s_waitcnt lgkmcnt(0)
    v_mfma_f32_32x32x16_bf16 v[128:143], a[124:127], v[108:111], v[128:143]
    buffer_load_dwordx4 v1, s[36:39], s51 offen offset:2048 sc1 lds
    buffer_load_dwordx4 v1, s[36:39], s51 offen offset:3072 sc1 lds
    s_and_b32 s4, s45, 7
    s_mul_i32 s47, s4, 229376
    s_mul_i32 s4, s3, 57344
    s_add_u32 s47, s47, s4
    s_add_u32 s58, s47, 5767168
    s_and_b32 s59, s44, 0
    s_and_b32 s4, s45, 0
    s_add_u32 s4, s4, s59
    s_mul_i32 s60, s4, 11
    s_lshr_b32 s60, s60, 5
    s_mul_i32 s60, s60, 3
    s_sub_u32 s60, s4, s60
    s_lshl_b32 s59, s59, 13
    s_lshl_b32 s4, s60, 13
    s_add_u32 s4, s4, 0x8000
    s_add_u32 s47, s58, s59
    s_and_b32 s4, s3, 1
    s_lshl_b32 s4, s4, 10
    v_add_u32 v14, s4, v1
    v_xor_b32 v15, 0x400, v14
    v_lshlrev_b32 v8, 16, v120
    v_and_b32 v9, 0xffff0000, v120
    v_add_f32 v128, v128, v8
    v_add_f32 v129, v129, v9
    v_cvt_pk_bf16_f32 v120, v128, v129
    v_lshlrev_b32 v8, 16, v121
    v_and_b32 v9, 0xffff0000, v121
    v_add_f32 v130, v130, v8
    v_add_f32 v131, v131, v9
    v_cvt_pk_bf16_f32 v121, v130, v131
    v_lshlrev_b32 v8, 16, v122
    v_and_b32 v9, 0xffff0000, v122
    v_add_f32 v132, v132, v8
    v_add_f32 v133, v133, v9
    v_cvt_pk_bf16_f32 v122, v132, v133
    v_lshlrev_b32 v8, 16, v123
    v_and_b32 v9, 0xffff0000, v123
    v_add_f32 v134, v134, v8
    v_add_f32 v135, v135, v9
    v_cvt_pk_bf16_f32 v123, v134, v135
    v_lshlrev_b32 v8, 16, v124
    v_and_b32 v9, 0xffff0000, v124
    v_add_f32 v136, v136, v8
    v_add_f32 v137, v137, v9
    v_cvt_pk_bf16_f32 v124, v136, v137
    v_lshlrev_b32 v8, 16, v125
    v_and_b32 v9, 0xffff0000, v125
    v_add_f32 v138, v138, v8
    v_add_f32 v139, v139, v9
    v_cvt_pk_bf16_f32 v125, v138, v139
    v_lshlrev_b32 v8, 16, v126
    v_and_b32 v9, 0xffff0000, v126
    v_add_f32 v140, v140, v8
    v_add_f32 v141, v141, v9
    v_cvt_pk_bf16_f32 v126, v140, v141
    v_lshlrev_b32 v8, 16, v127
    v_and_b32 v9, 0xffff0000, v127
    v_add_f32 v142, v142, v8
    v_add_f32 v143, v143, v9
    v_cvt_pk_bf16_f32 v127, v142, v143
    buffer_store_dwordx4 v[120:123], v1, s[36:39], s11 offen sc1
    buffer_store_dwordx4 v[124:127], v1, s[36:39], s11 offen offset:1024 sc1
    v_mov_b32 v8, 0
    v_mov_b32 v9, 0
    v_mov_b32 v10, 0x3f803f80
    v_dot2_f32_bf16 v8, v120, v10, v8
    v_dot2_f32_bf16 v9, v120, v120, v9
    v_dot2_f32_bf16 v8, v121, v10, v8
    v_dot2_f32_bf16 v9, v121, v121, v9
    v_dot2_f32_bf16 v8, v122, v10, v8
    v_dot2_f32_bf16 v9, v122, v122, v9
    v_dot2_f32_bf16 v8, v123, v10, v8
    v_dot2_f32_bf16 v9, v123, v123, v9
    v_dot2_f32_bf16 v8, v124, v10, v8
    v_dot2_f32_bf16 v9, v124, v124, v9
    v_dot2_f32_bf16 v8, v125, v10, v8
    v_dot2_f32_bf16 v9, v125, v125, v9
    v_dot2_f32_bf16 v8, v126, v10, v8
    v_dot2_f32_bf16 v9, v126, v126, v9
    v_dot2_f32_bf16 v8, v127, v10, v8
    v_dot2_f32_bf16 v9, v127, v127, v9
    s_nop 1
    v_mov_b32 v10, v8
    v_mov_b32 v11, v8
    s_nop 1
    v_permlane32_swap_b32 v10, v11
    v_add_f32 v8, v10, v11
    v_mov_b32 v10, v9
    v_mov_b32 v11, v9
    s_nop 1
    v_permlane32_swap_b32 v10, v11
    v_add_f32 v9, v10, v11
    v_lshlrev_b32 v10, 3, v2
    s_mov_b32 exec_hi, 0
    buffer_store_dwordx2 v[8:9], v10, s[36:39], s13 offen sc1
    s_mov_b64 exec, -1
    s_waitcnt vmcnt(15)
    v_add_f32 v64, v64, v68
    v_add_f32 v65, v65, v69
    v_add_f32 v66, v66, v70
    v_add_f32 v67, v67, v71
    v_add_f32 v64, v64, v66
    v_add_f32 v65, v65, v67
    v_add_f32 v64, v64, v65
    v_add_f32 v72, v72, v76
    v_add_f32 v73, v73, v77
    v_add_f32 v74, v74, v78
    v_add_f32 v75, v75, v79
    v_add_f32 v72, v72, v74
    v_add_f32 v73, v73, v75
    v_add_f32 v72, v72, v73
    v_cvt_pk_bf16_f32 v67, v64, 0
    s_and_b32 s9, s3, 3
    s_lshl_b32 s9, s9, 9
    v_lshlrev_b32 v65, 16, v67
    v_sub_f32 v65, v64, v65
    s_add_u32 s9, s9, 147456
    v_cvt_pk_bf16_f32 v66, v64, v65
    v_lshl_add_u32 v4, v0, 3, s9
    ds_write_b64 v4, v[66:67]
    v_cvt_pk_bf16_f32 v75, v72, 0
    s_and_b32 s9, s3, 1
    s_lshl_b32 s9, s9, 9
    v_lshlrev_b32 v73, 16, v75
    v_sub_f32 v73, v72, v73
    s_add_u32 s9, s9, 149504
    v_cvt_pk_bf16_f32 v74, v72, v73
    v_lshl_add_u32 v4, v0, 3, s9
    ds_write_b64 v4, v[74:75]
    s_waitcnt lgkmcnt(0)
    s_waitcnt vmcnt(0)
    s_barrier
    s_cmp_lg_u32 s3, 0
    s_cbranch_scc1 sig7
    s_lshl_b32 s4, s44, 8
    s_add_u32 s4, s4, 7798784
    v_mov_b32 v8, 1
    v_mov_b32 v9, 0
    s_mov_b64 exec, 1
    buffer_atomic_add v8, v9, s[36:39], s4 offen sc1
    s_mov_b64 exec, -1
sig7:
    s_sub_u32 s4, s3, 1
    s_cmp_ge_u32 s4, 3
    s_cbranch_scc1 bys8
    s_lshl_b32 s4, s4, 14
    s_add_u32 s51, s48, s4
    s_add_u32 s51, s51, 49152
    s_add_u32 s4, s4, 49152
    s_mov_b32 m0, s4
    s_nop 0
    buffer_load_dwordx4 v1, s[36:39], s51 offen offset:0 sc1 lds
    buffer_load_dwordx4 v1, s[36:39], s51 offen offset:1024 sc1 lds
    buffer_load_dwordx4 v1, s[36:39], s51 offen offset:2048 sc1 lds
    buffer_load_dwordx4 v1, s[36:39], s51 offen offset:3072 sc1 lds
    s_add_u32 s51, s51, 4096
    s_add_u32 s4, s4, 4096
    s_mov_b32 m0, s4
    s_nop 0
    buffer_load_dwordx4 v1, s[36:39], s51 offen offset:0 sc1 lds
    buffer_load_dwordx4 v1, s[36:39], s51 offen offset:1024 sc1 lds
    buffer_load_dwordx4 v1, s[36:39], s51 offen offset:2048 sc1 lds
    buffer_load_dwordx4 v1, s[36:39], s51 offen offset:3072 sc1 lds
    s_add_u32 s51, s51, 4096
    s_add_u32 s4, s4, 4096
    s_mov_b32 m0, s4
    s_nop 0
    buffer_load_dwordx4 v1, s[36:39], s51 offen offset:0 sc1 lds
    buffer_load_dwordx4 v1, s[36:39], s51 offen offset:1024 sc1 lds
    buffer_load_dwordx4 v1, s[36:39], s51 offen offset:2048 sc1 lds
    buffer_load_dwordx4 v1, s[36:39], s51 offen offset:3072 sc1 lds
    s_add_u32 s51, s51, 4096
    s_add_u32 s4, s4, 4096
    s_mov_b32 m0, s4
    s_nop 0
    buffer_load_dwordx4 v1, s[36:39], s51 offen offset:0 sc1 lds
    buffer_load_dwordx4 v1, s[36:39], s51 offen offset:1024 sc1 lds
    buffer_load_dwordx4 v1, s[36:39], s51 offen offset:2048 sc1 lds
    buffer_load_dwordx4 v1, s[36:39], s51 offen offset:3072 sc1 lds
bys8:
    s_cmp_lg_u32 s3, 0
    s_cbranch_scc1 wt9_done
    s_lshl_b32 s4, s44, 8
    s_add_u32 s4, s4, 7798784
    v_mov_b32 v9, 0
    s_mov_b64 exec, 1
    s_mov_b32 s5, 0
wt9_loop:
    buffer_load_dword v8, v9, s[36:39], s4 offen sc1
    s_add_u32 s5, s5, 1
    s_waitcnt vmcnt(0)
    v_cmp_gt_u32 vcc, 16, v8
    s_cmp_gt_u32 s5, 0x40000
    s_cbranch_scc1 wt9_out
    s_nop 1
    s_cbranch_vccnz wt9_loop
wt9_out:
    s_mov_b64 exec, -1
wt9_done:
    s_barrier
    s_lshl_b32 s8, s44, 2
    s_add_u32 s8, s8, s3
    s_lshl_b32 s12, s8, 15
    s_add_u32 s12, s12, 13631488
    s_and_b32 s15, s45, 7
    s_lshl_b32 s15, s15, 12
    s_add_u32 s10, s12, s15
    buffer_load_dwordx4 a[0:3], v1, s[36:39], s10 offen offset:0 sc1
    buffer_load_dwordx4 a[4:7], v1, s[36:39], s10 offen offset:1024 sc1
    buffer_load_dwordx4 a[8:11], v1, s[36:39], s10 offen offset:2048 sc1
    buffer_load_dwordx4 a[12:15], v1, s[36:39], s10 offen offset:3072 sc1
    s_add_u32 s15, s15, 4096
    s_and_b32 s15, s15, 0x7fff
    s_add_u32 s10, s12, s15
    buffer_load_dwordx4 a[16:19], v1, s[36:39], s10 offen offset:0 sc1
    buffer_load_dwordx4 a[20:23], v1, s[36:39], s10 offen offset:1024 sc1
    buffer_load_dwordx4 a[24:27], v1, s[36:39], s10 offen offset:2048 sc1
    buffer_load_dwordx4 a[28:31], v1, s[36:39], s10 offen offset:3072 sc1
    s_add_u32 s15, s15, 4096
    s_and_b32 s15, s15, 0x7fff
    s_add_u32 s10, s12, s15
    buffer_load_dwordx4 a[32:35], v1, s[36:39], s10 offen offset:0 sc1
    buffer_load_dwordx4 a[36:39], v1, s[36:39], s10 offen offset:1024 sc1
    buffer_load_dwordx4 a[40:43], v1, s[36:39], s10 offen offset:2048 sc1
    v_lshlrev_b32 v9, 3, v2
    v_add_u32 v9, 147456, v9
    s_mul_i32 s13, s8, 114688
    s_lshr_b32 s14, s45, 2
    s_mul_i32 s14, s14, 28672
    s_add_u32 s13, s13, s14
    s_and_b32 s14, s45, 3
    s_lshl_b32 s14, s14, 10
    s_add_u32 s13, s13, s14
    s_add_u32 s61, s13, 22020096
    s_waitcnt vmcnt(10)
    s_barrier
    ds_read_b128 a[128:131], v1 offset:0
    ds_read_b128 a[132:135], v1 offset:1024
    ds_read_b128 a[136:139], v1 offset:2048
    ds_read_b128 a[140:143], v1 offset:3072
    ds_read_b128 a[144:147], v1 offset:4096
    ds_read_b128 a[148:151], v1 offset:5120
    ds_read_b128 a[152:155], v1 offset:6144
    s_waitcnt lgkmcnt(3)
    v_mfma_f32_32x32x16_bf16 v[64:79], a[128:131], a[0:3], 0
    ds_read_b128 a[156:159], v1 offset:7168
    buffer_load_dwordx4 a[44:47], v1, s[36:39], s10 offen offset:3072 sc1
    s_add_u32 s15, s15, 4096
    s_and_b32 s15, s15, 0x7fff
    s_add_u32 s10, s12, s15
    v_mfma_f32_32x32x16_bf16 v[80:95], a[132:135], a[0:3], 0
    ds_read_b128 a[128:131], v1 offset:8192
    s_waitcnt vmcnt(10)
    v_mfma_f32_32x32x16_bf16 v[64:79], a[136:139], a[4:7], v[64:79]
    ds_read_b128 a[132:135], v1 offset:9216
    buffer_load_dwordx4 a[48:51], v1, s[36:39], s10 offen offset:0 sc1
    v_mfma_f32_32x32x16_bf16 v[80:95], a[140:143], a[4:7], v[80:95]
    ds_read_b128 a[136:139], v1 offset:10240
    s_waitcnt lgkmcnt(3)
    s_waitcnt vmcnt(10)
    v_mfma_f32_32x32x16_bf16 v[64:79], a[144:147], a[8:11], v[64:79]
    ds_read_b128 a[140:143], v1 offset:11264
    buffer_load_dwordx4 a[52:55], v1, s[36:39], s10 offen offset:1024 sc1
    v_lshlrev_b32 v4, 17, v3
    v_lshl_add_u32 v4, v2, 3, v4
    s_lshl_b32 s9, s8, 8
    s_add_u32 s9, s9, 8912896
    buffer_load_dwordx2 v[16:17], v4, s[36:39], s9 offen sc1
    s_add_u32 s9, s9, 16384
    buffer_load_dwordx2 v[18:19], v4, s[36:39], s9 offen sc1
    s_add_u32 s9, s9, 16384
    v_mfma_f32_32x32x16_bf16 v[80:95], a[148:151], a[8:11], v[80:95]
    ds_read_b128 a[144:147], v1 offset:12288
    s_waitcnt vmcnt(12)
    v_mfma_f32_32x32x16_bf16 v[64:79], a[152:155], a[12:15], v[64:79]
    ds_read_b128 a[148:151], v1 offset:13312
    buffer_load_dwordx4 a[56:59], v1, s[36:39], s10 offen offset:2048 sc1
    v_mfma_f32_32x32x16_bf16 v[80:95], a[156:159], a[12:15], v[80:95]
    ds_read_b128 a[152:155], v1 offset:14336
    s_waitcnt lgkmcnt(3)
    s_waitcnt vmcnt(12)
    v_mfma_f32_32x32x16_bf16 v[64:79], a[128:131], a[16:19], v[64:79]
    ds_read_b128 a[156:159], v1 offset:15360
    buffer_load_dwordx4 a[60:63], v1, s[36:39], s10 offen offset:3072 sc1
    s_add_u32 s15, s15, 4096
    s_and_b32 s15, s15, 0x7fff
    s_add_u32 s10, s12, s15
    buffer_load_dwordx2 v[20:21], v4, s[36:39], s9 offen sc1
    s_add_u32 s9, s9, 16384
    buffer_load_dwordx2 v[22:23], v4, s[36:39], s9 offen sc1
    s_add_u32 s9, s9, 16384
    v_mfma_f32_32x32x16_bf16 v[80:95], a[132:135], a[16:19], v[80:95]
    ds_read_b128 a[128:131], v1 offset:16384
    s_waitcnt vmcnt(14)
    v_mfma_f32_32x32x16_bf16 v[64:79], a[136:139], a[20:23], v[64:79]
    ds_read_b128 a[132:135], v1 offset:17408
    buffer_load_dwordx4 a[64:67], v1, s[36:39], s10 offen offset:0 sc1
    v_mfma_f32_32x32x16_bf16 v[80:95], a[140:143], a[20:23], v[80:95]
    ds_read_b128 a[136:139], v1 offset:18432
    s_waitcnt lgkmcnt(3)
    s_waitcnt vmcnt(14)
    v_mfma_f32_32x32x16_bf16 v[64:79], a[144:147], a[24:27], v[64:79]
    ds_read_b128 a[140:143], v1 offset:19456
    buffer_load_dwordx4 a[68:71], v1, s[36:39], s10 offen offset:1024 sc1
    buffer_load_dwordx2 v[24:25], v4, s[36:39], s9 offen sc1
    s_add_u32 s9, s9, 16384
    buffer_load_dwordx2 v[26:27], v4, s[36:39], s9 offen sc1
    s_add_u32 s9, s9, 16384
    v_mfma_f32_32x32x16_bf16 v[80:95], a[148:151], a[24:27], v[80:95]
    ds_read_b128 a[144:147], v1 offset:20480
    s_waitcnt vmcnt(16)
    v_mfma_f32_32x32x16_bf16 v[64:79], a[152:155], a[28:31], v[64:79]
    ds_read_b128 a[148:151], v1 offset:21504
    buffer_load_dwordx4 a[72:75], v1, s[36:39], s10 offen offset:2048 sc1
    v_mfma_f32_32x32x16_bf16 v[80:95], a[156:159], a[28:31], v[80:95]
    ds_read_b128 a[152:155], v1 offset:22528
    s_waitcnt lgkmcnt(3)
    s_waitcnt vmcnt(16)
    v_mfma_f32_32x32x16_bf16 v[64:79], a[128:131], a[32:35], v[64:79]
    ds_read_b128 a[156:159], v1 offset:23552
    buffer_load_dwordx4 a[76:79], v1, s[36:39], s10 offen offset:3072 sc1
    s_add_u32 s15, s15, 4096
    s_and_b32 s15, s15, 0x7fff
    s_add_u32 s10, s12, s15
    buffer_load_dwordx2 v[28:29], v4, s[36:39], s9 offen sc1
    s_add_u32 s9, s9, 16384
    buffer_load_dwordx2 v[30:31], v4, s[36:39], s9 offen sc1
    v_mfma_f32_32x32x16_bf16 v[80:95], a[132:135], a[32:35], v[80:95]
    ds_read_b128 a[128:131], v1 offset:24576
    s_waitcnt vmcnt(18)
    v_mfma_f32_32x32x16_bf16 v[64:79], a[136:139], a[36:39], v[64:79]
    ds_read_b128 a[132:135], v1 offset:25600
    buffer_load_dwordx4 a[80:83], v1, s[36:39], s10 offen offset:0 sc1
    v_mfma_f32_32x32x16_bf16 v[80:95], a[140:143], a[36:39], v[80:95]
    ds_read_b128 a[136:139], v1 offset:26624
    s_waitcnt lgkmcnt(3)
    s_waitcnt vmcnt(18)
    v_mfma_f32_32x32x16_bf16 v[64:79], a[144:147], a[40:43], v[64:79]
    ds_read_b128 a[140:143], v1 offset:27648
    buffer_load_dwordx4 a[84:87], v1, s[36:39], s10 offen offset:1024 sc1
    v_mfma_f32_32x32x16_bf16 v[80:95], a[148:151], a[40:43], v[80:95]
    ds_read_b128 a[144:147], v1 offset:28672
    s_waitcnt vmcnt(18)
    v_mfma_f32_32x32x16_bf16 v[64:79], a[152:155], a[44:47], v[64:79]
    ds_read_b128 a[148:151], v1 offset:29696
    buffer_load_dwordx4 a[88:91], v1, s[36:39], s10 offen offset:2048 sc1
    v_mfma_f32_32x32x16_bf16 v[80:95], a[156:159], a[44:47], v[80:95]
    ds_read_b128 a[152:155], v1 offset:30720
    s_waitcnt lgkmcnt(3)
    s_waitcnt vmcnt(18)
    v_mfma_f32_32x32x16_bf16 v[64:79], a[128:131], a[48:51], v[64:79]
    ds_read_b128 a[156:159], v1 offset:31744
    buffer_load_dwordx4 a[92:95], v1, s[36:39], s10 offen offset:3072 sc1
    s_add_u32 s15, s15, 4096
    s_and_b32 s15, s15, 0x7fff
    s_add_u32 s10, s12, s15
    v_mfma_f32_32x32x16_bf16 v[80:95], a[132:135], a[48:51], v[80:95]
    s_barrier
    ds_read_b128 a[128:131], v1 offset:32768
    s_waitcnt vmcnt(18)
    v_mfma_f32_32x32x16_bf16 v[64:79], a[136:139], a[52:55], v[64:79]
    ds_read_b128 a[132:135], v1 offset:33792
    buffer_load_dwordx4 a[96:99], v1, s[36:39], s10 offen offset:0 sc1
    v_mfma_f32_32x32x16_bf16 v[80:95], a[140:143], a[52:55], v[80:95]
    ds_read_b128 a[136:139], v1 offset:34816
    s_waitcnt lgkmcnt(3)
    s_waitcnt vmcnt(16)
    v_mfma_f32_32x32x16_bf16 v[64:79], a[144:147], a[56:59], v[64:79]
    ds_read_b128 a[140:143], v1 offset:35840
    buffer_load_dwordx4 a[100:103], v1, s[36:39], s10 offen offset:1024 sc1
    v_mfma_f32_32x32x16_bf16 v[80:95], a[148:151], a[56:59], v[80:95]
    ds_read_b128 a[144:147], v1 offset:36864
    s_waitcnt vmcnt(16)
    v_mfma_f32_32x32x16_bf16 v[64:79], a[152:155], a[60:63], v[64:79]
    ds_read_b128 a[148:151], v1 offset:37888
    buffer_load_dwordx4 a[104:107], v1, s[36:39], s10 offen offset:2048 sc1
    v_mfma_f32_32x32x16_bf16 v[80:95], a[156:159], a[60:63], v[80:95]
    ds_read_b128 a[152:155], v1 offset:38912
    s_waitcnt lgkmcnt(3)
    s_waitcnt vmcnt(14)
    v_mfma_f32_32x32x16_bf16 v[64:79], a[128:131], a[64:67], v[64:79]
    ds_read_b128 a[156:159], v1 offset:39936
    buffer_load_dwordx4 a[108:111], v1, s[36:39], s10 offen offset:3072 sc1
    s_add_u32 s15, s15, 4096
    s_and_b32 s15, s15, 0x7fff
    s_add_u32 s10, s12, s15
    v_mfma_f32_32x32x16_bf16 v[80:95], a[132:135], a[64:67], v[80:95]
    ds_read_b128 a[128:131], v1 offset:40960
    s_waitcnt vmcnt(14)
    v_mfma_f32_32x32x16_bf16 v[64:79], a[136:139], a[68:71], v[64:79]
    ds_read_b128 a[132:135], v1 offset:41984
    buffer_load_dwordx4 a[112:115], v1, s[36:39], s10 offen offset:0 sc1
    v_mfma_f32_32x32x16_bf16 v[80:95], a[140:143], a[68:71], v[80:95]
    ds_read_b128 a[136:139], v1 offset:43008
    s_waitcnt lgkmcnt(3)
    s_waitcnt vmcnt(12)
    v_mfma_f32_32x32x16_bf16 v[64:79], a[144:147], a[72:75], v[64:79]
    ds_read_b128 a[140:143], v1 offset:44032
    buffer_load_dwordx4 a[116:119], v1, s[36:39], s10 offen offset:1024 sc1
    v_mfma_f32_32x32x16_bf16 v[80:95], a[148:151], a[72:75], v[80:95]
    ds_read_b128 a[144:147], v1 offset:45056
    s_waitcnt vmcnt(12)
    v_mfma_f32_32x32x16_bf16 v[64:79], a[152:155], a[76:79], v[64:79]
    ds_read_b128 a[148:151], v1 offset:46080
    buffer_load_dwordx4 a[120:123], v1, s[36:39], s10 offen offset:2048 sc1
    v_mfma_f32_32x32x16_bf16 v[80:95], a[156:159], a[76:79], v[80:95]
    ds_read_b128 a[152:155], v1 offset:47104
    s_waitcnt lgkmcnt(3)
    s_waitcnt vmcnt(10)
    v_mfma_f32_32x32x16_bf16 v[64:79], a[128:131], a[80:83], v[64:79]
    ds_read_b128 a[156:159], v1 offset:48128
    buffer_load_dwordx4 a[124:127], v1, s[36:39], s10 offen offset:3072 sc1
    v_add_f32 v16, v16, v24
    v_add_f32 v17, v17, v25
    v_mfma_f32_32x32x16_bf16 v[80:95], a[132:135], a[80:83], v[80:95]
    s_barrier
    ds_read_b128 a[128:131], v1 offset:49152
    v_add_f32 v18, v18, v26
    v_add_f32 v19, v19, v27
    v_add_f32 v20, v20, v28
    v_add_f32 v21, v21, v29
    s_waitcnt vmcnt(10)
    v_mfma_f32_32x32x16_bf16 v[64:79], a[136:139], a[84:87], v[64:79]
    ds_read_b128 a[132:135], v1 offset:50176
    v_add_f32 v22, v22, v30
    v_add_f32 v23, v23, v31
    v_add_f32 v16, v16, v20
    v_add_f32 v17, v17, v21
    v_add_f32 v18, v18, v22
    v_mfma_f32_32x32x16_bf16 v[80:95], a[140:143], a[84:87], v[80:95]
    ds_read_b128 a[136:139], v1 offset:51200
    s_add_u32 s51, s48, s50
    s_add_u32 s51, s51, 98304
    s_add_u32 m0, s50, 98304
    s_nop 0
    buffer_load_dwordx4 v1, s[36:39], s51 offen sc1 lds
    s_waitcnt lgkmcnt(3)
    s_waitcnt vmcnt(10)
    v_mfma_f32_32x32x16_bf16 v[64:79], a[144:147], a[88:91], v[64:79]
    ds_read_b128 a[140:143], v1 offset:52224
    v_add_f32 v19, v19, v23
    v_add_f32 v16, v16, v18
    v_add_f32 v17, v17, v19
    v_mov_b32 v8, v16
    v_mov_b32 v4, v16
    v_mfma_f32_32x32x16_bf16 v[80:95], a[148:151], a[88:91], v[80:95]
    ds_read_b128 a[144:147], v1 offset:53248
    buffer_load_dwordx4 v1, s[36:39], s51 offen offset:1024 sc1 lds
    v_permlane32_swap_b32 v8, v4
    v_add_f32 v16, v8, v4
    s_waitcnt vmcnt(10)
    v_mfma_f32_32x32x16_bf16 v[64:79], a[152:155], a[92:95], v[64:79]
    ds_read_b128 a[148:151], v1 offset:54272
    v_mov_b32 v8, v17
    v_mov_b32 v4, v17
    s_nop 1
    v_permlane32_swap_b32 v8, v4
    v_add_f32 v17, v8, v4
    v_mul_f32 v6, 0x3b000000, v16
    v_mfma_f32_32x32x16_bf16 v[80:95], a[156:159], a[92:95], v[80:95]
    ds_read_b128 a[152:155], v1 offset:55296
    buffer_load_dwordx4 v1, s[36:39], s51 offen offset:2048 sc1 lds
    v_mul_f32 v17, 0x3b000000, v17
    s_waitcnt lgkmcnt(3)
    s_waitcnt vmcnt(10)
    v_mfma_f32_32x32x16_bf16 v[64:79], a[128:131], a[96:99], v[64:79]
    ds_read_b128 a[156:159], v1 offset:56320
    v_fma_f32 v17, -v6, v6, v17
    v_max_f32 v17, 0, v17
    v_add_f32 v17, 0x3727c5ac, v17
    v_rsq_f32 v7, v17
    v_mfma_f32_32x32x16_bf16 v[80:95], a[132:135], a[96:99], v[80:95]
    ds_read_b128 a[128:131], v1 offset:57344
    buffer_load_dwordx4 v1, s[36:39], s51 offen offset:3072 sc1 lds
    v_sub_f32 v42, 0, v6
    v_cndmask_b32 v42, 0, v42, s[52:53]
    s_waitcnt vmcnt(10)
    v_mfma_f32_32x32x16_bf16 v[64:79], a[136:139], a[100:103], v[64:79]
    ds_read_b128 a[132:135], v1 offset:58368
    v_cvt_pk_bf16_f32 v40, v42, v42
    v_lshlrev_b32 v43, 16, v40
    v_sub_f32 v43, v42, v43
    v_cvt_pk_bf16_f32 v41, v43, 0
    v_mov_b32 v42, 0
    v_mfma_f32_32x32x16_bf16 v[80:95], a[140:143], a[100:103], v[80:95]
    ds_read_b128 a[136:139], v1 offset:59392
    s_add_u32 s51, s48, s50
    s_add_u32 s51, s51, 114688
    s_add_u32 m0, s50, 114688
    s_nop 0
    buffer_load_dwordx4 v1, s[36:39], s51 offen sc1 lds
    s_waitcnt lgkmcnt(3)
    s_waitcnt vmcnt(10)
    v_mfma_f32_32x32x16_bf16 v[64:79], a[144:147], a[104:107], v[64:79]
    ds_read_b128 a[140:143], v1 offset:60416
    v_mov_b32 v43, 0
    v_mul_f32 v10, 0xc0135761, v7
    v_mul_f32 v13, v7, v7
    v_mul_f32 v11, 0x3d372713, v13
    v_mul_f32 v11, v11, v10
    v_mfma_f32_32x32x16_bf16 v[80:95], a[148:151], a[104:107], v[80:95]
    ds_read_b128 a[144:147], v1 offset:61440
    v_rcp_f32 v12, v13
    s_waitcnt vmcnt(9)
    v_mfma_f32_32x32x16_bf16 v[64:79], a[152:155], a[108:111], v[64:79]
    ds_read_b128 a[148:151], v1 offset:62464
    buffer_load_dwordx4 v1, s[36:39], s51 offen offset:1024 sc1 lds
    v_mfma_f32_32x32x16_bf16 v[80:95], a[156:159], a[108:111], v[80:95]
    ds_read_b128 a[152:155], v1 offset:63488
    s_waitcnt lgkmcnt(3)
    s_waitcnt vmcnt(9)
    v_mfma_f32_32x32x16_bf16 v[64:79], a[128:131], a[112:115], v[64:79]
    ds_read_b128 a[156:159], v1 offset:64512
    buffer_load_dwordx4 v1, s[36:39], s51 offen offset:2048 sc1 lds
    v_mfma_f32_32x32x16_bf16 v[80:95], a[132:135], a[112:115], v[80:95]
    ds_read_b64 a[128:129], v9 offset:0
    s_waitcnt vmcnt(9)
    v_mfma_f32_32x32x16_bf16 v[64:79], a[136:139], a[116:119], v[64:79]
    ds_read_b64 a[132:133], v9 offset:256
    buffer_load_dwordx4 v1, s[36:39], s51 offen offset:3072 sc1 lds
    v_mfma_f32_32x32x16_bf16 v[80:95], a[140:143], a[116:119], v[80:95]
    s_barrier
    ds_read_b128 a[136:139], v5 offset:0
    s_waitcnt lgkmcnt(3)
    s_waitcnt vmcnt(9)
    v_mfma_f32_32x32x16_bf16 v[64:79], a[144:147], a[120:123], v[64:79]
    ds_read_b128 a[140:143], v5 offset:1024
    s_add_u32 s51, s48, s50
    s_add_u32 s51, s51, 131072
    s_add_u32 m0, s50, 0
    s_nop 0
    buffer_load_dwordx4 v1, s[36:39], s51 offen sc1 lds
    v_mfma_f32_32x32x16_bf16 v[80:95], a[148:151], a[120:123], v[80:95]
    ds_read_b128 a[144:147], v5 offset:2048
    s_waitcnt vmcnt(9)
    v_mfma_f32_32x32x16_bf16 v[64:79], a[152:155], a[124:127], v[64:79]
    ds_read_b128 a[148:151], v5 offset:3072
    buffer_load_dwordx4 v1, s[36:39], s51 offen offset:1024 sc1 lds
    v_mfma_f32_32x32x16_bf16 v[80:95], a[156:159], a[124:127], v[80:95]
    ds_read_b128 a[152:155], v5 offset:4096
    s_waitcnt lgkmcnt(3)
    v_mfma_f32_32x32x16_bf16 v[64:79], a[128:131], v[40:43], v[64:79]
    ds_read_b128 a[156:159], v5 offset:5120
    v_mfma_f32_32x32x16_bf16 v[80:95], a[132:135], v[40:43], v[80:95]
    ds_read_b128 a[128:131], v5 offset:6144
    buffer_load_dwordx4 v1, s[36:39], s51 offen offset:2048 sc1 lds
    v_mfma_f32_32x32x16_bf16 v[96:111], a[136:139], a[0:3], 0
    ds_read_b128 a[132:135], v5 offset:7168
    v_mfma_f32_32x32x16_bf16 v[96:111], a[140:143], a[4:7], v[96:111]
    ds_read_b128 a[136:139], v5 offset:8192
    buffer_load_dwordx4 v1, s[36:39], s51 offen offset:3072 sc1 lds
    s_waitcnt lgkmcnt(3)
    v_mfma_f32_32x32x16_bf16 v[96:111], a[144:147], a[8:11], v[96:111]
    ds_read_b128 a[140:143], v5 offset:9216
    v_mul_f32 v16, v64, v64
    v_mul_f32 v17, v65, v65
    v_fma_f32 v16, v16, v11, v10
    v_fma_f32 v17, v17, v11, v10
    v_mul_f32 v16, v16, v64
    v_mfma_f32_32x32x16_bf16 v[96:111], a[148:151], a[12:15], v[96:111]
    ds_read_b128 a[144:147], v5 offset:10240
    s_add_u32 s51, s48, s50
    s_add_u32 s51, s51, 147456
    s_add_u32 m0, s50, 16384
    s_nop 0
    buffer_load_dwordx4 v1, s[36:39], s51 offen sc1 lds
    v_mfma_f32_32x32x16_bf16 v[96:111], a[152:155], a[16:19], v[96:111]
    ds_read_b128 a[148:151], v5 offset:11264
    v_mul_f32 v17, v17, v65
    v_exp_f32 v16, v16
    v_exp_f32 v17, v17
    v_mfma_f32_32x32x16_bf16 v[96:111], a[156:159], a[20:23], v[96:111]
    ds_read_b128 a[152:155], v5 offset:12288
    buffer_load_dwordx4 v1, s[36:39], s51 offen offset:1024 sc1 lds
    v_mul_f32 v64, v64, v72
    s_waitcnt lgkmcnt(3)
    v_mfma_f32_32x32x16_bf16 v[96:111], a[128:131], a[24:27], v[96:111]
    ds_read_b128 a[156:159], v5 offset:13312
    v_mul_f32 v65, v65, v73
    v_fma_f32 v16, v16, v12, v12
    v_fma_f32 v17, v17, v12, v12
    v_rcp_f32 v16, v16
    v_mfma_f32_32x32x16_bf16 v[96:111], a[132:135], a[28:31], v[96:111]
    ds_read_b128 a[128:131], v5 offset:14336
    buffer_load_dwordx4 v1, s[36:39], s51 offen offset:2048 sc1 lds
    v_rcp_f32 v17, v17
    v_mfma_f32_32x32x16_bf16 v[96:111], a[136:139], a[32:35], v[96:111]
    ds_read_b128 a[132:135], v5 offset:15360
    v_mul_f32 v64, v64, v16
    v_mul_f32 v65, v65, v17
    v_cvt_pk_bf16_f32 v32, v64, v65
    v_mul_f32 v16, v66, v66
    v_mul_f32 v17, v67, v67
    v_mfma_f32_32x32x16_bf16 v[96:111], a[140:143], a[36:39], v[96:111]
    s_barrier
    ds_read_b128 a[136:139], v5 offset:16384
    v_fma_f32 v16, v16, v11, v10
    v_fma_f32 v17, v17, v11, v10
    v_mul_f32 v16, v16, v66
    s_waitcnt lgkmcnt(3)
    v_mfma_f32_32x32x16_bf16 v[96:111], a[144:147], a[40:43], v[96:111]
    ds_read_b128 a[140:143], v5 offset:17408
    buffer_load_dwordx4 v1, s[36:39], s51 offen offset:3072 sc1 lds
    v_mul_f32 v17, v17, v67
    v_exp_f32 v16, v16
    v_mfma_f32_32x32x16_bf16 v[96:111], a[148:151], a[44:47], v[96:111]
    ds_read_b128 a[144:147], v5 offset:18432
    v_exp_f32 v17, v17
    v_mul_f32 v66, v66, v74
    v_mul_f32 v67, v67, v75
    v_fma_f32 v16, v16, v12, v12
    v_mfma_f32_32x32x16_bf16 v[96:111], a[152:155], a[48:51], v[96:111]
    ds_read_b128 a[148:151], v5 offset:19456
    s_add_u32 s51, s48, s50
    s_add_u32 s51, s51, 163840
    s_add_u32 m0, s50, 32768
    s_nop 0
    buffer_load_dwordx4 v1, s[36:39], s51 offen sc1 lds
    v_mfma_f32_32x32x16_bf16 v[96:111], a[156:159], a[52:55], v[96:111]
    ds_read_b128 a[152:155], v5 offset:20480
    v_fma_f32 v17, v17, v12, v12
    v_rcp_f32 v16, v16
    v_rcp_f32 v17, v17
    s_waitcnt lgkmcnt(3)
    v_mfma_f32_32x32x16_bf16 v[96:111], a[128:131], a[56:59], v[96:111]
    ds_read_b128 a[156:159], v5 offset:21504
    buffer_load_dwordx4 v1, s[36:39], s51 offen offset:1024 sc1 lds
    v_mul_f32 v66, v66, v16
    v_mul_f32 v67, v67, v17
    v_mfma_f32_32x32x16_bf16 v[96:111], a[132:135], a[60:63], v[96:111]
    ds_read_b128 a[128:131], v5 offset:22528
    v_cvt_pk_bf16_f32 v33, v66, v67
    v_mul_f32 v16, v68, v68
    v_mul_f32 v17, v69, v69
    v_fma_f32 v16, v16, v11, v10
    v_fma_f32 v17, v17, v11, v10
    v_mfma_f32_32x32x16_bf16 v[96:111], a[136:139], a[64:67], v[96:111]
    ds_read_b128 a[132:135], v5 offset:23552
    buffer_load_dwordx4 v1, s[36:39], s51 offen offset:2048 sc1 lds
    v_mul_f32 v16, v16, v68
    v_mul_f32 v17, v17, v69
    v_mfma_f32_32x32x16_bf16 v[96:111], a[140:143], a[68:71], v[96:111]
    ds_read_b128 a[136:139], v5 offset:24576
    v_exp_f32 v16, v16
    v_exp_f32 v17, v17
    s_waitcnt lgkmcnt(3)
    v_mfma_f32_32x32x16_bf16 v[96:111], a[144:147], a[72:75], v[96:111]
    ds_read_b128 a[140:143], v5 offset:25600
    buffer_load_dwordx4 v1, s[36:39], s51 offen offset:3072 sc1 lds
    v_mul_f32 v68, v68, v76
    v_mul_f32 v69, v69, v77
    v_mfma_f32_32x32x16_bf16 v[96:111], a[148:151], a[76:79], v[96:111]
    ds_read_b128 a[144:147], v5 offset:26624
    v_fma_f32 v16, v16, v12, v12
    v_fma_f32 v17, v17, v12, v12
    v_rcp_f32 v16, v16
    v_rcp_f32 v17, v17
    v_mfma_f32_32x32x16_bf16 v[96:111], a[152:155], a[80:83], v[96:111]
    ds_read_b128 a[148:151], v5 offset:27648
    v_mul_f32 v68, v68, v16
    v_mul_f32 v69, v69, v17
    v_cvt_pk_bf16_f32 v34, v68, v69
    v_mul_f32 v16, v70, v70
    v_mul_f32 v17, v71, v71
    v_mfma_f32_32x32x16_bf16 v[96:111], a[156:159], a[84:87], v[96:111]
    ds_read_b128 a[152:155], v5 offset:28672
    s_add_u32 s51, s48, s50
    s_add_u32 s51, s51, 180224
    s_add_u32 m0, s50, 49152
    s_nop 0
    buffer_load_dwordx4 v1, s[36:39], s51 offen sc1 lds
    s_waitcnt lgkmcnt(3)
    v_mfma_f32_32x32x16_bf16 v[96:111], a[128:131], a[88:91], v[96:111]
    ds_read_b128 a[156:159], v5 offset:29696
    v_fma_f32 v16, v16, v11, v10
    v_fma_f32 v17, v17, v11, v10
    v_mul_f32 v16, v16, v70
    v_mul_f32 v17, v17, v71
    v_exp_f32 v16, v16
    v_mfma_f32_32x32x16_bf16 v[96:111], a[132:135], a[92:95], v[96:111]
    ds_read_b128 a[128:131], v5 offset:30720
    buffer_load_dwordx4 v1, s[36:39], s51 offen offset:1024 sc1 lds
    v_exp_f32 v17, v17
    v_mfma_f32_32x32x16_bf16 v[96:111], a[136:139], a[96:99], v[96:111]
    ds_read_b128 a[132:135], v5 offset:31744
    v_mul_f32 v70, v70, v78
    v_mul_f32 v71, v71, v79
    v_fma_f32 v16, v16, v12, v12
    v_fma_f32 v17, v17, v12, v12
    v_rcp_f32 v16, v16
    v_mfma_f32_32x32x16_bf16 v[96:111], a[140:143], a[100:103], v[96:111]
    ds_read_b64 a[136:137], v9 offset:512
    buffer_load_dwordx4 v1, s[36:39], s51 offen offset:2048 sc1 lds
    v_rcp_f32 v17, v17
    s_waitcnt lgkmcnt(3)
    v_mfma_f32_32x32x16_bf16 v[96:111], a[144:147], a[104:107], v[96:111]
    s_waitcnt vmcnt(19)
    s_barrier
    ds_read_b128 a[140:143], v5 offset:32768
    v_mul_f32 v70, v70, v16
    v_mul_f32 v71, v71, v17
    v_cvt_pk_bf16_f32 v35, v70, v71
    v_mfma_f32_32x32x16_bf16 v[96:111], a[148:151], a[108:111], v[96:111]
    ds_read_b128 a[144:147], v5 offset:33792
    buffer_load_dwordx4 v1, s[36:39], s51 offen offset:3072 sc1 lds
    buffer_store_dwordx4 v[32:35], v1, s[36:39], s61 offen sc1
    s_add_u32 s61, s61, 4096
    v_mfma_f32_32x32x16_bf16 v[96:111], a[152:155], a[112:115], v[96:111]
    ds_read_b128 a[148:151], v5 offset:34816
    v_mul_f32 v16, v80, v80
    v_mul_f32 v17, v81, v81
    v_fma_f32 v16, v16, v11, v10
    v_fma_f32 v17, v17, v11, v10
    v_mul_f32 v16, v16, v80
    v_mfma_f32_32x32x16_bf16 v[96:111], a[156:159], a[116:119], v[96:111]
    ds_read_b128 a[152:155], v5 offset:35840
    s_add_u32 s51, s48, s50
    s_add_u32 s51, s51, 196608
    s_add_u32 m0, s50, 65536
    s_nop 0
    buffer_load_dwordx4 v1, s[36:39], s51 offen sc1 lds
    s_waitcnt lgkmcnt(3)
    v_mfma_f32_32x32x16_bf16 v[96:111], a[128:131], a[120:123], v[96:111]
    ds_read_b128 a[156:159], v5 offset:36864
    v_mul_f32 v17, v17, v81
    v_exp_f32 v16, v16
    v_exp_f32 v17, v17
    v_mfma_f32_32x32x16_bf16 v[96:111], a[132:135], a[124:127], v[96:111]
    ds_read_b128 a[128:131], v5 offset:37888
    v_mul_f32 v80, v80, v88
    v_mul_f32 v81, v81, v89
    v_fma_f32 v16, v16, v12, v12
    v_fma_f32 v17, v17, v12, v12
    v_rcp_f32 v16, v16
    v_mfma_f32_32x32x16_bf16 v[96:111], a[136:139], v[40:43], v[96:111]
    ds_read_b128 a[132:135], v5 offset:38912
    buffer_load_dwordx4 v1, s[36:39], s51 offen offset:1024 sc1 lds
    v_rcp_f32 v17, v17
    v_mfma_f32_32x32x16_bf16 v[112:127], a[140:143], a[0:3], 0
    ds_read_b128 a[136:139], v5 offset:39936
    v_mul_f32 v80, v80, v16
    v_mul_f32 v81, v81, v17
    v_cvt_pk_bf16_f32 v36, v80, v81
    v_mul_f32 v16, v82, v82
    s_waitcnt lgkmcnt(3)
    v_mfma_f32_32x32x16_bf16 v[112:127], a[144:147], a[4:7], v[112:127]
    ds_read_b128 a[140:143], v5 offset:40960
    buffer_load_dwordx4 v1, s[36:39], s51 offen offset:2048 sc1 lds
    v_mul_f32 v17, v83, v83
    v_fma_f32 v16, v16, v11, v10
    v_mfma_f32_32x32x16_bf16 v[112:127], a[148:151], a[8:11], v[112:127]
    ds_read_b128 a[144:147], v5 offset:41984
    v_fma_f32 v17, v17, v11, v10
    v_mul_f32 v16, v16, v82
    v_mul_f32 v17, v17, v83
    v_exp_f32 v16, v16
    v_mfma_f32_32x32x16_bf16 v[112:127], a[152:155], a[12:15], v[112:127]
    ds_read_b128 a[148:151], v5 offset:43008
    buffer_load_dwordx4 v1, s[36:39], s51 offen offset:3072 sc1 lds
    v_exp_f32 v17, v17
    v_mfma_f32_32x32x16_bf16 v[112:127], a[156:159], a[16:19], v[112:127]
    ds_read_b128 a[152:155], v5 offset:44032
    v_mul_f32 v82, v82, v90
    v_mul_f32 v83, v83, v91
    v_fma_f32 v16, v16, v12, v12
    v_fma_f32 v17, v17, v12, v12
    s_waitcnt lgkmcnt(3)
    v_mfma_f32_32x32x16_bf16 v[112:127], a[128:131], a[20:23], v[112:127]
    ds_read_b128 a[156:159], v5 offset:45056
    buffer_load_dwordx4 a[160:163], v14, s[36:39], s47 offen offset:0 sc1
    v_rcp_f32 v16, v16
    v_mfma_f32_32x32x16_bf16 v[112:127], a[132:135], a[24:27], v[112:127]
    ds_read_b128 a[128:131], v5 offset:46080
    v_rcp_f32 v17, v17
    v_mul_f32 v82, v82, v16
    v_mul_f32 v83, v83, v17
    v_cvt_pk_bf16_f32 v37, v82, v83
    v_mfma_f32_32x32x16_bf16 v[112:127], a[136:139], a[28:31], v[112:127]
    ds_read_b128 a[132:135], v5 offset:47104
    buffer_load_dwordx4 a[164:167], v15, s[36:39], s47 offen offset:0 sc1
    v_mul_f32 v16, v84, v84
    v_mul_f32 v17, v85, v85
    v_mfma_f32_32x32x16_bf16 v[112:127], a[140:143], a[32:35], v[112:127]
    ds_read_b128 a[136:139], v5 offset:48128
    v_fma_f32 v16, v16, v11, v10
    v_fma_f32 v17, v17, v11, v10
    v_mul_f32 v16, v16, v84
    v_mul_f32 v17, v17, v85
    s_waitcnt lgkmcnt(3)
    v_mfma_f32_32x32x16_bf16 v[112:127], a[144:147], a[36:39], v[112:127]
    s_waitcnt vmcnt(23)
    s_barrier
    ds_read_b128 a[140:143], v5 offset:49152
    v_exp_f32 v16, v16
    v_exp_f32 v17, v17
    v_mfma_f32_32x32x16_bf16 v[112:127], a[148:151], a[40:43], v[112:127]
    ds_read_b128 a[144:147], v5 offset:50176
    buffer_load_dwordx4 a[168:171], v14, s[36:39], s47 offen offset:2048 sc1
    v_mul_f32 v84, v84, v92
    v_mul_f32 v85, v85, v93
    v_mfma_f32_32x32x16_bf16 v[112:127], a[152:155], a[44:47], v[112:127]
    ds_read_b128 a[148:151], v5 offset:51200
    v_fma_f32 v16, v16, v12, v12
    v_fma_f32 v17, v17, v12, v12
    v_rcp_f32 v16, v16
    v_rcp_f32 v17, v17
    v_mfma_f32_32x32x16_bf16 v[112:127], a[156:159], a[48:51], v[112:127]
    ds_read_b128 a[152:155], v5 offset:52224
    s_add_u32 s51, s48, s50
    s_add_u32 s51, s51, 212992
    s_add_u32 m0, s50, 81920
    s_nop 0
    buffer_load_dwordx4 v1, s[36:39], s51 offen sc1 lds
    s_waitcnt lgkmcnt(3)
    v_mfma_f32_32x32x16_bf16 v[112:127], a[128:131], a[52:55], v[112:127]
    ds_read_b128 a[156:159], v5 offset:53248
    v_mul_f32 v84, v84, v16
    v_mul_f32 v85, v85, v17
    v_cvt_pk_bf16_f32 v38, v84, v85
    v_mul_f32 v16, v86, v86
    v_mul_f32 v17, v87, v87
    v_mfma_f32_32x32x16_bf16 v[112:127], a[132:135], a[56:59], v[112:127]
    ds_read_b128 a[128:131], v5 offset:54272
    buffer_load_dwordx4 v1, s[36:39], s51 offen offset:1024 sc1 lds
    v_fma_f32 v16, v16, v11, v10
    v_fma_f32 v17, v17, v11, v10
    v_mfma_f32_32x32x16_bf16 v[112:127], a[136:139], a[60:63], v[112:127]
    ds_read_b128 a[132:135], v5 offset:55296
    v_mul_f32 v16, v16, v86
    v_mul_f32 v17, v17, v87
    v_exp_f32 v16, v16
    v_exp_f32 v17, v17
    v_mfma_f32_32x32x16_bf16 v[112:127], a[140:143], a[64:67], v[112:127]
    ds_read_b128 a[136:139], v5 offset:56320
    buffer_load_dwordx4 v1, s[36:39], s51 offen offset:2048 sc1 lds
    v_mul_f32 v86, v86, v94
    s_waitcnt lgkmcnt(3)
    v_mfma_f32_32x32x16_bf16 v[112:127], a[144:147], a[68:71], v[112:127]
    ds_read_b128 a[140:143], v5 offset:57344
    v_mul_f32 v87, v87, v95
    v_fma_f32 v16, v16, v12, v12
    v_fma_f32 v17, v17, v12, v12
    v_rcp_f32 v16, v16
    v_mfma_f32_32x32x16_bf16 v[112:127], a[148:151], a[72:75], v[112:127]
    ds_read_b128 a[144:147], v5 offset:58368
    buffer_load_dwordx4 v1, s[36:39], s51 offen offset:3072 sc1 lds
    v_rcp_f32 v17, v17
    v_mfma_f32_32x32x16_bf16 v[112:127], a[152:155], a[76:79], v[112:127]
    ds_read_b128 a[148:151], v5 offset:59392
    v_mul_f32 v86, v86, v16
    v_mul_f32 v87, v87, v17
    v_cvt_pk_bf16_f32 v39, v86, v87
    buffer_store_dwordx4 v[36:39], v1, s[36:39], s61 offen sc1
    s_add_u32 s61, s61, 4096
    v_mfma_f32_32x32x16_bf16 v[112:127], a[156:159], a[80:83], v[112:127]
    ds_read_b128 a[152:155], v5 offset:60416
    v_mul_f32 v16, v96, v96
    v_mul_f32 v17, v97, v97
    v_fma_f32 v16, v16, v11, v10
    v_fma_f32 v17, v17, v11, v10
    s_waitcnt lgkmcnt(3)
    v_mfma_f32_32x32x16_bf16 v[112:127], a[128:131], a[84:87], v[112:127]
    ds_read_b128 a[156:159], v5 offset:61440
    buffer_load_dwordx4 a[172:175], v15, s[36:39], s47 offen offset:2048 sc1
    s_add_u32 s59, s59, 4096
    s_and_b32 s59, s59, 0x7fff
    s_add_u32 s47, s58, s59
    v_mfma_f32_32x32x16_bf16 v[112:127], a[132:135], a[88:91], v[112:127]
    ds_read_b128 a[128:131], v5 offset:62464
    v_mul_f32 v16, v16, v96
    v_mul_f32 v17, v17, v97
    v_exp_f32 v16, v16
    v_exp_f32 v17, v17
    v_mfma_f32_32x32x16_bf16 v[112:127], a[136:139], a[92:95], v[112:127]
    ds_read_b128 a[132:135], v5 offset:63488
    buffer_load_dwordx4 a[176:179], v14, s[36:39], s47 offen offset:0 sc1
    v_mul_f32 v96, v96, v104
    v_mul_f32 v97, v97, v105
    v_mfma_f32_32x32x16_bf16 v[112:127], a[140:143], a[96:99], v[112:127]
    ds_read_b128 a[136:139], v5 offset:64512
    v_fma_f32 v16, v16, v12, v12
    v_fma_f32 v17, v17, v12, v12
    v_rcp_f32 v16, v16
    s_waitcnt lgkmcnt(3)
    v_mfma_f32_32x32x16_bf16 v[112:127], a[144:147], a[100:103], v[112:127]
    ds_read_b64 a[140:141], v9 offset:768
    buffer_load_dwordx4 a[180:183], v15, s[36:39], s47 offen offset:0 sc1
    v_rcp_f32 v17, v17
    v_mfma_f32_32x32x16_bf16 v[112:127], a[148:151], a[104:107], v[112:127]
    s_waitcnt vmcnt(28)
    s_barrier
    ds_read_b128 a[144:147], v1 offset:0
    v_mul_f32 v96, v96, v16
    v_mul_f32 v97, v97, v17
    v_cvt_pk_bf16_f32 v32, v96, v97
    v_mfma_f32_32x32x16_bf16 v[112:127], a[152:155], a[108:111], v[112:127]
    ds_read_b128 a[148:151], v1 offset:1024
    buffer_load_dwordx4 a[184:187], v14, s[36:39], s47 offen offset:2048 sc1
    v_mul_f32 v16, v98, v98
    v_mul_f32 v17, v99, v99
    v_mfma_f32_32x32x16_bf16 v[112:127], a[156:159], a[112:115], v[112:127]
    ds_read_b128 a[152:155], v1 offset:2048
    v_fma_f32 v16, v16, v11, v10
    v_fma_f32 v17, v17, v11, v10
    v_mul_f32 v16, v16, v98
    v_mul_f32 v17, v17, v99
    s_waitcnt lgkmcnt(3)
    v_mfma_f32_32x32x16_bf16 v[112:127], a[128:131], a[116:119], v[112:127]
    ds_read_b128 a[156:159], v1 offset:3072
    buffer_load_dwordx4 a[188:191], v15, s[36:39], s47 offen offset:2048 sc1
    s_add_u32 s59, s59, 4096
    s_and_b32 s59, s59, 0x7fff
    s_add_u32 s47, s58, s59
    v_mfma_f32_32x32x16_bf16 v[112:127], a[132:135], a[120:123], v[112:127]
    ds_read_b128 a[128:131], v1 offset:4096
    v_exp_f32 v16, v16
    v_exp_f32 v17, v17
    v_mul_f32 v98, v98, v106
    v_mfma_f32_32x32x16_bf16 v[112:127], a[136:139], a[124:127], v[112:127]
    ds_read_b128 a[132:135], v1 offset:5120
    v_mul_f32 v99, v99, v107
    v_fma_f32 v16, v16, v12, v12
    v_fma_f32 v17, v17, v12, v12
    v_rcp_f32 v16, v16
    v_mfma_f32_32x32x16_bf16 v[112:127], a[140:143], v[40:43], v[112:127]
    ds_read_b128 a[136:139], v1 offset:6144
    buffer_load_dwordx4 a[192:195], v14, s[36:39], s47 offen offset:0 sc1
    v_rcp_f32 v17, v17
    s_waitcnt lgkmcnt(3)
    v_mfma_f32_32x32x16_bf16 v[64:79], a[144:147], a[0:3], 0
    ds_read_b128 a[140:143], v1 offset:7168
    v_mul_f32 v98, v98, v16
    v_mul_f32 v99, v99, v17
    v_cvt_pk_bf16_f32 v33, v98, v99
    v_mul_f32 v16, v100, v100
    v_mul_f32 v17, v101, v101
    v_mfma_f32_32x32x16_bf16 v[64:79], a[148:151], a[4:7], v[64:79]
    ds_read_b128 a[144:147], v1 offset:8192
    buffer_load_dwordx4 a[196:199], v15, s[36:39], s47 offen offset:0 sc1
    v_fma_f32 v16, v16, v11, v10
    v_fma_f32 v17, v17, v11, v10
    v_mfma_f32_32x32x16_bf16 v[64:79], a[152:155], a[8:11], v[64:79]
    ds_read_b128 a[148:151], v1 offset:9216
    v_mul_f32 v16, v16, v100
    v_mul_f32 v17, v17, v101
    v_exp_f32 v16, v16
    v_exp_f32 v17, v17
    v_mfma_f32_32x32x16_bf16 v[64:79], a[156:159], a[12:15], v[64:79]
    ds_read_b128 a[152:155], v1 offset:10240
    buffer_load_dwordx4 a[200:203], v14, s[36:39], s47 offen offset:2048 sc1
    v_mul_f32 v100, v100, v108
    s_waitcnt lgkmcnt(3)
    v_mfma_f32_32x32x16_bf16 v[64:79], a[128:131], a[16:19], v[64:79]
    ds_read_b128 a[156:159], v1 offset:11264
    v_mul_f32 v101, v101, v109
    v_fma_f32 v16, v16, v12, v12
    v_fma_f32 v17, v17, v12, v12
    v_rcp_f32 v16, v16
    v_mfma_f32_32x32x16_bf16 v[64:79], a[132:135], a[20:23], v[64:79]
    ds_read_b128 a[128:131], v1 offset:12288
    buffer_load_dwordx4 a[204:207], v15, s[36:39], s47 offen offset:2048 sc1
    s_add_u32 s59, s59, 4096
    s_and_b32 s59, s59, 0x7fff
    s_add_u32 s47, s58, s59
    v_mfma_f32_32x32x16_bf16 v[64:79], a[136:139], a[24:27], v[64:79]
    ds_read_b128 a[132:135], v1 offset:13312
    v_rcp_f32 v17, v17
    v_mul_f32 v100, v100, v16
    v_mul_f32 v101, v101, v17
    v_cvt_pk_bf16_f32 v34, v100, v101
    v_mfma_f32_32x32x16_bf16 v[64:79], a[140:143], a[28:31], v[64:79]
    ds_read_b128 a[136:139], v1 offset:14336
    buffer_load_dwordx4 a[208:211], v14, s[36:39], s47 offen offset:0 sc1
    v_mul_f32 v16, v102, v102
    s_waitcnt lgkmcnt(3)
    v_mfma_f32_32x32x16_bf16 v[64:79], a[144:147], a[32:35], v[64:79]
    ds_read_b128 a[140:143], v1 offset:15360
    v_mul_f32 v17, v103, v103
    v_fma_f32 v16, v16, v11, v10
    v_fma_f32 v17, v17, v11, v10
    v_mul_f32 v16, v16, v102
    v_mul_f32 v17, v17, v103
    v_mfma_f32_32x32x16_bf16 v[64:79], a[148:151], a[36:39], v[64:79]
    s_waitcnt vmcnt(31)
    s_barrier
    ds_read_b128 a[144:147], v1 offset:16384
    v_exp_f32 v16, v16
    v_exp_f32 v17, v17
    v_mfma_f32_32x32x16_bf16 v[64:79], a[152:155], a[40:43], v[64:79]
    ds_read_b128 a[148:151], v1 offset:17408
    buffer_load_dwordx4 a[212:215], v15, s[36:39], s47 offen offset:0 sc1
    v_mul_f32 v102, v102, v110
    v_mul_f32 v103, v103, v111
    v_mfma_f32_32x32x16_bf16 v[64:79], a[156:159], a[44:47], v[64:79]
    ds_read_b128 a[152:155], v1 offset:18432
    v_fma_f32 v16, v16, v12, v12
    v_fma_f32 v17, v17, v12, v12
    v_rcp_f32 v16, v16
    s_waitcnt lgkmcnt(3)
    v_mfma_f32_32x32x16_bf16 v[64:79], a[128:131], a[48:51], v[64:79]
    ds_read_b128 a[156:159], v1 offset:19456
    buffer_load_dwordx4 a[216:219], v14, s[36:39], s47 offen offset:2048 sc1
    v_rcp_f32 v17, v17
    v_mfma_f32_32x32x16_bf16 v[64:79], a[132:135], a[52:55], v[64:79]
    ds_read_b128 a[128:131], v1 offset:20480
    v_mul_f32 v102, v102, v16
    v_mul_f32 v103, v103, v17
    v_cvt_pk_bf16_f32 v35, v102, v103
    buffer_store_dwordx4 v[32:35], v1, s[36:39], s61 offen sc1
    s_add_u32 s61, s61, 4096
    v_mfma_f32_32x32x16_bf16 v[64:79], a[136:139], a[56:59], v[64:79]
    ds_read_b128 a[132:135], v1 offset:21504
    buffer_load_dwordx4 a[220:223], v15, s[36:39], s47 offen offset:2048 sc1
    s_add_u32 s59, s59, 4096
    s_and_b32 s59, s59, 0x7fff
    s_add_u32 s47, s58, s59
    v_mfma_f32_32x32x16_bf16 v[64:79], a[140:143], a[60:63], v[64:79]
    ds_read_b128 a[136:139], v1 offset:22528
    v_mul_f32 v16, v112, v112
    v_mul_f32 v17, v113, v113
    v_fma_f32 v16, v16, v11, v10
    v_fma_f32 v17, v17, v11, v10
    s_waitcnt lgkmcnt(3)
    v_mfma_f32_32x32x16_bf16 v[64:79], a[144:147], a[64:67], v[64:79]
    ds_read_b128 a[140:143], v1 offset:23552
    buffer_load_dwordx4 a[224:227], v14, s[36:39], s47 offen offset:0 sc1
    v_mul_f32 v16, v16, v112
    v_mul_f32 v17, v17, v113
    v_mfma_f32_32x32x16_bf16 v[64:79], a[148:151], a[68:71], v[64:79]
    ds_read_b128 a[144:147], v1 offset:24576
    v_exp_f32 v16, v16
    v_exp_f32 v17, v17
    v_mul_f32 v112, v112, v120
    v_mfma_f32_32x32x16_bf16 v[64:79], a[152:155], a[72:75], v[64:79]
    ds_read_b128 a[148:151], v1 offset:25600
    buffer_load_dwordx4 a[228:231], v15, s[36:39], s47 offen offset:0 sc1
    v_mul_f32 v113, v113, v121
    v_fma_f32 v16, v16, v12, v12
    v_mfma_f32_32x32x16_bf16 v[64:79], a[156:159], a[76:79], v[64:79]
    ds_read_b128 a[152:155], v1 offset:26624
    v_fma_f32 v17, v17, v12, v12
    v_rcp_f32 v16, v16
    v_rcp_f32 v17, v17
    s_waitcnt lgkmcnt(3)
    v_mfma_f32_32x32x16_bf16 v[64:79], a[128:131], a[80:83], v[64:79]
    ds_read_b128 a[156:159], v1 offset:27648
    v_mul_f32 v112, v112, v16
    v_mul_f32 v113, v113, v17
    v_cvt_pk_bf16_f32 v36, v112, v113
    v_mul_f32 v16, v114, v114
    v_mul_f32 v17, v115, v115
    v_mfma_f32_32x32x16_bf16 v[64:79], a[132:135], a[84:87], v[64:79]
    ds_read_b128 a[128:131], v1 offset:28672
    buffer_load_dwordx4 a[232:235], v14, s[36:39], s47 offen offset:2048 sc1
    v_fma_f32 v16, v16, v11, v10
    v_fma_f32 v17, v17, v11, v10
    v_mfma_f32_32x32x16_bf16 v[64:79], a[136:139], a[88:91], v[64:79]
    ds_read_b128 a[132:135], v1 offset:29696
    v_mul_f32 v16, v16, v114
    v_mul_f32 v17, v17, v115
    v_exp_f32 v16, v16
    v_exp_f32 v17, v17
    v_mfma_f32_32x32x16_bf16 v[64:79], a[140:143], a[92:95], v[64:79]
    ds_read_b128 a[136:139], v1 offset:30720
    buffer_load_dwordx4 a[236:239], v15, s[36:39], s47 offen offset:2048 sc1
    s_add_u32 s59, s59, 4096
    s_and_b32 s59, s59, 0x7fff
    s_add_u32 s47, s58, s59
    s_waitcnt lgkmcnt(3)
    v_mfma_f32_32x32x16_bf16 v[64:79], a[144:147], a[96:99], v[64:79]
    ds_read_b128 a[140:143], v1 offset:31744
    v_mul_f32 v114, v114, v122
    v_mul_f32 v115, v115, v123
    v_fma_f32 v16, v16, v12, v12
    v_fma_f32 v17, v17, v12, v12
    v_rcp_f32 v16, v16
    v_mfma_f32_32x32x16_bf16 v[64:79], a[148:151], a[100:103], v[64:79]
    ds_read_b64 a[144:145], v9 offset:1024
    buffer_load_dwordx4 a[240:243], v14, s[36:39], s47 offen offset:0 sc1
    v_rcp_f32 v17, v17
    v_mfma_f32_32x32x16_bf16 v[64:79], a[152:155], a[104:107], v[64:79]
    s_waitcnt vmcnt(36)
    s_barrier
    ds_read_b128 a[148:151], v1 offset:32768
    v_mul_f32 v114, v114, v16
    v_mul_f32 v115, v115, v17
    v_cvt_pk_bf16_f32 v37, v114, v115
    v_mfma_f32_32x32x16_bf16 v[64:79], a[156:159], a[108:111], v[64:79]
    ds_read_b128 a[152:155], v1 offset:33792
    buffer_load_dwordx4 a[244:247], v15, s[36:39], s47 offen offset:0 sc1
    v_mul_f32 v16, v116, v116
    s_waitcnt lgkmcnt(3)
    v_mfma_f32_32x32x16_bf16 v[64:79], a[128:131], a[112:115], v[64:79]
    ds_read_b128 a[156:159], v1 offset:34816
    v_mul_f32 v17, v117, v117
    v_fma_f32 v16, v16, v11, v10
    v_fma_f32 v17, v17, v11, v10
    v_mul_f32 v16, v16, v116
    v_mul_f32 v17, v17, v117
    v_mfma_f32_32x32x16_bf16 v[64:79], a[132:135], a[116:119], v[64:79]
    ds_read_b128 a[128:131], v1 offset:35840
    buffer_load_dwordx4 a[248:251], v14, s[36:39], s47 offen offset:2048 sc1
    v_exp_f32 v16, v16
    v_mfma_f32_32x32x16_bf16 v[64:79], a[136:139], a[120:123], v[64:79]
    ds_read_b128 a[132:135], v1 offset:36864
    v_exp_f32 v17, v17
    v_mul_f32 v116, v116, v124
    v_mul_f32 v117, v117, v125
    v_fma_f32 v16, v16, v12, v12
    v_mfma_f32_32x32x16_bf16 v[64:79], a[140:143], a[124:127], v[64:79]
    ds_read_b128 a[136:139], v1 offset:37888
    v_fma_f32 v17, v17, v12, v12
    v_rcp_f32 v16, v16
    v_rcp_f32 v17, v17
    s_waitcnt lgkmcnt(3)
    v_mfma_f32_32x32x16_bf16 v[64:79], a[144:147], v[40:43], v[64:79]
    ds_read_b128 a[140:143], v1 offset:38912
    buffer_load_dwordx4 a[252:255], v15, s[36:39], s47 offen offset:2048 sc1
    s_add_u32 s59, s59, 4096
    s_and_b32 s59, s59, 0x7fff
    s_add_u32 s47, s58, s59
    v_mfma_f32_32x32x16_bf16 v[80:95], a[148:151], a[0:3], 0
    ds_read_b128 a[144:147], v1 offset:39936
    v_mul_f32 v116, v116, v16
    v_mul_f32 v117, v117, v17
    v_cvt_pk_bf16_f32 v38, v116, v117
    v_mul_f32 v16, v118, v118
    v_mul_f32 v17, v119, v119
    v_mfma_f32_32x32x16_bf16 v[80:95], a[152:155], a[4:7], v[80:95]
    ds_read_b128 a[148:151], v1 offset:40960
    buffer_load_dwordx4 v[224:227], v14, s[36:39], s47 offen offset:0 sc1
    v_fma_f32 v16, v16, v11, v10
    v_fma_f32 v17, v17, v11, v10
    v_mfma_f32_32x32x16_bf16 v[80:95], a[156:159], a[8:11], v[80:95]
    ds_read_b128 a[152:155], v1 offset:41984
    v_mul_f32 v16, v16, v118
    v_mul_f32 v17, v17, v119
    v_exp_f32 v16, v16
    s_waitcnt lgkmcnt(3)
    v_mfma_f32_32x32x16_bf16 v[80:95], a[128:131], a[12:15], v[80:95]
    ds_read_b128 a[156:159], v1 offset:43008
    buffer_load_dwordx4 v[228:231], v15, s[36:39], s47 offen offset:0 sc1
    v_exp_f32 v17, v17
    v_mfma_f32_32x32x16_bf16 v[80:95], a[132:135], a[16:19], v[80:95]
    ds_read_b128 a[128:131], v1 offset:44032
    v_mul_f32 v118, v118, v126
    v_mul_f32 v119, v119, v127
    v_fma_f32 v16, v16, v12, v12
    v_fma_f32 v17, v17, v12, v12
    v_rcp_f32 v16, v16
    v_mfma_f32_32x32x16_bf16 v[80:95], a[136:139], a[20:23], v[80:95]
    ds_read_b128 a[132:135], v1 offset:45056
    buffer_load_dwordx4 v[232:235], v14, s[36:39], s47 offen offset:2048 sc1
    v_rcp_f32 v17, v17
    v_mfma_f32_32x32x16_bf16 v[80:95], a[140:143], a[24:27], v[80:95]
    ds_read_b128 a[136:139], v1 offset:46080
    v_mul_f32 v118, v118, v16
    v_mul_f32 v119, v119, v17
    v_cvt_pk_bf16_f32 v39, v118, v119
    buffer_store_dwordx4 v[36:39], v1, s[36:39], s61 offen sc1
    s_add_u32 s61, s61, 4096
    s_waitcnt lgkmcnt(3)
    v_mfma_f32_32x32x16_bf16 v[80:95], a[144:147], a[28:31], v[80:95]
    ds_read_b128 a[140:143], v1 offset:47104
    buffer_load_dwordx4 v[236:239], v15, s[36:39], s47 offen offset:2048 sc1
    s_add_u32 s59, s59, 4096
    s_and_b32 s59, s59, 0x7fff
    s_add_u32 s47, s58, s59
    v_mfma_f32_32x32x16_bf16 v[80:95], a[148:151], a[32:35], v[80:95]
    ds_read_b128 a[144:147], v1 offset:48128
    v_mul_f32 v16, v64, v64
    v_mul_f32 v17, v65, v65
    v_fma_f32 v16, v16, v11, v10
    v_fma_f32 v17, v17, v11, v10
    v_mul_f32 v16, v16, v64
    v_mfma_f32_32x32x16_bf16 v[80:95], a[152:155], a[36:39], v[80:95]
    s_waitcnt vmcnt(40)
    s_barrier
    ds_read_b128 a[148:151], v1 offset:49152
    v_mul_f32 v17, v17, v65
    v_exp_f32 v16, v16
    v_mfma_f32_32x32x16_bf16 v[80:95], a[156:159], a[40:43], v[80:95]
    ds_read_b128 a[152:155], v1 offset:50176
    buffer_load_dwordx4 v[240:243], v14, s[36:39], s47 offen offset:0 sc1
    v_exp_f32 v17, v17
    s_waitcnt lgkmcnt(3)
    v_mfma_f32_32x32x16_bf16 v[80:95], a[128:131], a[44:47], v[80:95]
    ds_read_b128 a[156:159], v1 offset:51200
    v_mul_f32 v64, v64, v72
    v_mul_f32 v65, v65, v73
    v_fma_f32 v16, v16, v12, v12
    v_fma_f32 v17, v17, v12, v12
    v_rcp_f32 v16, v16
    v_mfma_f32_32x32x16_bf16 v[80:95], a[132:135], a[48:51], v[80:95]
    ds_read_b128 a[128:131], v1 offset:52224
    buffer_load_dwordx4 v[244:247], v15, s[36:39], s47 offen offset:0 sc1
    v_rcp_f32 v17, v17
    v_mfma_f32_32x32x16_bf16 v[80:95], a[136:139], a[52:55], v[80:95]
    ds_read_b128 a[132:135], v1 offset:53248
    v_mul_f32 v64, v64, v16
    v_mul_f32 v65, v65, v17
    v_cvt_pk_bf16_f32 v32, v64, v65
    v_mul_f32 v16, v66, v66
    v_mul_f32 v17, v67, v67
    v_mfma_f32_32x32x16_bf16 v[80:95], a[140:143], a[56:59], v[80:95]
    ds_read_b128 a[136:139], v1 offset:54272
    buffer_load_dwordx4 v[248:251], v14, s[36:39], s47 offen offset:2048 sc1
    v_fma_f32 v16, v16, v11, v10
    s_waitcnt lgkmcnt(3)
    v_mfma_f32_32x32x16_bf16 v[80:95], a[144:147], a[60:63], v[80:95]
    ds_read_b128 a[140:143], v1 offset:55296
    v_fma_f32 v17, v17, v11, v10
    v_mul_f32 v16, v16, v66
    v_mul_f32 v17, v17, v67
    v_exp_f32 v16, v16
    v_mfma_f32_32x32x16_bf16 v[80:95], a[148:151], a[64:67], v[80:95]
    ds_read_b128 a[144:147], v1 offset:56320
    buffer_load_dwordx4 v[252:255], v15, s[36:39], s47 offen offset:2048 sc1
    s_lshl_b32 s59, s60, 13
    s_add_u32 s59, s59, 0x8000
    s_add_u32 s47, s58, s59
    v_mfma_f32_32x32x16_bf16 v[80:95], a[152:155], a[68:71], v[80:95]
    ds_read_b128 a[148:151], v1 offset:57344
    v_exp_f32 v17, v17
    v_mul_f32 v66, v66, v74
    v_mul_f32 v67, v67, v75
    v_fma_f32 v16, v16, v12, v12
    v_mfma_f32_32x32x16_bf16 v[80:95], a[156:159], a[72:75], v[80:95]
    ds_read_b128 a[152:155], v1 offset:58368
    buffer_load_dwordx4 v[176:179], v14, s[36:39], s47 offen offset:0 sc1
    v_fma_f32 v17, v17, v12, v12
    s_waitcnt lgkmcnt(3)
    v_mfma_f32_32x32x16_bf16 v[80:95], a[128:131], a[76:79], v[80:95]
    ds_read_b128 a[156:159], v1 offset:59392
    v_rcp_f32 v16, v16
    v_rcp_f32 v17, v17
    v_mul_f32 v66, v66, v16
    v_mfma_f32_32x32x16_bf16 v[80:95], a[132:135], a[80:83], v[80:95]
    ds_read_b128 a[128:131], v1 offset:60416
    v_mul_f32 v67, v67, v17
    v_cvt_pk_bf16_f32 v33, v66, v67
    v_mul_f32 v16, v68, v68
    v_mul_f32 v17, v69, v69
    v_fma_f32 v16, v16, v11, v10
    v_mfma_f32_32x32x16_bf16 v[80:95], a[136:139], a[84:87], v[80:95]
    ds_read_b128 a[132:135], v1 offset:61440
    buffer_load_dwordx4 v[180:183], v15, s[36:39], s47 offen offset:0 sc1
    v_fma_f32 v17, v17, v11, v10
    v_mul_f32 v16, v16, v68
    v_mfma_f32_32x32x16_bf16 v[80:95], a[140:143], a[88:91], v[80:95]
    ds_read_b128 a[136:139], v1 offset:62464
    v_mul_f32 v17, v17, v69
    v_exp_f32 v16, v16
    v_exp_f32 v17, v17
    s_waitcnt lgkmcnt(3)
    v_mfma_f32_32x32x16_bf16 v[80:95], a[144:147], a[92:95], v[80:95]
    ds_read_b128 a[140:143], v1 offset:63488
    buffer_load_dwordx4 v[184:187], v14, s[36:39], s47 offen offset:2048 sc1
    v_mul_f32 v68, v68, v76
    v_mul_f32 v69, v69, v77
    v_mfma_f32_32x32x16_bf16 v[80:95], a[148:151], a[96:99], v[80:95]
    ds_read_b128 a[144:147], v1 offset:64512
    v_fma_f32 v16, v16, v12, v12
    v_fma_f32 v17, v17, v12, v12
    v_rcp_f32 v16, v16
    v_rcp_f32 v17, v17
    v_mfma_f32_32x32x16_bf16 v[80:95], a[152:155], a[100:103], v[80:95]
    ds_read_b64 a[148:149], v9 offset:1280
    buffer_load_dwordx4 v[188:191], v15, s[36:39], s47 offen offset:2048 sc1
    s_add_u32 s59, s59, 4096
    s_add_u32 s47, s58, s59
    v_mfma_f32_32x32x16_bf16 v[80:95], a[156:159], a[104:107], v[80:95]
    s_waitcnt vmcnt(43)
    s_waitcnt vmcnt(9)
    s_barrier
    s_cmp_lg_u32 s3, 0
    s_cbranch_scc1 sq10
    s_lshl_b32 s4, s44, 8
    s_lshr_b32 s5, s45, 2
    s_lshl_b32 s5, s5, 5
    s_add_u32 s4, s4, s5
    s_add_u32 s4, s4, 7802880
    v_mov_b32 v8, 1
    s_mov_b64 exec, 1
    buffer_atomic_add v8, off, s[36:39], s4 sc1
    s_mov_b64 exec, -1
sq10:
    ds_read_b128 a[152:155], v5 offset:0
    s_waitcnt lgkmcnt(3)
    v_mfma_f32_32x32x16_bf16 v[80:95], a[128:131], a[108:111], v[80:95]
    ds_read_b128 a[156:159], v5 offset:1024
    buffer_load_dwordx4 v[192:195], v14, s[36:39], s47 offen offset:0 sc1
    v_mul_f32 v68, v68, v16
    v_mul_f32 v69, v69, v17
    v_mfma_f32_32x32x16_bf16 v[80:95], a[132:135], a[112:115], v[80:95]
    ds_read_b128 a[128:131], v5 offset:2048
    v_cvt_pk_bf16_f32 v34, v68, v69
    v_mul_f32 v16, v70, v70
    v_mul_f32 v17, v71, v71
    v_fma_f32 v16, v16, v11, v10
    v_fma_f32 v17, v17, v11, v10
    v_mfma_f32_32x32x16_bf16 v[80:95], a[136:139], a[116:119], v[80:95]
    ds_read_b128 a[132:135], v5 offset:3072
    buffer_load_dwordx4 v[196:199], v15, s[36:39], s47 offen offset:0 sc1
    v_mul_f32 v16, v16, v70
    v_mul_f32 v17, v17, v71
    v_mfma_f32_32x32x16_bf16 v[80:95], a[140:143], a[120:123], v[80:95]
    ds_read_b128 a[136:139], v5 offset:4096
    v_exp_f32 v16, v16
    v_exp_f32 v17, v17
    s_waitcnt lgkmcnt(3)
    v_mfma_f32_32x32x16_bf16 v[80:95], a[144:147], a[124:127], v[80:95]
    ds_read_b128 a[140:143], v5 offset:5120
    v_mul_f32 v70, v70, v78
    v_mul_f32 v71, v71, v79
    v_fma_f32 v16, v16, v12, v12
    v_fma_f32 v17, v17, v12, v12
    v_rcp_f32 v16, v16
    v_mfma_f32_32x32x16_bf16 v[80:95], a[148:151], v[40:43], v[80:95]
    ds_read_b128 a[144:147], v5 offset:6144
    buffer_load_dwordx4 v[200:203], v14, s[36:39], s47 offen offset:2048 sc1
    v_rcp_f32 v17, v17
    v_mfma_f32_32x32x16_bf16 v[96:111], a[152:155], a[0:3], 0
    ds_read_b128 a[148:151], v5 offset:7168
    v_mul_f32 v70, v70, v16
    v_mul_f32 v71, v71, v17
    v_cvt_pk_bf16_f32 v35, v70, v71
    buffer_store_dwordx4 v[32:35], v1, s[36:39], s61 offen sc1
    s_add_u32 s61, s61, 4096
    v_mfma_f32_32x32x16_bf16 v[96:111], a[156:159], a[4:7], v[96:111]
    ds_read_b128 a[152:155], v5 offset:8192
    buffer_load_dwordx4 v[204:207], v15, s[36:39], s47 offen offset:2048 sc1
    s_add_u32 s59, s59, 4096
    s_cmp_eq_u32 s59, 0xe000
    s_cselect_b32 s59, 0x8000, s59
    s_add_u32 s47, s58, s59
    s_waitcnt lgkmcnt(3)
    v_mfma_f32_32x32x16_bf16 v[96:111], a[128:131], a[8:11], v[96:111]
    ds_read_b128 a[156:159], v5 offset:9216
    v_mfma_f32_32x32x16_bf16 v[96:111], a[132:135], a[12:15], v[96:111]
    ds_read_b128 a[128:131], v5 offset:10240
    buffer_load_dwordx4 v[208:211], v14, s[36:39], s47 offen offset:0 sc1
    v_mul_f32 v16, v80, v80
    v_mul_f32 v17, v81, v81
    v_mfma_f32_32x32x16_bf16 v[96:111], a[136:139], a[16:19], v[96:111]
    ds_read_b128 a[132:135], v5 offset:11264
    v_fma_f32 v16, v16, v11, v10
    v_fma_f32 v17, v17, v11, v10
    v_mul_f32 v16, v16, v80
    v_mul_f32 v17, v17, v81
    v_exp_f32 v16, v16
    v_mfma_f32_32x32x16_bf16 v[96:111], a[140:143], a[20:23], v[96:111]
    ds_read_b128 a[136:139], v5 offset:12288
    buffer_load_dwordx4 v[212:215], v15, s[36:39], s47 offen offset:0 sc1
    v_exp_f32 v17, v17
    s_waitcnt lgkmcnt(3)
    v_mfma_f32_32x32x16_bf16 v[96:111], a[144:147], a[24:27], v[96:111]
    ds_read_b128 a[140:143], v5 offset:13312
    v_mul_f32 v80, v80, v88
    v_mul_f32 v81, v81, v89
    v_fma_f32 v16, v16, v12, v12
    v_fma_f32 v17, v17, v12, v12
    v_rcp_f32 v16, v16
    v_mfma_f32_32x32x16_bf16 v[96:111], a[148:151], a[28:31], v[96:111]
    ds_read_b128 a[144:147], v5 offset:14336
    buffer_load_dwordx4 v[216:219], v14, s[36:39], s47 offen offset:2048 sc1
    v_rcp_f32 v17, v17
    v_mfma_f32_32x32x16_bf16 v[96:111], a[152:155], a[32:35], v[96:111]
    ds_read_b128 a[148:151], v5 offset:15360
    v_mul_f32 v80, v80, v16
    v_mul_f32 v81, v81, v17
    v_cvt_pk_bf16_f32 v36, v80, v81
    v_mul_f32 v16, v82, v82
    v_mul_f32 v17, v83, v83
    v_mfma_f32_32x32x16_bf16 v[96:111], a[156:159], a[36:39], v[96:111]
    s_barrier
    ds_read_b128 a[152:155], v5 offset:16384
    v_fma_f32 v16, v16, v11, v10
    v_fma_f32 v17, v17, v11, v10
    v_mul_f32 v16, v16, v82
    s_waitcnt lgkmcnt(3)
    v_mfma_f32_32x32x16_bf16 v[96:111], a[128:131], a[40:43], v[96:111]
    ds_read_b128 a[156:159], v5 offset:17408
    buffer_load_dwordx4 v[220:223], v15, s[36:39], s47 offen offset:2048 sc1
    s_add_u32 s59, s59, 4096
    s_add_u32 s47, s58, s59
    v_mfma_f32_32x32x16_bf16 v[96:111], a[132:135], a[44:47], v[96:111]
    ds_read_b128 a[128:131], v5 offset:18432
    v_mul_f32 v17, v17, v83
    v_exp_f32 v16, v16
    v_exp_f32 v17, v17
    v_mfma_f32_32x32x16_bf16 v[96:111], a[136:139], a[48:51], v[96:111]
    ds_read_b128 a[132:135], v5 offset:19456
    buffer_load_dwordx4 v[128:131], v14, s[36:39], s47 offen offset:0 sc1
    v_mul_f32 v82, v82, v90
    v_mul_f32 v83, v83, v91
    v_mfma_f32_32x32x16_bf16 v[96:111], a[140:143], a[52:55], v[96:111]
    ds_read_b128 a[136:139], v5 offset:20480
    v_fma_f32 v16, v16, v12, v12
    v_fma_f32 v17, v17, v12, v12
    v_rcp_f32 v16, v16
    s_waitcnt lgkmcnt(3)
    v_mfma_f32_32x32x16_bf16 v[96:111], a[144:147], a[56:59], v[96:111]
    ds_read_b128 a[140:143], v5 offset:21504
    buffer_load_dwordx4 v[132:135], v15, s[36:39], s47 offen offset:0 sc1
    v_rcp_f32 v17, v17
    v_mfma_f32_32x32x16_bf16 v[96:111], a[148:151], a[60:63], v[96:111]
    ds_read_b128 a[144:147], v5 offset:22528
    v_mul_f32 v82, v82, v16
    v_mul_f32 v83, v83, v17
    v_cvt_pk_bf16_f32 v37, v82, v83
    v_mul_f32 v16, v84, v84
    v_mul_f32 v17, v85, v85
    v_mfma_f32_32x32x16_bf16 v[96:111], a[152:155], a[64:67], v[96:111]
    ds_read_b128 a[148:151], v5 offset:23552
    buffer_load_dwordx4 v[136:139], v14, s[36:39], s47 offen offset:2048 sc1
    v_fma_f32 v16, v16, v11, v10
    v_fma_f32 v17, v17, v11, v10
    v_mfma_f32_32x32x16_bf16 v[96:111], a[156:159], a[68:71], v[96:111]
    ds_read_b128 a[152:155], v5 offset:24576
    v_mul_f32 v16, v16, v84
    v_mul_f32 v17, v17, v85
    v_exp_f32 v16, v16
    s_waitcnt lgkmcnt(3)
    v_mfma_f32_32x32x16_bf16 v[96:111], a[128:131], a[72:75], v[96:111]
    ds_read_b128 a[156:159], v5 offset:25600
    buffer_load_dwordx4 v[140:143], v15, s[36:39], s47 offen offset:2048 sc1
    s_add_u32 s59, s59, 4096
    s_cmp_eq_u32 s59, 0xe000
    s_cselect_b32 s59, 0x8000, s59
    s_add_u32 s47, s58, s59
    v_mfma_f32_32x32x16_bf16 v[96:111], a[132:135], a[76:79], v[96:111]
    ds_read_b128 a[128:131], v5 offset:26624
    v_exp_f32 v17, v17
    v_mul_f32 v84, v84, v92
    v_mul_f32 v85, v85, v93
    v_fma_f32 v16, v16, v12, v12
    v_mfma_f32_32x32x16_bf16 v[96:111], a[136:139], a[80:83], v[96:111]
    ds_read_b128 a[132:135], v5 offset:27648
    v_fma_f32 v17, v17, v12, v12
    v_rcp_f32 v16, v16
    v_rcp_f32 v17, v17
    v_mfma_f32_32x32x16_bf16 v[96:111], a[140:143], a[84:87], v[96:111]
    ds_read_b128 a[136:139], v5 offset:28672
    buffer_load_dwordx4 v[144:147], v14, s[36:39], s47 offen offset:0 sc1
    v_mul_f32 v84, v84, v16
    s_waitcnt lgkmcnt(3)
    v_mfma_f32_32x32x16_bf16 v[96:111], a[144:147], a[88:91], v[96:111]
    ds_read_b128 a[140:143], v5 offset:29696
    v_mul_f32 v85, v85, v17
    v_cvt_pk_bf16_f32 v38, v84, v85
    v_mul_f32 v16, v86, v86
    v_mul_f32 v17, v87, v87
    v_fma_f32 v16, v16, v11, v10
    v_mfma_f32_32x32x16_bf16 v[96:111], a[148:151], a[92:95], v[96:111]
    ds_read_b128 a[144:147], v5 offset:30720
    buffer_load_dwordx4 v[148:151], v15, s[36:39], s47 offen offset:0 sc1
    v_fma_f32 v17, v17, v11, v10
    v_mul_f32 v16, v16, v86
    v_mfma_f32_32x32x16_bf16 v[96:111], a[152:155], a[96:99], v[96:111]
    ds_read_b128 a[148:151], v5 offset:31744
    v_mul_f32 v17, v17, v87
    v_exp_f32 v16, v16
    v_exp_f32 v17, v17
    v_mfma_f32_32x32x16_bf16 v[96:111], a[156:159], a[100:103], v[96:111]
    ds_read_b64 a[152:153], v9 offset:1536
    buffer_load_dwordx4 v[152:155], v14, s[36:39], s47 offen offset:2048 sc1
    v_mul_f32 v86, v86, v94
    s_waitcnt lgkmcnt(3)
    v_mfma_f32_32x32x16_bf16 v[96:111], a[128:131], a[104:107], v[96:111]
    v_mul_f32 v87, v87, v95
    v_fma_f32 v16, v16, v12, v12
    v_fma_f32 v17, v17, v12, v12
    v_rcp_f32 v16, v16
    v_rcp_f32 v17, v17
    v_mfma_f32_32x32x16_bf16 v[96:111], a[132:135], a[108:111], v[96:111]
    buffer_load_dwordx4 v[156:159], v15, s[36:39], s47 offen offset:2048 sc1
    s_add_u32 s59, s59, 4096
    s_add_u32 s47, s58, s59
    v_mul_f32 v86, v86, v16
    v_mfma_f32_32x32x16_bf16 v[96:111], a[136:139], a[112:115], v[96:111]
    v_mul_f32 v87, v87, v17
    v_cvt_pk_bf16_f32 v39, v86, v87
    buffer_store_dwordx4 v[36:39], v1, s[36:39], s61 offen sc1
    s_add_u32 s61, s61, 4096
    v_mfma_f32_32x32x16_bf16 v[96:111], a[140:143], a[116:119], v[96:111]
    buffer_load_dwordx4 v[160:163], v14, s[36:39], s47 offen offset:0 sc1
    s_waitcnt lgkmcnt(0)
    v_mfma_f32_32x32x16_bf16 v[96:111], a[144:147], a[120:123], v[96:111]
    v_mfma_f32_32x32x16_bf16 v[96:111], a[148:151], a[124:127], v[96:111]
    v_mfma_f32_32x32x16_bf16 v[96:111], a[152:155], v[40:43], v[96:111]
    buffer_load_dwordx4 v[164:167], v15, s[36:39], s47 offen offset:0 sc1
    buffer_load_dwordx4 v[168:171], v14, s[36:39], s47 offen offset:2048 sc1
    buffer_load_dwordx4 v[172:175], v15, s[36:39], s47 offen offset:2048 sc1
    s_lshl_b32 s54, s44, 8
    s_lshl_b32 s4, s3, 5
    s_add_u32 s54, s54, s4
    s_add_u32 s54, s54, 7802880
    buffer_load_dword v4, off, s[36:39], s54 sc1
    s_nop 3
    v_mul_f32 v16, v96, v96
    v_mul_f32 v17, v97, v97
    v_fma_f32 v16, v16, v11, v10
    v_fma_f32 v17, v17, v11, v10
    v_mul_f32 v16, v16, v96
    v_mul_f32 v17, v17, v97
    v_exp_f32 v16, v16
    v_exp_f32 v17, v17
    v_mul_f32 v96, v96, v104
    v_mul_f32 v97, v97, v105
    v_fma_f32 v16, v16, v12, v12
    v_fma_f32 v17, v17, v12, v12
    v_rcp_f32 v16, v16
    v_rcp_f32 v17, v17
    v_mul_f32 v96, v96, v16
    v_mul_f32 v97, v97, v17
    v_cvt_pk_bf16_f32 v32, v96, v97
    v_mul_f32 v16, v98, v98
    v_mul_f32 v17, v99, v99
    v_fma_f32 v16, v16, v11, v10
    v_fma_f32 v17, v17, v11, v10
    v_mul_f32 v16, v16, v98
    v_mul_f32 v17, v17, v99
    v_exp_f32 v16, v16
    v_exp_f32 v17, v17
    v_mul_f32 v98, v98, v106
    v_mul_f32 v99, v99, v107
    v_fma_f32 v16, v16, v12, v12
    v_fma_f32 v17, v17, v12, v12
    v_rcp_f32 v16, v16
    v_rcp_f32 v17, v17
    v_mul_f32 v98, v98, v16
    v_mul_f32 v99, v99, v17
    v_cvt_pk_bf16_f32 v33, v98, v99
    v_mul_f32 v16, v100, v100
    v_mul_f32 v17, v101, v101
    v_fma_f32 v16, v16, v11, v10
    v_fma_f32 v17, v17, v11, v10
    v_mul_f32 v16, v16, v100
    v_mul_f32 v17, v17, v101
    v_exp_f32 v16, v16
    v_exp_f32 v17, v17
    v_mul_f32 v100, v100, v108
    v_mul_f32 v101, v101, v109
    v_fma_f32 v16, v16, v12, v12
    v_fma_f32 v17, v17, v12, v12
    v_rcp_f32 v16, v16
    v_rcp_f32 v17, v17
    v_mul_f32 v100, v100, v16
    v_mul_f32 v101, v101, v17
    v_cvt_pk_bf16_f32 v34, v100, v101
    v_mul_f32 v16, v102, v102
    v_mul_f32 v17, v103, v103
    v_fma_f32 v16, v16, v11, v10
    v_fma_f32 v17, v17, v11, v10
    v_mul_f32 v16, v16, v102
    v_mul_f32 v17, v17, v103
    v_exp_f32 v16, v16
    v_exp_f32 v17, v17
    v_mul_f32 v102, v102, v110
    v_mul_f32 v103, v103, v111
    v_fma_f32 v16, v16, v12, v12
    v_fma_f32 v17, v17, v12, v12
    v_rcp_f32 v16, v16
    v_rcp_f32 v17, v17
    v_mul_f32 v102, v102, v16
    v_mul_f32 v103, v103, v17
    v_cvt_pk_bf16_f32 v35, v102, v103
    buffer_store_dwordx4 v[32:35], v1, s[36:39], s61 offen sc1
    s_add_u32 s61, s61, 4096
    s_waitcnt vmcnt(1)
    v_readfirstlane_b32 s4, v4
    s_mov_b32 s5, 0
    s_cmp_ge_u32 s4, 4
    s_cbranch_scc1 pc11_ok
pc11_loop:
    buffer_load_dword v4, off, s[36:39], s54 sc1
    s_add_u32 s5, s5, 1
    s_waitcnt vmcnt(0)
    v_readfirstlane_b32 s4, v4
    s_cmp_gt_u32 s5, 0x40000
    s_cbranch_scc1 pc11_ok
    s_cmp_lt_u32 s4, 4
    s_cbranch_scc1 pc11_loop
pc11_ok:
    s_lshl_b32 s6, s44, 1
    s_lshr_b32 s7, s45, 3
    s_add_u32 s6, s6, s7
    s_and_b32 s7, s45, 7
    s_lshr_b32 s11, s3, 1
    s_lshl_b32 s12, s6, 1
    s_add_u32 s11, s11, s12
    s_and_b32 s12, s3, 1
    s_lshl_b32 s13, s7, 1
    s_add_u32 s12, s12, s13
    s_lshl_b32 s13, s11, 15
    s_lshl_b32 s14, s12, 11
    s_add_u32 s13, s13, s14
    s_add_u32 s14, s13, 13631488
    buffer_load_dwordx4 v[80:83], v1, s[36:39], s14 offen sc1
    buffer_load_dwordx4 v[84:87], v1, s[36:39], s14 offen offset:1024 sc1
    s_mul_i32 s10, s3, 28672
    s_add_u32 s10, s10, 22020096
    s_mul_i32 s8, s11, 114688
    s_add_u32 s8, s8, s10
    s_xor_b32 s9, s11, 1
    s_mul_i32 s9, s9, 114688
    s_add_u32 s9, s9, s10
    s_and_b32 s10, s44, 0
    s_add_u32 s10, s10, s7
    s_and_b32 s10, s10, 3
    s_lshl_b32 s10, s10, 12
    s_add_u32 s6, s9, s10
    s_lshl_b32 s55, s60, 12
    s_add_u32 s55, s55, 0x4000
    s_add_u32 s13, s13, 11534336
    s_lshl_b32 s14, s12, 14
    s_lshl_b32 s15, s11, 8
    s_add_u32 s14, s14, s15
    s_add_u32 s14, s14, 8650752
    buffer_load_dwordx4 a[0:3], v1, s[36:39], s6 offen offset:0 sc1
    buffer_load_dwordx4 a[4:7], v1, s[36:39], s6 offen offset:1024 sc1
    buffer_load_dwordx4 a[8:11], v1, s[36:39], s6 offen offset:2048 sc1
    buffer_load_dwordx4 a[12:15], v1, s[36:39], s6 offen offset:3072 sc1
    s_add_u32 s10, s10, 4096
    s_and_b32 s10, s10, 0x3fff
    s_add_u32 s6, s9, s10
    buffer_load_dwordx4 a[16:19], v1, s[36:39], s6 offen offset:0 sc1
    buffer_load_dwordx4 a[20:23], v1, s[36:39], s6 offen offset:1024 sc1
    buffer_load_dwordx4 a[24:27], v1, s[36:39], s6 offen offset:2048 sc1
    buffer_load_dwordx4 a[28:31], v1, s[36:39], s6 offen offset:3072 sc1
    s_add_u32 s10, s10, 4096
    s_and_b32 s10, s10, 0x3fff
    s_add_u32 s6, s9, s10
    buffer_load_dwordx4 a[32:35], v1, s[36:39], s6 offen offset:0 sc1
    buffer_load_dwordx4 a[36:39], v1, s[36:39], s6 offen offset:1024 sc1
    buffer_load_dwordx4 a[40:43], v1, s[36:39], s6 offen offset:2048 sc1
    buffer_load_dwordx4 a[44:47], v1, s[36:39], s6 offen offset:3072 sc1
    s_add_u32 s10, s10, 4096
    s_and_b32 s10, s10, 0x3fff
    s_add_u32 s6, s9, s10
    s_waitcnt vmcnt(11)
    s_barrier
    s_cmp_lg_u32 s3, 0
    s_cbranch_scc1 sq12
    s_lshl_b32 s4, s44, 8
    s_lshr_b32 s5, s45, 2
    s_lshl_b32 s5, s5, 5
    s_add_u32 s4, s4, s5
    s_add_u32 s4, s4, 7803008
    v_mov_b32 v8, 1
    s_mov_b64 exec, 1
    buffer_atomic_add v8, off, s[36:39], s4 sc1
    s_mov_b64 exec, -1
sq12:
    v_mfma_f32_32x32x16_bf16 v[48:63], a[160:163], a[0:3], 0
    buffer_load_dwordx4 a[48:51], v1, s[36:39], s6 offen offset:0 sc1
    v_mfma_f32_32x32x16_bf16 v[64:79], a[164:167], a[0:3], 0
    s_waitcnt vmcnt(11)
    v_mfma_f32_32x32x16_bf16 v[48:63], a[168:171], a[4:7], v[48:63]
    buffer_load_dwordx4 a[52:55], v1, s[36:39], s6 offen offset:1024 sc1
    v_mfma_f32_32x32x16_bf16 v[64:79], a[172:175], a[4:7], v[64:79]
    s_waitcnt vmcnt(11)
    v_mfma_f32_32x32x16_bf16 v[48:63], a[176:179], a[8:11], v[48:63]
    buffer_load_dwordx4 a[56:59], v1, s[36:39], s6 offen offset:2048 sc1
    v_mfma_f32_32x32x16_bf16 v[64:79], a[180:183], a[8:11], v[64:79]
    s_waitcnt vmcnt(11)
    v_mfma_f32_32x32x16_bf16 v[48:63], a[184:187], a[12:15], v[48:63]
    buffer_load_dwordx4 a[60:63], v1, s[36:39], s6 offen offset:3072 sc1
    s_add_u32 s10, s10, 4096
    s_and_b32 s10, s10, 0x3fff
    s_add_u32 s6, s8, s10
    v_mfma_f32_32x32x16_bf16 v[64:79], a[188:191], a[12:15], v[64:79]
    s_waitcnt vmcnt(11)
    v_mfma_f32_32x32x16_bf16 v[48:63], a[192:195], a[16:19], v[48:63]
    buffer_load_dwordx4 a[64:67], v1, s[36:39], s6 offen offset:0 sc1
    v_mfma_f32_32x32x16_bf16 v[64:79], a[196:199], a[16:19], v[64:79]
    s_waitcnt vmcnt(11)
    v_mfma_f32_32x32x16_bf16 v[48:63], a[200:203], a[20:23], v[48:63]
    buffer_load_dwordx4 a[68:71], v1, s[36:39], s6 offen offset:1024 sc1
    v_mfma_f32_32x32x16_bf16 v[64:79], a[204:207], a[20:23], v[64:79]
    s_waitcnt vmcnt(11)
    v_mfma_f32_32x32x16_bf16 v[48:63], a[208:211], a[24:27], v[48:63]
    buffer_load_dwordx4 a[72:75], v1, s[36:39], s6 offen offset:2048 sc1
    v_mfma_f32_32x32x16_bf16 v[64:79], a[212:215], a[24:27], v[64:79]
    s_waitcnt vmcnt(11)
    v_mfma_f32_32x32x16_bf16 v[48:63], a[216:219], a[28:31], v[48:63]
    buffer_load_dwordx4 a[76:79], v1, s[36:39], s6 offen offset:3072 sc1
    s_add_u32 s10, s10, 4096
    s_and_b32 s10, s10, 0x3fff
    s_add_u32 s6, s8, s10
    v_mfma_f32_32x32x16_bf16 v[64:79], a[220:223], a[28:31], v[64:79]
    s_waitcnt vmcnt(11)
    v_mfma_f32_32x32x16_bf16 v[48:63], a[224:227], a[32:35], v[48:63]
    buffer_load_dwordx4 a[80:83], v1, s[36:39], s6 offen offset:0 sc1
    v_mfma_f32_32x32x16_bf16 v[64:79], a[228:231], a[32:35], v[64:79]
    s_waitcnt vmcnt(11)
    v_mfma_f32_32x32x16_bf16 v[48:63], a[232:235], a[36:39], v[48:63]
    buffer_load_dwordx4 a[84:87], v1, s[36:39], s6 offen offset:1024 sc1
    v_mfma_f32_32x32x16_bf16 v[64:79], a[236:239], a[36:39], v[64:79]
    s_waitcnt vmcnt(11)
    v_mfma_f32_32x32x16_bf16 v[48:63], a[240:243], a[40:43], v[48:63]
    buffer_load_dwordx4 a[88:91], v1, s[36:39], s6 offen offset:2048 sc1
    v_mfma_f32_32x32x16_bf16 v[64:79], a[244:247], a[40:43], v[64:79]
    s_waitcnt vmcnt(11)
    v_mfma_f32_32x32x16_bf16 v[48:63], a[248:251], a[44:47], v[48:63]
    buffer_load_dwordx4 a[92:95], v1, s[36:39], s6 offen offset:3072 sc1
    s_add_u32 s10, s10, 4096
    s_and_b32 s10, s10, 0x3fff
    s_add_u32 s6, s8, s10
    v_mfma_f32_32x32x16_bf16 v[64:79], a[252:255], a[44:47], v[64:79]
    s_waitcnt vmcnt(11)
    v_mfma_f32_32x32x16_bf16 v[48:63], v[224:227], a[48:51], v[48:63]
    buffer_load_dwordx4 a[96:99], v1, s[36:39], s6 offen offset:0 sc1
    v_mfma_f32_32x32x16_bf16 v[64:79], v[228:231], a[48:51], v[64:79]
    s_waitcnt vmcnt(11)
    v_mfma_f32_32x32x16_bf16 v[48:63], v[232:235], a[52:55], v[48:63]
    buffer_load_dwordx4 a[100:103], v1, s[36:39], s6 offen offset:1024 sc1
    v_mfma_f32_32x32x16_bf16 v[64:79], v[236:239], a[52:55], v[64:79]
    s_waitcnt vmcnt(11)
    v_mfma_f32_32x32x16_bf16 v[48:63], v[240:243], a[56:59], v[48:63]
    buffer_load_dwordx4 a[104:107], v1, s[36:39], s6 offen offset:2048 sc1
    s_lshl_b32 s54, s44, 8
    s_lshl_b32 s4, s3, 5
    s_add_u32 s54, s54, s4
    s_add_u32 s54, s54, 7803008
    buffer_load_dword v104, off, s[36:39], s54 sc1
    v_mfma_f32_32x32x16_bf16 v[64:79], v[244:247], a[56:59], v[64:79]
    s_waitcnt vmcnt(12)
    v_mfma_f32_32x32x16_bf16 v[48:63], v[248:251], a[60:63], v[48:63]
    buffer_load_dwordx4 a[108:111], v1, s[36:39], s6 offen offset:3072 sc1
    s_add_u32 s10, s10, 4096
    s_and_b32 s10, s10, 0x3fff
    s_add_u32 s6, s8, s10
    v_mfma_f32_32x32x16_bf16 v[64:79], v[252:255], a[60:63], v[64:79]
    s_waitcnt vmcnt(12)
    v_mfma_f32_32x32x16_bf16 v[32:47], a[164:167], a[64:67], 0
    buffer_load_dwordx4 a[112:115], v1, s[36:39], s6 offen offset:0 sc1
    v_mfma_f32_32x32x16_bf16 v[16:31], a[160:163], a[64:67], 0
    s_waitcnt vmcnt(12)
    v_mfma_f32_32x32x16_bf16 v[32:47], a[172:175], a[68:71], v[32:47]
    buffer_load_dwordx4 a[116:119], v1, s[36:39], s6 offen offset:1024 sc1
    v_mfma_f32_32x32x16_bf16 v[16:31], a[168:171], a[68:71], v[16:31]
    s_waitcnt vmcnt(12)
    v_mfma_f32_32x32x16_bf16 v[32:47], a[180:183], a[72:75], v[32:47]
    buffer_load_dwordx4 a[120:123], v1, s[36:39], s6 offen offset:2048 sc1
    v_mfma_f32_32x32x16_bf16 v[16:31], a[176:179], a[72:75], v[16:31]
    s_waitcnt vmcnt(12)
    v_mfma_f32_32x32x16_bf16 v[32:47], a[188:191], a[76:79], v[32:47]
    buffer_load_dwordx4 a[124:127], v1, s[36:39], s6 offen offset:3072 sc1
    s_add_u32 s6, s9, s55
    s_add_u32 s55, s55, 4096
    s_cmp_eq_u32 s55, 0x7000
    s_cselect_b32 s55, 0x4000, s55
    v_mfma_f32_32x32x16_bf16 v[16:31], a[184:187], a[76:79], v[16:31]
    s_waitcnt vmcnt(12)
    v_mfma_f32_32x32x16_bf16 v[32:47], a[196:199], a[80:83], v[32:47]
    s_waitcnt vmcnt(5)
    v_readfirstlane_b32 s4, v104
    s_mov_b32 s5, 0
    s_cmp_ge_u32 s4, 4
    s_cbranch_scc1 pc13_ok
pc13_loop:
    buffer_load_dword v104, off, s[36:39], s54 sc1
    s_add_u32 s5, s5, 1
    s_waitcnt vmcnt(0)
    v_readfirstlane_b32 s4, v104
    s_cmp_gt_u32 s5, 0x40000
    s_cbranch_scc1 pc13_ok
    s_cmp_lt_u32 s4, 4
    s_cbranch_scc1 pc13_loop
pc13_ok:
    buffer_load_dwordx4 a[0:3], v1, s[36:39], s6 offen offset:0 sc1
    v_mfma_f32_32x32x16_bf16 v[16:31], a[192:195], a[80:83], v[16:31]
    v_mfma_f32_32x32x16_bf16 v[32:47], a[204:207], a[84:87], v[32:47]
    buffer_load_dwordx4 a[4:7], v1, s[36:39], s6 offen offset:1024 sc1
    v_mfma_f32_32x32x16_bf16 v[16:31], a[200:203], a[84:87], v[16:31]
    v_mfma_f32_32x32x16_bf16 v[32:47], a[212:215], a[88:91], v[32:47]
    buffer_load_dwordx4 a[8:11], v1, s[36:39], s6 offen offset:2048 sc1
    v_mfma_f32_32x32x16_bf16 v[16:31], a[208:211], a[88:91], v[16:31]
    v_mfma_f32_32x32x16_bf16 v[32:47], a[220:223], a[92:95], v[32:47]
    buffer_load_dwordx4 a[12:15], v1, s[36:39], s6 offen offset:3072 sc1
    s_add_u32 s6, s9, s55
    s_add_u32 s55, s55, 4096
    s_cmp_eq_u32 s55, 0x7000
    s_cselect_b32 s55, 0x4000, s55
    v_mfma_f32_32x32x16_bf16 v[16:31], a[216:219], a[92:95], v[16:31]
    v_mfma_f32_32x32x16_bf16 v[32:47], a[228:231], a[96:99], v[32:47]
    buffer_load_dwordx4 a[16:19], v1, s[36:39], s6 offen offset:0 sc1
    v_mfma_f32_32x32x16_bf16 v[16:31], a[224:227], a[96:99], v[16:31]
    v_mfma_f32_32x32x16_bf16 v[32:47], a[236:239], a[100:103], v[32:47]
    buffer_load_dwordx4 a[20:23], v1, s[36:39], s6 offen offset:1024 sc1
    v_mfma_f32_32x32x16_bf16 v[16:31], a[232:235], a[100:103], v[16:31]
    v_mfma_f32_32x32x16_bf16 v[32:47], a[244:247], a[104:107], v[32:47]
    buffer_load_dwordx4 a[24:27], v1, s[36:39], s6 offen offset:2048 sc1
    v_mfma_f32_32x32x16_bf16 v[16:31], a[240:243], a[104:107], v[16:31]
    s_waitcnt vmcnt(11)
    v_mfma_f32_32x32x16_bf16 v[32:47], a[252:255], a[108:111], v[32:47]
    buffer_load_dwordx4 a[28:31], v1, s[36:39], s6 offen offset:3072 sc1
    s_add_u32 s6, s9, s55
    s_add_u32 s55, s55, 4096
    s_cmp_eq_u32 s55, 0x7000
    s_cselect_b32 s55, 0x4000, s55
    v_mfma_f32_32x32x16_bf16 v[16:31], a[248:251], a[108:111], v[16:31]
    s_waitcnt vmcnt(11)
    v_mfma_f32_32x32x16_bf16 v[32:47], v[228:231], a[112:115], v[32:47]
    buffer_load_dwordx4 a[32:35], v1, s[36:39], s6 offen offset:0 sc1
    v_mfma_f32_32x32x16_bf16 v[16:31], v[224:227], a[112:115], v[16:31]
    s_waitcnt vmcnt(11)
    v_mfma_f32_32x32x16_bf16 v[32:47], v[236:239], a[116:119], v[32:47]
    buffer_load_dwordx4 a[36:39], v1, s[36:39], s6 offen offset:1024 sc1
    v_mfma_f32_32x32x16_bf16 v[16:31], v[232:235], a[116:119], v[16:31]
    s_waitcnt vmcnt(11)
    v_mfma_f32_32x32x16_bf16 v[32:47], v[244:247], a[120:123], v[32:47]
    buffer_load_dwordx4 a[40:43], v1, s[36:39], s6 offen offset:2048 sc1
    v_mfma_f32_32x32x16_bf16 v[16:31], v[240:243], a[120:123], v[16:31]
    s_waitcnt vmcnt(11)
    v_mfma_f32_32x32x16_bf16 v[32:47], v[252:255], a[124:127], v[32:47]
    buffer_load_dwordx4 a[44:47], v1, s[36:39], s6 offen offset:3072 sc1
    s_add_u32 s6, s8, s55
    s_add_u32 s55, s55, 4096
    s_cmp_eq_u32 s55, 0x7000
    s_cselect_b32 s55, 0x4000, s55
    v_mfma_f32_32x32x16_bf16 v[16:31], v[248:251], a[124:127], v[16:31]
    s_waitcnt vmcnt(11)
    v_mfma_f32_32x32x16_bf16 v[48:63], v[176:179], a[0:3], v[48:63]
    buffer_load_dwordx4 a[48:51], v1, s[36:39], s6 offen offset:0 sc1
    v_mfma_f32_32x32x16_bf16 v[64:79], v[180:183], a[0:3], v[64:79]
    s_waitcnt vmcnt(11)
    v_mfma_f32_32x32x16_bf16 v[48:63], v[184:187], a[4:7], v[48:63]
    buffer_load_dwordx4 a[52:55], v1, s[36:39], s6 offen offset:1024 sc1
    v_mfma_f32_32x32x16_bf16 v[64:79], v[188:191], a[4:7], v[64:79]
    s_waitcnt vmcnt(11)
    v_mfma_f32_32x32x16_bf16 v[48:63], v[192:195], a[8:11], v[48:63]
    buffer_load_dwordx4 a[56:59], v1, s[36:39], s6 offen offset:2048 sc1
    v_mfma_f32_32x32x16_bf16 v[64:79], v[196:199], a[8:11], v[64:79]
    s_waitcnt vmcnt(11)
    v_mfma_f32_32x32x16_bf16 v[48:63], v[200:203], a[12:15], v[48:63]
    buffer_load_dwordx4 a[60:63], v1, s[36:39], s6 offen offset:3072 sc1
    s_add_u32 s6, s8, s55
    s_add_u32 s55, s55, 4096
    s_cmp_eq_u32 s55, 0x7000
    s_cselect_b32 s55, 0x4000, s55
    v_mfma_f32_32x32x16_bf16 v[64:79], v[204:207], a[12:15], v[64:79]
    s_waitcnt vmcnt(11)
    v_mfma_f32_32x32x16_bf16 v[48:63], v[208:211], a[16:19], v[48:63]
    buffer_load_dwordx4 a[64:67], v1, s[36:39], s6 offen offset:0 sc1
    v_mfma_f32_32x32x16_bf16 v[64:79], v[212:215], a[16:19], v[64:79]
    s_waitcnt vmcnt(11)
    v_mfma_f32_32x32x16_bf16 v[48:63], v[216:219], a[20:23], v[48:63]
    buffer_load_dwordx4 a[68:71], v1, s[36:39], s6 offen offset:1024 sc1
    v_mfma_f32_32x32x16_bf16 v[64:79], v[220:223], a[20:23], v[64:79]
    s_waitcnt vmcnt(11)
    v_mfma_f32_32x32x16_bf16 v[48:63], v[128:131], a[24:27], v[48:63]
    buffer_load_dwordx4 a[72:75], v1, s[36:39], s6 offen offset:2048 sc1
    v_mfma_f32_32x32x16_bf16 v[64:79], v[132:135], a[24:27], v[64:79]
    s_waitcnt vmcnt(11)
    v_mfma_f32_32x32x16_bf16 v[48:63], v[136:139], a[28:31], v[48:63]
    buffer_load_dwordx4 a[76:79], v1, s[36:39], s6 offen offset:3072 sc1
    s_add_u32 s6, s8, s55
    s_add_u32 s55, s55, 4096
    s_cmp_eq_u32 s55, 0x7000
    s_cselect_b32 s55, 0x4000, s55
    v_mfma_f32_32x32x16_bf16 v[64:79], v[140:143], a[28:31], v[64:79]
    s_waitcnt vmcnt(11)
    v_mfma_f32_32x32x16_bf16 v[48:63], v[144:147], a[32:35], v[48:63]
    buffer_load_dwordx4 a[80:83], v1, s[36:39], s6 offen offset:0 sc1
    v_mfma_f32_32x32x16_bf16 v[64:79], v[148:151], a[32:35], v[64:79]
    s_waitcnt vmcnt(11)
    v_mfma_f32_32x32x16_bf16 v[48:63], v[152:155], a[36:39], v[48:63]
    buffer_load_dwordx4 a[84:87], v1, s[36:39], s6 offen offset:1024 sc1
    v_mfma_f32_32x32x16_bf16 v[64:79], v[156:159], a[36:39], v[64:79]
    s_waitcnt vmcnt(11)
    v_mfma_f32_32x32x16_bf16 v[48:63], v[160:163], a[40:43], v[48:63]
    buffer_load_dwordx4 a[88:91], v1, s[36:39], s6 offen offset:2048 sc1
    s_add_u32 s51, s49, s50
    s_add_u32 s51, s51, 49152
    s_add_u32 m0, s50, 49152
    s_nop 0
    buffer_load_dwordx4 v1, s[36:39], s51 offen sc1 lds
    v_mfma_f32_32x32x16_bf16 v[64:79], v[164:167], a[40:43], v[64:79]
    s_waitcnt vmcnt(12)
    v_mfma_f32_32x32x16_bf16 v[48:63], v[168:171], a[44:47], v[48:63]
    buffer_load_dwordx4 a[92:95], v1, s[36:39], s6 offen offset:3072 sc1
    buffer_load_dwordx4 v1, s[36:39], s51 offen offset:1024 sc1 lds
    v_mfma_f32_32x32x16_bf16 v[64:79], v[172:175], a[44:47], v[64:79]
    s_waitcnt vmcnt(13)
    v_mfma_f32_32x32x16_bf16 v[32:47], v[180:183], a[48:51], v[32:47]
    buffer_load_dwordx4 v1, s[36:39], s51 offen offset:2048 sc1 lds
    v_mfma_f32_32x32x16_bf16 v[16:31], v[176:179], a[48:51], v[16:31]
    s_xor_b32 s4, s3, 2
    s_mul_i32 s4, s4, 12288
    s_add_u32 s4, s4, 102400
    v_add_u32 v4, s4, v1
    s_nop 0
    ds_write_b128 v4, v[48:51] offset:0
    ds_write_b128 v4, v[52:55] offset:1024
    s_waitcnt vmcnt(13)
    v_mfma_f32_32x32x16_bf16 v[32:47], v[188:191], a[52:55], v[32:47]
    ds_write_b128 v4, v[56:59] offset:2048
    ds_write_b128 v4, v[60:63] offset:3072
    s_xor_b32 s4, s3, 3
    s_mul_i32 s4, s4, 12288
    s_add_u32 s4, s4, 106496
    v_add_u32 v4, s4, v1
    v_mfma_f32_32x32x16_bf16 v[16:31], v[184:187], a[52:55], v[16:31]
    buffer_load_dwordx4 v1, s[36:39], s51 offen offset:3072 sc1 lds
    ds_write_b128 v4, v[64:67] offset:0
    ds_write_b128 v4, v[68:71] offset:1024
    ds_write_b128 v4, v[72:75] offset:2048
    s_waitcnt vmcnt(13)
    v_mfma_f32_32x32x16_bf16 v[32:47], v[196:199], a[56:59], v[32:47]
    ds_write_b128 v4, v[76:79] offset:3072
    s_mul_i32 s4, s3, 12288
    s_add_u32 s4, s4, 98304
    v_add_u32 v7, s4, v1
    v_mfma_f32_32x32x16_bf16 v[16:31], v[192:195], a[56:59], v[16:31]
    s_add_u32 s51, s49, s50
    s_add_u32 s51, s51, 65536
    s_add_u32 m0, s50, 65536
    s_nop 0
    buffer_load_dwordx4 v1, s[36:39], s51 offen sc1 lds
    s_waitcnt vmcnt(13)
    v_mfma_f32_32x32x16_bf16 v[32:47], v[204:207], a[60:63], v[32:47]
    v_mfma_f32_32x32x16_bf16 v[16:31], v[200:203], a[60:63], v[16:31]
    s_waitcnt vmcnt(12)
    v_mfma_f32_32x32x16_bf16 v[32:47], v[212:215], a[64:67], v[32:47]
    buffer_load_dwordx4 v1, s[36:39], s51 offen offset:1024 sc1 lds
    v_mfma_f32_32x32x16_bf16 v[16:31], v[208:211], a[64:67], v[16:31]
    s_waitcnt vmcnt(12)
    v_mfma_f32_32x32x16_bf16 v[32:47], v[220:223], a[68:71], v[32:47]
    buffer_load_dwordx4 v1, s[36:39], s51 offen offset:2048 sc1 lds
    v_mfma_f32_32x32x16_bf16 v[16:31], v[216:219], a[68:71], v[16:31]
    s_waitcnt lgkmcnt(0)
    s_barrier
    ds_read_b128 v[48:51], v7 offset:4096
    ds_read_b128 v[52:55], v7 offset:5120
    ds_read_b128 v[56:59], v7 offset:6144
    ds_read_b128 v[60:63], v7 offset:7168
    s_waitcnt vmcnt(12)
    v_mfma_f32_32x32x16_bf16 v[32:47], v[132:135], a[72:75], v[32:47]
    ds_read_b128 v[64:67], v7 offset:8192
    ds_read_b128 v[68:71], v7 offset:9216
    ds_read_b128 v[72:75], v7 offset:10240
    ds_read_b128 v[76:79], v7 offset:11264
    s_waitcnt lgkmcnt(0)
    v_add_f32 v48, v48, v64
    v_mfma_f32_32x32x16_bf16 v[16:31], v[128:131], a[72:75], v[16:31]
    buffer_load_dwordx4 v1, s[36:39], s51 offen offset:3072 sc1 lds
    v_add_f32 v49, v49, v65
    v_add_f32 v50, v50, v66
    v_add_f32 v51, v51, v67
    s_waitcnt vmcnt(12)
    v_mfma_f32_32x32x16_bf16 v[32:47], v[140:143], a[76:79], v[32:47]
    v_add_f32 v52, v52, v68
    v_add_f32 v53, v53, v69
    v_add_f32 v54, v54, v70
    v_add_f32 v55, v55, v71
    v_add_f32 v56, v56, v72
    v_add_f32 v57, v57, v73
    v_mfma_f32_32x32x16_bf16 v[16:31], v[136:139], a[76:79], v[16:31]
    s_add_u32 s51, s49, s50
    s_add_u32 s51, s51, 81920
    s_add_u32 m0, s50, 81920
    s_nop 0
    buffer_load_dwordx4 v1, s[36:39], s51 offen sc1 lds
    s_waitcnt vmcnt(12)
    v_mfma_f32_32x32x16_bf16 v[32:47], v[148:151], a[80:83], v[32:47]
    v_add_f32 v58, v58, v74
    v_add_f32 v59, v59, v75
    v_add_f32 v60, v60, v76
    v_add_f32 v61, v61, v77
    v_add_f32 v62, v62, v78
    v_add_f32 v63, v63, v79
    s_waitcnt vmcnt(11)
    v_mfma_f32_32x32x16_bf16 v[32:47], v[156:159], a[84:87], v[32:47]
    s_waitcnt vmcnt(10)
    v_mfma_f32_32x32x16_bf16 v[32:47], v[164:167], a[88:91], v[32:47]
    buffer_load_dwordx4 v1, s[36:39], s51 offen offset:1024 sc1 lds
    s_waitcnt vmcnt(9)
    v_mfma_f32_32x32x16_bf16 v[32:47], v[172:175], a[92:95], v[32:47]
    v_mfma_f32_32x32x16_bf16 v[16:31], v[144:147], a[80:83], v[16:31]
    buffer_load_dwordx4 v1, s[36:39], s51 offen offset:2048 sc1 lds
    v_mfma_f32_32x32x16_bf16 v[16:31], v[152:155], a[84:87], v[16:31]
    s_xor_b32 s4, s3, 1
    s_mul_i32 s4, s4, 12288
    s_add_u32 s4, s4, 98304
    v_add_u32 v4, s4, v1
    s_nop 4
    ds_write_b128 v4, v[32:35] offset:0
    ds_write_b128 v4, v[36:39] offset:1024
    v_mfma_f32_32x32x16_bf16 v[16:31], v[160:163], a[88:91], v[16:31]
    ds_write_b128 v4, v[40:43] offset:2048
    ds_write_b128 v4, v[44:47] offset:3072
    v_mfma_f32_32x32x16_bf16 v[16:31], v[168:171], a[92:95], v[16:31]
    buffer_load_dwordx4 v1, s[36:39], s51 offen offset:3072 sc1 lds
    s_waitcnt lgkmcnt(0)
    s_barrier
    ds_read_b128 v[88:91], v7 offset:0
    ds_read_b128 v[92:95], v7 offset:1024
    ds_read_b128 v[96:99], v7 offset:2048
    ds_read_b128 v[100:103], v7 offset:3072
    s_nop 4
    v_pk_add_f32 v[16:17], v[16:17], v[48:49]
    v_pk_add_f32 v[18:19], v[18:19], v[50:51]
    v_pk_add_f32 v[20:21], v[20:21], v[52:53]
    v_pk_add_f32 v[22:23], v[22:23], v[54:55]
    v_pk_add_f32 v[24:25], v[24:25], v[56:57]
    v_pk_add_f32 v[26:27], v[26:27], v[58:59]
    v_pk_add_f32 v[28:29], v[28:29], v[60:61]
    v_pk_add_f32 v[30:31], v[30:31], v[62:63]
    s_waitcnt lgkmcnt(3)
    v_pk_add_f32 v[16:17], v[16:17], v[88:89]
    v_pk_add_f32 v[18:19], v[18:19], v[90:91]
    s_waitcnt lgkmcnt(2)
    v_pk_add_f32 v[20:21], v[20:21], v[92:93]
    v_pk_add_f32 v[22:23], v[22:23], v[94:95]
    s_waitcnt lgkmcnt(1)
    v_pk_add_f32 v[24:25], v[24:25], v[96:97]
    v_pk_add_f32 v[26:27], v[26:27], v[98:99]
    s_waitcnt lgkmcnt(0)
    v_pk_add_f32 v[28:29], v[28:29], v[100:101]
    v_pk_add_f32 v[30:31], v[30:31], v[102:103]
    v_lshlrev_b32 v8, 16, v80
    v_and_b32 v9, 0xffff0000, v80
    v_add_f32 v16, v16, v8
    v_add_f32 v17, v17, v9
    v_cvt_pk_bf16_f32 v80, v16, v17
    v_lshlrev_b32 v8, 16, v81
    v_and_b32 v9, 0xffff0000, v81
    v_add_f32 v18, v18, v8
    v_add_f32 v19, v19, v9
    v_cvt_pk_bf16_f32 v81, v18, v19
    v_lshlrev_b32 v8, 16, v82
    v_and_b32 v9, 0xffff0000, v82
    v_add_f32 v20, v20, v8
    v_add_f32 v21, v21, v9
    v_cvt_pk_bf16_f32 v82, v20, v21
    v_lshlrev_b32 v8, 16, v83
    v_and_b32 v9, 0xffff0000, v83
    v_add_f32 v22, v22, v8
    v_add_f32 v23, v23, v9
    v_cvt_pk_bf16_f32 v83, v22, v23
    v_lshlrev_b32 v8, 16, v84
    v_and_b32 v9, 0xffff0000, v84
    v_add_f32 v24, v24, v8
    v_add_f32 v25, v25, v9
    v_cvt_pk_bf16_f32 v84, v24, v25
    v_lshlrev_b32 v8, 16, v85
    v_and_b32 v9, 0xffff0000, v85
    v_add_f32 v26, v26, v8
    v_add_f32 v27, v27, v9
    v_cvt_pk_bf16_f32 v85, v26, v27
    v_lshlrev_b32 v8, 16, v86
    v_and_b32 v9, 0xffff0000, v86
    v_add_f32 v28, v28, v8
    v_add_f32 v29, v29, v9
    v_cvt_pk_bf16_f32 v86, v28, v29
    v_lshlrev_b32 v8, 16, v87
    v_and_b32 v9, 0xffff0000, v87
    v_add_f32 v30, v30, v8
    v_add_f32 v31, v31, v9
    v_cvt_pk_bf16_f32 v87, v30, v31
    buffer_store_dwordx4 v[80:83], v1, s[36:39], s13 offen sc1
    buffer_store_dwordx4 v[84:87], v1, s[36:39], s13 offen offset:1024 sc1
    v_mov_b32 v8, 0
    v_mov_b32 v9, 0
    v_mov_b32 v10, 0x3f803f80
    v_dot2_f32_bf16 v8, v80, v10, v8
    v_dot2_f32_bf16 v9, v80, v80, v9
    v_dot2_f32_bf16 v8, v81, v10, v8
    v_dot2_f32_bf16 v9, v81, v81, v9
    v_dot2_f32_bf16 v8, v82, v10, v8
    v_dot2_f32_bf16 v9, v82, v82, v9
    v_dot2_f32_bf16 v8, v83, v10, v8
    v_dot2_f32_bf16 v9, v83, v83, v9
    v_dot2_f32_bf16 v8, v84, v10, v8
    v_dot2_f32_bf16 v9, v84, v84, v9
    v_dot2_f32_bf16 v8, v85, v10, v8
    v_dot2_f32_bf16 v9, v85, v85, v9
    v_dot2_f32_bf16 v8, v86, v10, v8
    v_dot2_f32_bf16 v9, v86, v86, v9
    v_dot2_f32_bf16 v8, v87, v10, v8
    v_dot2_f32_bf16 v9, v87, v87, v9
    s_nop 1
    v_mov_b32 v10, v8
    v_mov_b32 v11, v8
    s_nop 1
    v_permlane32_swap_b32 v10, v11
    v_add_f32 v8, v10, v11
    v_mov_b32 v10, v9
    v_mov_b32 v11, v9
    s_nop 1
    v_permlane32_swap_b32 v10, v11
    v_add_f32 v9, v10, v11
    v_lshlrev_b32 v10, 3, v2
    s_mov_b32 exec_hi, 0
    buffer_store_dwordx2 v[8:9], v10, s[36:39], s14 offen sc1
    s_mov_b64 exec, -1
    s_waitcnt vmcnt(0)
    s_barrier
    s_cmp_lg_u32 s3, 0
    s_cbranch_scc1 sig14
    s_lshl_b32 s4, s44, 8
    s_add_u32 s4, s4, 7806976
    v_mov_b32 v8, 1
    v_mov_b32 v9, 0
    s_mov_b64 exec, 1
    buffer_atomic_add v8, v9, s[36:39], s4 offen sc1
    s_mov_b64 exec, -1
sig14:
    s_sub_u32 s4, s3, 1
    s_cmp_ge_u32 s4, 3
    s_cbranch_scc1 bys15
    s_lshl_b32 s4, s4, 14
    s_add_u32 s51, s49, s4
    s_add_u32 s51, s51, 0
    s_add_u32 s4, s4, 0
    s_mov_b32 m0, s4
    s_nop 0
    buffer_load_dwordx4 v1, s[36:39], s51 offen offset:0 sc1 lds
    buffer_load_dwordx4 v1, s[36:39], s51 offen offset:1024 sc1 lds
    buffer_load_dwordx4 v1, s[36:39], s51 offen offset:2048 sc1 lds
    buffer_load_dwordx4 v1, s[36:39], s51 offen offset:3072 sc1 lds
    s_add_u32 s51, s51, 4096
    s_add_u32 s4, s4, 4096
    s_mov_b32 m0, s4
    s_nop 0
    buffer_load_dwordx4 v1, s[36:39], s51 offen offset:0 sc1 lds
    buffer_load_dwordx4 v1, s[36:39], s51 offen offset:1024 sc1 lds
    buffer_load_dwordx4 v1, s[36:39], s51 offen offset:2048 sc1 lds
    buffer_load_dwordx4 v1, s[36:39], s51 offen offset:3072 sc1 lds
    s_add_u32 s51, s51, 4096
    s_add_u32 s4, s4, 4096
    s_mov_b32 m0, s4
    s_nop 0
    buffer_load_dwordx4 v1, s[36:39], s51 offen offset:0 sc1 lds
    buffer_load_dwordx4 v1, s[36:39], s51 offen offset:1024 sc1 lds
    buffer_load_dwordx4 v1, s[36:39], s51 offen offset:2048 sc1 lds
    buffer_load_dwordx4 v1, s[36:39], s51 offen offset:3072 sc1 lds
    s_add_u32 s51, s51, 4096
    s_add_u32 s4, s4, 4096
    s_mov_b32 m0, s4
    s_nop 0
    buffer_load_dwordx4 v1, s[36:39], s51 offen offset:0 sc1 lds
    buffer_load_dwordx4 v1, s[36:39], s51 offen offset:1024 sc1 lds
    buffer_load_dwordx4 v1, s[36:39], s51 offen offset:2048 sc1 lds
    buffer_load_dwordx4 v1, s[36:39], s51 offen offset:3072 sc1 lds
bys15:
    s_and_b32 s4, s45, 3
    s_lshl_b32 s46, s4, 17
    s_lshl_b32 s4, s3, 10
    s_add_u32 s46, s46, s4
    s_add_u32 s56, s46, 1572864
    s_lshl_b32 s57, s44, 1
    s_lshr_b32 s4, s45, 2
    s_add_u32 s57, s57, s4
    s_and_b32 s57, s57, 7
    s_lshl_b32 s57, s57, 12
    s_add_u32 s46, s56, s57
    v_add_u32 v160, 0, v1
    v_add_u32 v161, 32768, v1
    v_add_u32 v162, 65536, v1
    v_add_u32 v163, 98304, v1
    s_mul_i32 s62, s3, 12288
    s_lshl_b32 s63, s3, 14
    s_cmp_lg_u32 s3, 0
    s_cbranch_scc1 wt16_done
    s_lshl_b32 s4, s44, 8
    s_add_u32 s4, s4, 7806976
    v_mov_b32 v9, 0
    s_mov_b64 exec, 1
    s_mov_b32 s5, 0
wt16_loop:
    buffer_load_dword v8, v9, s[36:39], s4 offen sc1
    s_add_u32 s5, s5, 1
    s_waitcnt vmcnt(0)
    v_cmp_gt_u32 vcc, 16, v8
    s_cmp_gt_u32 s5, 0x40000
    s_cbranch_scc1 wt16_out
    s_nop 1
    s_cbranch_vccnz wt16_loop
wt16_out:
    s_mov_b64 exec, -1
wt16_done:
    s_barrier
    s_lshl_b32 s8, s44, 2
    s_add_u32 s8, s8, s3
    s_lshl_b32 s12, s8, 15
    s_add_u32 s12, s12, 11534336
    s_and_b32 s15, s45, 7
    s_lshl_b32 s15, s15, 12
    s_add_u32 s10, s12, s15
    buffer_load_dwordx4 a[0:3], v1, s[36:39], s10 offen offset:0 sc1
    buffer_load_dwordx4 a[4:7], v1, s[36:39], s10 offen offset:1024 sc1
    buffer_load_dwordx4 a[8:11], v1, s[36:39], s10 offen offset:2048 sc1
    buffer_load_dwordx4 a[12:15], v1, s[36:39], s10 offen offset:3072 sc1
    s_add_u32 s15, s15, 4096
    s_and_b32 s15, s15, 0x7fff
    s_add_u32 s10, s12, s15
    buffer_load_dwordx4 a[16:19], v1, s[36:39], s10 offen offset:0 sc1
    buffer_load_dwordx4 a[20:23], v1, s[36:39], s10 offen offset:1024 sc1
    buffer_load_dwordx4 a[24:27], v1, s[36:39], s10 offen offset:2048 sc1
    buffer_load_dwordx4 a[28:31], v1, s[36:39], s10 offen offset:3072 sc1
    s_add_u32 s15, s15, 4096
    s_and_b32 s15, s15, 0x7fff
    s_add_u32 s10, s12, s15
    buffer_load_dwordx4 a[32:35], v1, s[36:39], s10 offen offset:0 sc1
    buffer_load_dwordx4 a[36:39], v1, s[36:39], s10 offen offset:1024 sc1
    buffer_load_dwordx4 a[40:43], v1, s[36:39], s10 offen offset:2048 sc1
    v_lshlrev_b32 v11, 3, v2
    v_add_u32 v11, 149504, v11
    s_waitcnt vmcnt(10)
    s_barrier
    ds_read_b128 a[128:131], v1 offset:0
    ds_read_b128 a[132:135], v1 offset:1024
    ds_read_b128 a[136:139], v1 offset:2048
    ds_read_b128 a[140:143], v1 offset:3072
    ds_read_b128 a[144:147], v1 offset:4096
    ds_read_b128 a[148:151], v1 offset:5120
    ds_read_b128 a[152:155], v1 offset:6144
    s_waitcnt lgkmcnt(3)
    v_mfma_f32_32x32x16_bf16 v[64:79], a[0:3], a[128:131], 0
    ds_read_b128 a[156:159], v1 offset:7168
    buffer_load_dwordx4 a[44:47], v1, s[36:39], s10 offen offset:3072 sc1
    s_add_u32 s15, s15, 4096
    s_and_b32 s15, s15, 0x7fff
    s_add_u32 s10, s12, s15
    v_mfma_f32_32x32x16_bf16 v[80:95], a[0:3], a[132:135], 0
    ds_read_b128 a[128:131], v1 offset:8192
    s_waitcnt vmcnt(10)
    v_mfma_f32_32x32x16_bf16 v[64:79], a[4:7], a[136:139], v[64:79]
    ds_read_b128 a[132:135], v1 offset:9216
    buffer_load_dwordx4 a[48:51], v1, s[36:39], s10 offen offset:0 sc1
    v_mfma_f32_32x32x16_bf16 v[80:95], a[4:7], a[140:143], v[80:95]
    ds_read_b128 a[136:139], v1 offset:10240
    s_waitcnt lgkmcnt(3)
    s_waitcnt vmcnt(10)
    v_mfma_f32_32x32x16_bf16 v[64:79], a[8:11], a[144:147], v[64:79]
    ds_read_b128 a[140:143], v1 offset:11264
    buffer_load_dwordx4 a[52:55], v1, s[36:39], s10 offen offset:1024 sc1
    v_lshlrev_b32 v4, 17, v3
    v_lshl_add_u32 v4, v2, 3, v4
    s_lshl_b32 s9, s8, 8
    s_add_u32 s9, s9, 8650752
    buffer_load_dwordx2 v[16:17], v4, s[36:39], s9 offen sc1
    s_add_u32 s9, s9, 16384
    buffer_load_dwordx2 v[18:19], v4, s[36:39], s9 offen sc1
    s_add_u32 s9, s9, 16384
    v_mfma_f32_32x32x16_bf16 v[80:95], a[8:11], a[148:151], v[80:95]
    ds_read_b128 a[144:147], v1 offset:12288
    s_waitcnt vmcnt(12)
    v_mfma_f32_32x32x16_bf16 v[64:79], a[12:15], a[152:155], v[64:79]
    ds_read_b128 a[148:151], v1 offset:13312
    buffer_load_dwordx4 a[56:59], v1, s[36:39], s10 offen offset:2048 sc1
    v_mfma_f32_32x32x16_bf16 v[80:95], a[12:15], a[156:159], v[80:95]
    ds_read_b128 a[152:155], v1 offset:14336
    s_waitcnt lgkmcnt(3)
    s_waitcnt vmcnt(12)
    v_mfma_f32_32x32x16_bf16 v[64:79], a[16:19], a[128:131], v[64:79]
    ds_read_b128 a[156:159], v1 offset:15360
    buffer_load_dwordx4 a[60:63], v1, s[36:39], s10 offen offset:3072 sc1
    s_add_u32 s15, s15, 4096
    s_and_b32 s15, s15, 0x7fff
    s_add_u32 s10, s12, s15
    buffer_load_dwordx2 v[20:21], v4, s[36:39], s9 offen sc1
    s_add_u32 s9, s9, 16384
    buffer_load_dwordx2 v[22:23], v4, s[36:39], s9 offen sc1
    s_add_u32 s9, s9, 16384
    v_mfma_f32_32x32x16_bf16 v[80:95], a[16:19], a[132:135], v[80:95]
    ds_read_b128 a[128:131], v1 offset:16384
    s_waitcnt vmcnt(14)
    v_mfma_f32_32x32x16_bf16 v[64:79], a[20:23], a[136:139], v[64:79]
    ds_read_b128 a[132:135], v1 offset:17408
    buffer_load_dwordx4 a[64:67], v1, s[36:39], s10 offen offset:0 sc1
    v_mfma_f32_32x32x16_bf16 v[80:95], a[20:23], a[140:143], v[80:95]
    ds_read_b128 a[136:139], v1 offset:18432
    s_waitcnt lgkmcnt(3)
    s_waitcnt vmcnt(14)
    v_mfma_f32_32x32x16_bf16 v[64:79], a[24:27], a[144:147], v[64:79]
    ds_read_b128 a[140:143], v1 offset:19456
    buffer_load_dwordx4 a[68:71], v1, s[36:39], s10 offen offset:1024 sc1
    buffer_load_dwordx2 v[24:25], v4, s[36:39], s9 offen sc1
    s_add_u32 s9, s9, 16384
    buffer_load_dwordx2 v[26:27], v4, s[36:39], s9 offen sc1
    s_add_u32 s9, s9, 16384
    v_mfma_f32_32x32x16_bf16 v[80:95], a[24:27], a[148:151], v[80:95]
    ds_read_b128 a[144:147], v1 offset:20480
    s_waitcnt vmcnt(16)
    v_mfma_f32_32x32x16_bf16 v[64:79], a[28:31], a[152:155], v[64:79]
    ds_read_b128 a[148:151], v1 offset:21504
    buffer_load_dwordx4 a[72:75], v1, s[36:39], s10 offen offset:2048 sc1
    v_mfma_f32_32x32x16_bf16 v[80:95], a[28:31], a[156:159], v[80:95]
    ds_read_b128 a[152:155], v1 offset:22528
    s_waitcnt lgkmcnt(3)
    s_waitcnt vmcnt(16)
    v_mfma_f32_32x32x16_bf16 v[64:79], a[32:35], a[128:131], v[64:79]
    ds_read_b128 a[156:159], v1 offset:23552
    buffer_load_dwordx4 a[76:79], v1, s[36:39], s10 offen offset:3072 sc1
    s_add_u32 s15, s15, 4096
    s_and_b32 s15, s15, 0x7fff
    s_add_u32 s10, s12, s15
    buffer_load_dwordx2 v[28:29], v4, s[36:39], s9 offen sc1
    s_add_u32 s9, s9, 16384
    buffer_load_dwordx2 v[30:31], v4, s[36:39], s9 offen sc1
    v_mfma_f32_32x32x16_bf16 v[80:95], a[32:35], a[132:135], v[80:95]
    ds_read_b128 a[128:131], v1 offset:24576
    s_waitcnt vmcnt(18)
    v_mfma_f32_32x32x16_bf16 v[64:79], a[36:39], a[136:139], v[64:79]
    ds_read_b128 a[132:135], v1 offset:25600
    buffer_load_dwordx4 a[80:83], v1, s[36:39], s10 offen offset:0 sc1
    v_mfma_f32_32x32x16_bf16 v[80:95], a[36:39], a[140:143], v[80:95]
    ds_read_b128 a[136:139], v1 offset:26624
    s_waitcnt lgkmcnt(3)
    s_waitcnt vmcnt(18)
    v_mfma_f32_32x32x16_bf16 v[64:79], a[40:43], a[144:147], v[64:79]
    ds_read_b128 a[140:143], v1 offset:27648
    buffer_load_dwordx4 a[84:87], v1, s[36:39], s10 offen offset:1024 sc1
    v_mfma_f32_32x32x16_bf16 v[80:95], a[40:43], a[148:151], v[80:95]
    ds_read_b128 a[144:147], v1 offset:28672
    s_waitcnt vmcnt(18)
    v_mfma_f32_32x32x16_bf16 v[64:79], a[44:47], a[152:155], v[64:79]
    ds_read_b128 a[148:151], v1 offset:29696
    buffer_load_dwordx4 a[88:91], v1, s[36:39], s10 offen offset:2048 sc1
    v_mfma_f32_32x32x16_bf16 v[80:95], a[44:47], a[156:159], v[80:95]
    ds_read_b128 a[152:155], v1 offset:30720
    s_waitcnt lgkmcnt(3)
    s_waitcnt vmcnt(18)
    v_mfma_f32_32x32x16_bf16 v[64:79], a[48:51], a[128:131], v[64:79]
    ds_read_b128 a[156:159], v1 offset:31744
    buffer_load_dwordx4 a[92:95], v1, s[36:39], s10 offen offset:3072 sc1
    s_add_u32 s15, s15, 4096
    s_and_b32 s15, s15, 0x7fff
    s_add_u32 s10, s12, s15
    v_mfma_f32_32x32x16_bf16 v[80:95], a[48:51], a[132:135], v[80:95]
    ds_read_b128 a[128:131], v1 offset:32768
    s_waitcnt vmcnt(18)
    v_mfma_f32_32x32x16_bf16 v[64:79], a[52:55], a[136:139], v[64:79]
    ds_read_b128 a[132:135], v1 offset:33792
    buffer_load_dwordx4 a[96:99], v1, s[36:39], s10 offen offset:0 sc1
    v_mfma_f32_32x32x16_bf16 v[80:95], a[52:55], a[140:143], v[80:95]
    ds_read_b128 a[136:139], v1 offset:34816
    s_waitcnt lgkmcnt(3)
    s_waitcnt vmcnt(16)
    v_mfma_f32_32x32x16_bf16 v[64:79], a[56:59], a[144:147], v[64:79]
    ds_read_b128 a[140:143], v1 offset:35840
    buffer_load_dwordx4 a[100:103], v1, s[36:39], s10 offen offset:1024 sc1
    v_mfma_f32_32x32x16_bf16 v[80:95], a[56:59], a[148:151], v[80:95]
    ds_read_b128 a[144:147], v1 offset:36864
    s_waitcnt vmcnt(16)
    v_mfma_f32_32x32x16_bf16 v[64:79], a[60:63], a[152:155], v[64:79]
    ds_read_b128 a[148:151], v1 offset:37888
    buffer_load_dwordx4 a[104:107], v1, s[36:39], s10 offen offset:2048 sc1
    v_mfma_f32_32x32x16_bf16 v[80:95], a[60:63], a[156:159], v[80:95]
    ds_read_b128 a[152:155], v1 offset:38912
    s_waitcnt lgkmcnt(3)
    s_waitcnt vmcnt(14)
    v_mfma_f32_32x32x16_bf16 v[64:79], a[64:67], a[128:131], v[64:79]
    ds_read_b128 a[156:159], v1 offset:39936
    buffer_load_dwordx4 a[108:111], v1, s[36:39], s10 offen offset:3072 sc1
    s_add_u32 s15, s15, 4096
    s_and_b32 s15, s15, 0x7fff
    s_add_u32 s10, s12, s15
    v_mfma_f32_32x32x16_bf16 v[80:95], a[64:67], a[132:135], v[80:95]
    ds_read_b128 a[128:131], v1 offset:40960
    s_waitcnt vmcnt(14)
    v_mfma_f32_32x32x16_bf16 v[64:79], a[68:71], a[136:139], v[64:79]
    ds_read_b128 a[132:135], v1 offset:41984
    buffer_load_dwordx4 a[112:115], v1, s[36:39], s10 offen offset:0 sc1
    v_mfma_f32_32x32x16_bf16 v[80:95], a[68:71], a[140:143], v[80:95]
    ds_read_b128 a[136:139], v1 offset:43008
    s_waitcnt lgkmcnt(3)
    s_waitcnt vmcnt(12)
    v_mfma_f32_32x32x16_bf16 v[64:79], a[72:75], a[144:147], v[64:79]
    ds_read_b128 a[140:143], v1 offset:44032
    buffer_load_dwordx4 a[116:119], v1, s[36:39], s10 offen offset:1024 sc1
    v_mfma_f32_32x32x16_bf16 v[80:95], a[72:75], a[148:151], v[80:95]
    ds_read_b128 a[144:147], v1 offset:45056
    s_waitcnt vmcnt(12)
    v_mfma_f32_32x32x16_bf16 v[64:79], a[76:79], a[152:155], v[64:79]
    ds_read_b128 a[148:151], v1 offset:46080
    buffer_load_dwordx4 a[120:123], v1, s[36:39], s10 offen offset:2048 sc1
    v_mfma_f32_32x32x16_bf16 v[80:95], a[76:79], a[156:159], v[80:95]
    ds_read_b128 a[152:155], v1 offset:47104
    s_waitcnt lgkmcnt(3)
    s_waitcnt vmcnt(10)
    v_mfma_f32_32x32x16_bf16 v[64:79], a[80:83], a[128:131], v[64:79]
    ds_read_b128 a[156:159], v1 offset:48128
    buffer_load_dwordx4 a[124:127], v1, s[36:39], s10 offen offset:3072 sc1
    v_add_f32 v16, v16, v24
    v_add_f32 v17, v17, v25
    v_mfma_f32_32x32x16_bf16 v[80:95], a[80:83], a[132:135], v[80:95]
    ds_read_b128 a[128:131], v1 offset:49152
    v_add_f32 v18, v18, v26
    v_add_f32 v19, v19, v27
    v_add_f32 v20, v20, v28
    v_add_f32 v21, v21, v29
    v_add_f32 v22, v22, v30
    s_waitcnt vmcnt(10)
    v_mfma_f32_32x32x16_bf16 v[64:79], a[84:87], a[136:139], v[64:79]
    ds_read_b128 a[132:135], v1 offset:50176
    v_add_f32 v23, v23, v31
    v_add_f32 v16, v16, v20
    v_add_f32 v17, v17, v21
    v_add_f32 v18, v18, v22
    v_add_f32 v19, v19, v23
    v_mfma_f32_32x32x16_bf16 v[80:95], a[84:87], a[140:143], v[80:95]
    ds_read_b128 a[136:139], v1 offset:51200
    s_add_u32 m0, s62, 98304
    s_nop 0
    buffer_load_dwordx4 v160, s[36:39], s46 offen sc1 lds
    s_waitcnt lgkmcnt(3)
    s_waitcnt vmcnt(10)
    v_mfma_f32_32x32x16_bf16 v[64:79], a[88:91], a[144:147], v[64:79]
    ds_read_b128 a[140:143], v1 offset:52224
    v_add_f32 v16, v16, v18
    v_add_f32 v17, v17, v19
    v_mov_b32 v8, v16
    v_mov_b32 v9, v16
    s_nop 1
    v_permlane32_swap_b32 v8, v9
    v_mfma_f32_32x32x16_bf16 v[80:95], a[88:91], a[148:151], v[80:95]
    ds_read_b128 a[144:147], v1 offset:53248
    s_add_u32 m0, s62, 99328
    s_nop 0
    buffer_load_dwordx4 v161, s[36:39], s46 offen sc1 lds
    v_add_f32 v16, v8, v9
    s_waitcnt vmcnt(10)
    v_mfma_f32_32x32x16_bf16 v[64:79], a[92:95], a[152:155], v[64:79]
    ds_read_b128 a[148:151], v1 offset:54272
    v_mov_b32 v8, v17
    v_mov_b32 v9, v17
    s_nop 1
    v_permlane32_swap_b32 v8, v9
    v_add_f32 v17, v8, v9
    v_mul_f32 v6, 0x3b000000, v16
    v_mfma_f32_32x32x16_bf16 v[80:95], a[92:95], a[156:159], v[80:95]
    ds_read_b128 a[152:155], v1 offset:55296
    v_mul_f32 v17, 0x3b000000, v17
    v_fma_f32 v17, -v6, v6, v17
    v_max_f32 v17, 0, v17
    v_add_f32 v17, 0x3727c5ac, v17
    s_waitcnt lgkmcnt(3)
    s_waitcnt vmcnt(9)
    v_mfma_f32_32x32x16_bf16 v[64:79], a[96:99], a[128:131], v[64:79]
    ds_read_b128 a[156:159], v1 offset:56320
    s_add_u32 m0, s62, 100352
    s_nop 0
    buffer_load_dwordx4 v162, s[36:39], s46 offen sc1 lds
    v_rsq_f32 v7, v17
    v_mfma_f32_32x32x16_bf16 v[80:95], a[96:99], a[132:135], v[80:95]
    ds_read_b128 a[128:131], v1 offset:57344
    v_sub_f32 v42, 0, v6
    v_cndmask_b32 v42, 0, v42, s[52:53]
    v_cvt_pk_bf16_f32 v40, v42, v42
    v_lshlrev_b32 v43, 16, v40
    v_sub_f32 v43, v42, v43
    s_waitcnt vmcnt(9)
    v_mfma_f32_32x32x16_bf16 v[64:79], a[100:103], a[136:139], v[64:79]
    ds_read_b128 a[132:135], v1 offset:58368
    s_add_u32 m0, s62, 101376
    s_nop 0
    buffer_load_dwordx4 v163, s[36:39], s46 offen sc1 lds
    s_add_u32 s57, s57, 4096
    s_and_b32 s57, s57, 0x7fff
    s_add_u32 s46, s56, s57
    v_mfma_f32_32x32x16_bf16 v[80:95], a[100:103], a[140:143], v[80:95]
    ds_read_b128 a[136:139], v1 offset:59392
    v_cvt_pk_bf16_f32 v41, v43, 0
    v_mov_b32 v42, 0
    v_mov_b32 v43, 0
    s_lshl_b32 s13, s3, 8
    s_waitcnt lgkmcnt(3)
    s_waitcnt vmcnt(9)
    v_mfma_f32_32x32x16_bf16 v[64:79], a[104:107], a[144:147], v[64:79]
    ds_read_b128 a[140:143], v1 offset:60416
    s_add_u32 s13, s13, 150528
    v_lshl_add_u32 v8, v2, 2, s13
    v_lshl_add_u32 v9, v3, 4, s13
    ds_write_b32 v8, v7
    ds_read_b128 v[48:51], v9 offset:0
    v_mfma_f32_32x32x16_bf16 v[80:95], a[104:107], a[148:151], v[80:95]
    ds_read_b128 a[144:147], v1 offset:61440
    s_add_u32 m0, s62, 102400
    s_nop 0
    buffer_load_dwordx4 v160, s[36:39], s46 offen sc1 lds
    ds_read_b128 v[52:55], v9 offset:32
    s_waitcnt vmcnt(9)
    v_mfma_f32_32x32x16_bf16 v[64:79], a[108:111], a[152:155], v[64:79]
    ds_read_b128 a[148:151], v1 offset:62464
    ds_read_b128 v[56:59], v9 offset:64
    ds_read_b128 v[60:63], v9 offset:96
    v_mul_f32 v13, 0x3fb8aa3b, v7
    v_bfe_u32 v8, v0, 2, 1
    v_bfe_u32 v9, v0, 4, 1
    v_mfma_f32_32x32x16_bf16 v[80:95], a[108:111], a[156:159], v[80:95]
    ds_read_b128 a[152:155], v1 offset:63488
    s_add_u32 m0, s62, 103424
    s_nop 0
    buffer_load_dwordx4 v161, s[36:39], s46 offen sc1 lds
    s_waitcnt lgkmcnt(8)
    s_waitcnt vmcnt(9)
    v_mfma_f32_32x32x16_bf16 v[64:79], a[112:115], a[128:131], v[64:79]
    ds_read_b128 a[156:159], v1 offset:64512
    v_cmp_eq_u32 vcc, v8, v9
    v_mov_b32 v37, 0x3f803f80
    s_nop 0
    v_cndmask_b32 v36, 0, v37, vcc
    v_mov_b32 v37, v36
    v_mov_b32 v38, v36
    v_mfma_f32_32x32x16_bf16 v[80:95], a[112:115], a[132:135], v[80:95]
    ds_read_b64 a[128:129], v11 offset:0
    v_mov_b32 v39, v36
    s_waitcnt vmcnt(8)
    v_mfma_f32_32x32x16_bf16 v[64:79], a[116:119], a[136:139], v[64:79]
    ds_read_b64 a[132:133], v11 offset:256
    s_add_u32 m0, s62, 104448
    s_nop 0
    buffer_load_dwordx4 v162, s[36:39], s46 offen sc1 lds
    v_mfma_f32_32x32x16_bf16 v[80:95], a[116:119], a[140:143], v[80:95]
    ds_read_b128 a[136:139], v5 offset:0
    s_waitcnt lgkmcnt(3)
    s_waitcnt vmcnt(8)
    v_mfma_f32_32x32x16_bf16 v[64:79], a[120:123], a[144:147], v[64:79]
    ds_read_b128 a[140:143], v5 offset:1024
    s_add_u32 m0, s62, 105472
    s_nop 0
    buffer_load_dwordx4 v163, s[36:39], s46 offen sc1 lds
    s_add_u32 s57, s57, 4096
    s_and_b32 s57, s57, 0x7fff
    s_add_u32 s46, s56, s57
    v_mfma_f32_32x32x16_bf16 v[80:95], a[120:123], a[148:151], v[80:95]
    ds_read_b128 a[144:147], v5 offset:2048
    s_waitcnt vmcnt(8)
    v_mfma_f32_32x32x16_bf16 v[64:79], a[124:127], a[152:155], v[64:79]
    ds_read_b128 a[148:151], v5 offset:3072
    v_mfma_f32_32x32x16_bf16 v[80:95], a[124:127], a[156:159], v[80:95]
    ds_read_b128 a[152:155], v5 offset:4096
    s_add_u32 m0, s62, 106496
    s_nop 0
    buffer_load_dwordx4 v160, s[36:39], s46 offen sc1 lds
    s_waitcnt lgkmcnt(3)
    v_mfma_f32_32x32x16_bf16 v[64:79], v[40:43], a[128:131], v[64:79]
    ds_read_b128 a[156:159], v5 offset:5120
    v_mfma_f32_32x32x16_bf16 v[80:95], v[40:43], a[132:135], v[80:95]
    ds_read_b128 a[128:131], v5 offset:6144
    s_add_u32 m0, s62, 107520
    s_nop 0
    buffer_load_dwordx4 v161, s[36:39], s46 offen sc1 lds
    v_mfma_f32_32x32x16_bf16 v[96:111], a[136:139], a[0:3], 0
    ds_read_b128 a[132:135], v5 offset:7168
    s_barrier
    v_mfma_f32_32x32x16_bf16 v[96:111], a[140:143], a[4:7], v[96:111]
    ds_read_b128 a[136:139], v5 offset:8192
    s_mul_i32 s13, s3, 2176
    s_add_u32 s13, s13, 151552
    v_and_b32 v8, 15, v0
    v_lshlrev_b32 v8, 5, v8
    v_lshl_add_u32 v8, v3, 4, v8
    v_add_u32 v8, s13, v8
    v_bfe_u32 v4, v0, 3, 2
    v_mul_u32_u24 v4, 544, v4
    v_bfe_u32 v9, v0, 2, 1
    v_lshl_add_u32 v4, v9, 4, v4
    v_and_b32 v9, 3, v0
    v_lshl_add_u32 v4, v9, 2, v4
    v_add_u32 v4, s13, v4
    s_waitcnt lgkmcnt(3)
    v_mfma_f32_32x32x16_bf16 v[96:111], a[144:147], a[8:11], v[96:111]
    ds_read_b128 a[140:143], v5 offset:9216
    s_add_u32 m0, s62, 108544
    s_nop 0
    buffer_load_dwordx4 v162, s[36:39], s46 offen sc1 lds
    v_mul_f32 v64, v64, v48
    v_mul_f32 v65, v65, v49
    v_mul_f32 v128, 0x3fb8aa3b, v64
    v_mul_f32 v129, 0x3fb8aa3b, v65
    v_min_f32 v128, 0, v128
    v_min_f32 v129, 0, v129
    v_exp_f32 v128, v128
    v_mfma_f32_32x32x16_bf16 v[96:111], a[148:151], a[12:15], v[96:111]
    ds_read_b128 a[144:147], v5 offset:10240
    v_exp_f32 v129, v129
    v_max_f32 v64, 0, v64
    v_max_f32 v65, 0, v65
    v_add_f32 v128, 0x358637bd, v128
    v_add_f32 v129, 0x358637bd, v129
    v_add_f32 v64, v64, v128
    v_add_f32 v65, v65, v129
    v_cvt_pk_bf16_f32 v112, v64, v65
    v_mul_f32 v80, v80, v48
    v_mul_f32 v81, v81, v49
    v_mfma_f32_32x32x16_bf16 v[96:111], a[152:155], a[16:19], v[96:111]
    ds_read_b128 a[148:151], v5 offset:11264
    s_add_u32 m0, s62, 109568
    s_nop 0
    buffer_load_dwordx4 v163, s[36:39], s46 offen sc1 lds
    s_add_u32 s57, s57, 4096
    s_and_b32 s57, s57, 0x7fff
    s_add_u32 s46, s56, s57
    v_cvt_pk_bf16_f32 v120, v80, v81
    v_mul_f32 v66, v66, v50
    v_mul_f32 v67, v67, v51
    v_mul_f32 v128, 0x3fb8aa3b, v66
    v_mfma_f32_32x32x16_bf16 v[96:111], a[156:159], a[20:23], v[96:111]
    ds_read_b128 a[152:155], v5 offset:12288
    v_mul_f32 v129, 0x3fb8aa3b, v67
    v_min_f32 v128, 0, v128
    v_min_f32 v129, 0, v129
    v_exp_f32 v128, v128
    v_exp_f32 v129, v129
    v_max_f32 v66, 0, v66
    v_max_f32 v67, 0, v67
    v_add_f32 v128, 0x358637bd, v128
    s_waitcnt lgkmcnt(3)
    v_mfma_f32_32x32x16_bf16 v[96:111], a[128:131], a[24:27], v[96:111]
    ds_read_b128 a[156:159], v5 offset:13312
    v_add_f32 v129, 0x358637bd, v129
    v_add_f32 v66, v66, v128
    v_add_f32 v67, v67, v129
    v_cvt_pk_bf16_f32 v113, v66, v67
    v_mul_f32 v82, v82, v50
    v_mul_f32 v83, v83, v51
    v_cvt_pk_bf16_f32 v121, v82, v83
    v_mul_f32 v68, v68, v52
    v_mul_f32 v69, v69, v53
    v_mul_f32 v128, 0x3fb8aa3b, v68
    v_mul_f32 v129, 0x3fb8aa3b, v69
    v_mfma_f32_32x32x16_bf16 v[96:111], a[132:135], a[28:31], v[96:111]
    ds_read_b128 a[128:131], v5 offset:14336
    s_add_u32 m0, s63, 0
    s_nop 0
    buffer_load_dwordx4 v160, s[36:39], s46 offen sc1 lds
    v_min_f32 v128, 0, v128
    v_min_f32 v129, 0, v129
    v_exp_f32 v128, v128
    v_exp_f32 v129, v129
    v_max_f32 v68, 0, v68
    v_mfma_f32_32x32x16_bf16 v[96:111], a[136:139], a[32:35], v[96:111]
    ds_read_b128 a[132:135], v5 offset:15360
    v_max_f32 v69, 0, v69
    v_add_f32 v128, 0x358637bd, v128
    v_add_f32 v129, 0x358637bd, v129
    v_add_f32 v68, v68, v128
    v_add_f32 v69, v69, v129
    v_cvt_pk_bf16_f32 v114, v68, v69
    v_mul_f32 v84, v84, v52
    v_mul_f32 v85, v85, v53
    v_cvt_pk_bf16_f32 v122, v84, v85
    v_mul_f32 v70, v70, v54
    v_mul_f32 v71, v71, v55
    v_mfma_f32_32x32x16_bf16 v[96:111], a[140:143], a[36:39], v[96:111]
    ds_read_b128 a[136:139], v5 offset:16384
    s_add_u32 m0, s63, 1024
    s_nop 0
    buffer_load_dwordx4 v161, s[36:39], s46 offen sc1 lds
    v_mul_f32 v128, 0x3fb8aa3b, v70
    v_mul_f32 v129, 0x3fb8aa3b, v71
    v_min_f32 v128, 0, v128
    v_min_f32 v129, 0, v129
    v_exp_f32 v128, v128
    s_waitcnt lgkmcnt(3)
    v_mfma_f32_32x32x16_bf16 v[96:111], a[144:147], a[40:43], v[96:111]
    ds_read_b128 a[140:143], v5 offset:17408
    v_exp_f32 v129, v129
    v_max_f32 v70, 0, v70
    v_max_f32 v71, 0, v71
    v_add_f32 v128, 0x358637bd, v128
    v_add_f32 v129, 0x358637bd, v129
    v_add_f32 v70, v70, v128
    v_add_f32 v71, v71, v129
    v_cvt_pk_bf16_f32 v115, v70, v71
    v_mul_f32 v86, v86, v54
    v_mul_f32 v87, v87, v55
    v_mfma_f32_32x32x16_bf16 v[96:111], a[148:151], a[44:47], v[96:111]
    ds_read_b128 a[144:147], v5 offset:18432
    v_cvt_pk_bf16_f32 v123, v86, v87
    v_mul_f32 v72, v72, v56
    v_mul_f32 v73, v73, v57
    v_mul_f32 v128, 0x3fb8aa3b, v72
    v_mul_f32 v129, 0x3fb8aa3b, v73
    v_min_f32 v128, 0, v128
    v_min_f32 v129, 0, v129
    v_exp_f32 v128, v128
    v_exp_f32 v129, v129
    v_mfma_f32_32x32x16_bf16 v[96:111], a[152:155], a[48:51], v[96:111]
    ds_read_b128 a[148:151], v5 offset:19456
    s_add_u32 m0, s63, 2048
    s_nop 0
    buffer_load_dwordx4 v162, s[36:39], s46 offen sc1 lds
    v_max_f32 v72, 0, v72
    v_max_f32 v73, 0, v73
    v_add_f32 v128, 0x358637bd, v128
    v_add_f32 v129, 0x358637bd, v129
    v_add_f32 v72, v72, v128
    v_add_f32 v73, v73, v129
    v_cvt_pk_bf16_f32 v116, v72, v73
    v_mfma_f32_32x32x16_bf16 v[96:111], a[156:159], a[52:55], v[96:111]
    ds_read_b128 a[152:155], v5 offset:20480
    v_mul_f32 v88, v88, v56
    v_mul_f32 v89, v89, v57
    v_cvt_pk_bf16_f32 v124, v88, v89
    v_mul_f32 v74, v74, v58
    v_mul_f32 v75, v75, v59
    v_mul_f32 v128, 0x3fb8aa3b, v74
    v_mul_f32 v129, 0x3fb8aa3b, v75
    v_min_f32 v128, 0, v128
    v_min_f32 v129, 0, v129
    v_exp_f32 v128, v128
    s_waitcnt lgkmcnt(3)
    v_mfma_f32_32x32x16_bf16 v[96:111], a[128:131], a[56:59], v[96:111]
    ds_read_b128 a[156:159], v5 offset:21504
    s_add_u32 m0, s63, 3072
    s_nop 0
    buffer_load_dwordx4 v163, s[36:39], s46 offen sc1 lds
    s_add_u32 s57, s57, 4096
    s_and_b32 s57, s57, 0x7fff
    s_add_u32 s46, s56, s57
    v_exp_f32 v129, v129
    v_max_f32 v74, 0, v74
    v_max_f32 v75, 0, v75
    v_mfma_f32_32x32x16_bf16 v[96:111], a[132:135], a[60:63], v[96:111]
    ds_read_b128 a[128:131], v5 offset:22528
    v_add_f32 v128, 0x358637bd, v128
    v_add_f32 v129, 0x358637bd, v129
    v_add_f32 v74, v74, v128
    v_add_f32 v75, v75, v129
    v_cvt_pk_bf16_f32 v117, v74, v75
    v_mul_f32 v90, v90, v58
    v_mul_f32 v91, v91, v59
    v_cvt_pk_bf16_f32 v125, v90, v91
    v_mul_f32 v76, v76, v60
    v_mul_f32 v77, v77, v61
    v_mul_f32 v128, 0x3fb8aa3b, v76
    v_mfma_f32_32x32x16_bf16 v[96:111], a[136:139], a[64:67], v[96:111]
    ds_read_b128 a[132:135], v5 offset:23552
    v_mul_f32 v129, 0x3fb8aa3b, v77
    v_min_f32 v128, 0, v128
    v_min_f32 v129, 0, v129
    v_exp_f32 v128, v128
    v_exp_f32 v129, v129
    v_max_f32 v76, 0, v76
    v_max_f32 v77, 0, v77
    v_add_f32 v128, 0x358637bd, v128
    v_add_f32 v129, 0x358637bd, v129
    v_mfma_f32_32x32x16_bf16 v[96:111], a[140:143], a[68:71], v[96:111]
    ds_read_b128 a[136:139], v5 offset:24576
    s_add_u32 m0, s63, 4096
    s_nop 0
    buffer_load_dwordx4 v160, s[36:39], s46 offen sc1 lds
    v_add_f32 v76, v76, v128
    v_add_f32 v77, v77, v129
    v_cvt_pk_bf16_f32 v118, v76, v77
    v_mul_f32 v92, v92, v60
    v_mul_f32 v93, v93, v61
    v_cvt_pk_bf16_f32 v126, v92, v93
    s_waitcnt lgkmcnt(3)
    v_mfma_f32_32x32x16_bf16 v[96:111], a[144:147], a[72:75], v[96:111]
    ds_read_b128 a[140:143], v5 offset:25600
    v_mul_f32 v78, v78, v62
    v_mul_f32 v79, v79, v63
    v_mul_f32 v128, 0x3fb8aa3b, v78
    v_mul_f32 v129, 0x3fb8aa3b, v79
    v_min_f32 v128, 0, v128
    v_min_f32 v129, 0, v129
    v_exp_f32 v128, v128
    v_exp_f32 v129, v129
    v_max_f32 v78, 0, v78
    v_mfma_f32_32x32x16_bf16 v[96:111], a[148:151], a[76:79], v[96:111]
    ds_read_b128 a[144:147], v5 offset:26624
    s_add_u32 m0, s63, 5120
    s_nop 0
    buffer_load_dwordx4 v161, s[36:39], s46 offen sc1 lds
    v_max_f32 v79, 0, v79
    v_add_f32 v128, 0x358637bd, v128
    v_add_f32 v129, 0x358637bd, v129
    v_add_f32 v78, v78, v128
    v_add_f32 v79, v79, v129
    v_cvt_pk_bf16_f32 v119, v78, v79
    v_mul_f32 v94, v94, v62
    v_mfma_f32_32x32x16_bf16 v[96:111], a[152:155], a[80:83], v[96:111]
    ds_read_b128 a[148:151], v5 offset:27648
    v_mul_f32 v95, v95, v63
    v_cvt_pk_bf16_f32 v127, v94, v95
    v_mfma_f32_32x32x16_bf16 v[144:159], v[112:115], v[120:123], 0
    v_mfma_f32_16x16x32_bf16 v[44:47], v[36:39], v[112:115], 0
    v_mfma_f32_32x32x16_bf16 v[144:159], v[116:119], v[124:127], v[144:159]
    v_mfma_f32_16x16x32_bf16 v[44:47], v[36:39], v[116:119], v[44:47]
    s_mul_i32 s14, s45, 2176
    s_add_u32 s14, s14, 7929856
    s_lshl_b32 s13, s3, 8
    v_lshl_add_u32 v10, v0, 2, s13
    v_add_u32 v9, 151552, v10
    v_mfma_f32_32x32x16_bf16 v[96:111], a[156:159], a[84:87], v[96:111]
    ds_read_b128 a[152:155], v5 offset:28672
    s_waitcnt lgkmcnt(3)
    v_mfma_f32_32x32x16_bf16 v[96:111], a[128:131], a[88:91], v[96:111]
    ds_read_b128 a[156:159], v5 offset:29696
    s_add_u32 m0, s63, 6144
    s_nop 0
    buffer_load_dwordx4 v162, s[36:39], s46 offen sc1 lds
    v_mfma_f32_32x32x16_bf16 v[96:111], a[132:135], a[92:95], v[96:111]
    ds_read_b128 a[128:131], v5 offset:30720
    s_mov_b32 exec_lo, 0x0000ffff
    s_mov_b32 exec_hi, 0x0000ffff
    ds_write_b128 v8, v[144:147]
    ds_write_b128 v8, v[148:151] offset:544
    s_mov_b32 exec_lo, 0xffff0000
    s_mov_b32 exec_hi, 0xffff0000
    ds_write_b128 v8, v[152:155] offset:1088
    ds_write_b128 v8, v[156:159] offset:1632
    s_mov_b64 exec, -1
    ds_write_b32 v4, v44 offset:512
    v_mfma_f32_32x32x16_bf16 v[96:111], a[136:139], a[96:99], v[96:111]
    ds_read_b128 a[132:135], v5 offset:31744
    s_add_u32 m0, s63, 7168
    s_nop 0
    buffer_load_dwordx4 v163, s[36:39], s46 offen sc1 lds
    s_add_u32 s57, s57, 4096
    s_and_b32 s57, s57, 0x7fff
    s_add_u32 s46, s56, s57
    s_waitcnt lgkmcnt(0)
    s_barrier
    ds_read_b32 v16, v9 offset:0
    ds_read_b32 v17, v9 offset:2176
    ds_read_b32 v18, v9 offset:4352
    ds_read_b32 v19, v9 offset:6528
    ds_read_b32 v20, v9 offset:1024
    ds_read_b32 v21, v9 offset:3200
    ds_read_b32 v22, v9 offset:5376
    ds_read_b32 v23, v9 offset:7552
    ds_read_b32 v24, v9 offset:2048
    ds_read_b32 v25, v9 offset:4224
    ds_read_b32 v26, v9 offset:6400
    ds_read_b32 v27, v9 offset:8576
    v_mfma_f32_32x32x16_bf16 v[96:111], a[140:143], a[100:103], v[96:111]
    ds_read_b64 a[136:137], v11 offset:512
    v_mfma_f32_32x32x16_bf16 v[96:111], a[144:147], a[104:107], v[96:111]
    s_waitcnt lgkmcnt(1)
    v_add_f32 v16, v16, v17
    v_add_f32 v18, v18, v19
    v_add_f32 v20, v20, v21
    v_add_f32 v22, v22, v23
    v_add_f32 v24, v24, v25
    v_add_f32 v26, v26, v27
    v_add_f32 v16, v16, v18
    v_add_f32 v20, v20, v22
    v_add_f32 v24, v24, v26
    buffer_atomic_add_f32 v16, v10, s[36:39], s14 offen sc1
    buffer_atomic_add_f32 v20, v10, s[36:39], s14 offen offset:1024 sc1
    s_cmp_eq_u32 s3, 0
    s_cselect_b32 exec_lo, -1, 1
    s_mov_b32 exec_hi, 0
    s_cselect_b32 s15, 0, 0x10000000
    s_add_u32 s14, s14, s15
    buffer_atomic_add_f32 v24, v10, s[36:39], s14 offen offset:2048 sc1
    s_mov_b64 exec, -1
    v_mfma_f32_32x32x16_bf16 v[96:111], a[148:151], a[108:111], v[96:111]
    s_add_u32 m0, s63, 8192
    s_nop 0
    buffer_load_dwordx4 v160, s[36:39], s46 offen sc1 lds
    v_mfma_f32_32x32x16_bf16 v[96:111], a[152:155], a[112:115], v[96:111]
    v_mfma_f32_32x32x16_bf16 v[96:111], a[156:159], a[116:119], v[96:111]
    s_add_u32 m0, s63, 9216
    s_nop 0
    buffer_load_dwordx4 v161, s[36:39], s46 offen sc1 lds
    s_waitcnt lgkmcnt(0)
    v_mfma_f32_32x32x16_bf16 v[96:111], a[128:131], a[120:123], v[96:111]
    v_mfma_f32_32x32x16_bf16 v[96:111], a[132:135], a[124:127], v[96:111]
    v_mfma_f32_32x32x16_bf16 v[96:111], a[136:139], v[40:43], v[96:111]
    s_add_u32 m0, s63, 10240
    s_nop 0
    buffer_load_dwordx4 v162, s[36:39], s46 offen sc1 lds
    s_nop 8
    v_mul_f32 v128, v96, v13
    v_mul_f32 v129, v97, v13
    v_mul_f32 v96, v96, v7
    v_mul_f32 v97, v97, v7
    v_min_f32 v128, 0, v128
    v_min_f32 v129, 0, v129
    v_exp_f32 v128, v128
    v_exp_f32 v129, v129
    v_max_f32 v96, 0, v96
    v_max_f32 v97, 0, v97
    v_add_f32 v128, 0x358637bd, v128
    v_add_f32 v129, 0x358637bd, v129
    v_add_f32 v96, v96, v128
    v_add_f32 v97, v97, v129
    v_cvt_pk_bf16_f32 v136, v96, v97
    v_mul_f32 v128, v98, v13
    v_mul_f32 v129, v99, v13
    v_mul_f32 v98, v98, v7
    v_mul_f32 v99, v99, v7
    v_min_f32 v128, 0, v128
    v_min_f32 v129, 0, v129
    v_exp_f32 v128, v128
    v_exp_f32 v129, v129
    v_max_f32 v98, 0, v98
    v_max_f32 v99, 0, v99
    v_add_f32 v128, 0x358637bd, v128
    v_add_f32 v129, 0x358637bd, v129
    v_add_f32 v98, v98, v128
    v_add_f32 v99, v99, v129
    v_cvt_pk_bf16_f32 v137, v98, v99
    s_waitcnt vmcnt(3)
    s_barrier
    s_cmp_lg_u32 s3, 0
    s_cbranch_scc1 kvs17_a
    s_lshl_b32 s4, s44, 8
    s_add_u32 s4, s4, 7819264
    v_mov_b32 v8, 1
    s_mov_b64 exec, 1
    buffer_atomic_add v8, off, s[36:39], s4 sc0 sc1
    s_mov_b64 exec, -1
kvs17_a:
    s_lshl_b32 s13, s44, 2
    s_add_u32 s13, s13, s3
    s_lshl_b32 s13, s13, 15
    s_lshl_b32 s14, s45, 11
    s_add_u32 s13, s13, s14
    s_add_u32 s13, s13, 19922944
    v_mul_f32 v128, v100, v13
    v_mul_f32 v129, v101, v13
    v_mul_f32 v100, v100, v7
    v_mul_f32 v101, v101, v7
    v_min_f32 v128, 0, v128
    v_min_f32 v129, 0, v129
    v_exp_f32 v128, v128
    v_exp_f32 v129, v129
    v_max_f32 v100, 0, v100
    v_max_f32 v101, 0, v101
    v_add_f32 v128, 0x358637bd, v128
    v_add_f32 v129, 0x358637bd, v129
    v_add_f32 v100, v100, v128
    v_add_f32 v101, v101, v129
    v_cvt_pk_bf16_f32 v138, v100, v101
    v_mul_f32 v128, v102, v13
    v_mul_f32 v129, v103, v13
    v_mul_f32 v102, v102, v7
    v_mul_f32 v103, v103, v7
    v_min_f32 v128, 0, v128
    v_min_f32 v129, 0, v129
    v_exp_f32 v128, v128
    v_exp_f32 v129, v129
    v_max_f32 v102, 0, v102
    v_max_f32 v103, 0, v103
    v_add_f32 v128, 0x358637bd, v128
    v_add_f32 v129, 0x358637bd, v129
    v_add_f32 v102, v102, v128
    v_add_f32 v103, v103, v129
    v_cvt_pk_bf16_f32 v139, v102, v103
    v_mul_f32 v128, v104, v13
    v_mul_f32 v129, v105, v13
    v_mul_f32 v104, v104, v7
    v_mul_f32 v105, v105, v7
    v_min_f32 v128, 0, v128
    v_min_f32 v129, 0, v129
    v_exp_f32 v128, v128
    v_exp_f32 v129, v129
    v_max_f32 v104, 0, v104
    v_max_f32 v105, 0, v105
    v_add_f32 v128, 0x358637bd, v128
    v_add_f32 v129, 0x358637bd, v129
    v_add_f32 v104, v104, v128
    v_add_f32 v105, v105, v129
    v_cvt_pk_bf16_f32 v140, v104, v105
    v_mul_f32 v128, v106, v13
    v_mul_f32 v129, v107, v13
    v_mul_f32 v106, v106, v7
    v_mul_f32 v107, v107, v7
    v_min_f32 v128, 0, v128
    v_min_f32 v129, 0, v129
    v_exp_f32 v128, v128
    v_exp_f32 v129, v129
    v_max_f32 v106, 0, v106
    v_max_f32 v107, 0, v107
    v_add_f32 v128, 0x358637bd, v128
    v_add_f32 v129, 0x358637bd, v129
    v_add_f32 v106, v106, v128
    v_add_f32 v107, v107, v129
    v_cvt_pk_bf16_f32 v141, v106, v107
    v_mul_f32 v128, v108, v13
    v_mul_f32 v129, v109, v13
    v_mul_f32 v108, v108, v7
    v_mul_f32 v109, v109, v7
    v_min_f32 v128, 0, v128
    v_min_f32 v129, 0, v129
    v_exp_f32 v128, v128
    v_exp_f32 v129, v129
    v_max_f32 v108, 0, v108
    v_max_f32 v109, 0, v109
    v_add_f32 v128, 0x358637bd, v128
    v_add_f32 v129, 0x358637bd, v129
    v_add_f32 v108, v108, v128
    v_add_f32 v109, v109, v129
    v_cvt_pk_bf16_f32 v142, v108, v109
    v_mul_f32 v128, v110, v13
    v_mul_f32 v129, v111, v13
    v_mul_f32 v110, v110, v7
    v_mul_f32 v111, v111, v7
    v_min_f32 v128, 0, v128
    v_min_f32 v129, 0, v129
    v_exp_f32 v128, v128
    v_exp_f32 v129, v129
    v_max_f32 v110, 0, v110
    v_max_f32 v111, 0, v111
    v_add_f32 v128, 0x358637bd, v128
    v_add_f32 v129, 0x358637bd, v129
    v_add_f32 v110, v110, v128
    v_add_f32 v111, v111, v129
    v_cvt_pk_bf16_f32 v143, v110, v111
    buffer_store_dwordx4 v[136:139], v1, s[36:39], s13 offen sc1
    buffer_store_dwordx4 v[140:143], v1, s[36:39], s13 offen offset:1024 sc1
    v_add_u32 v164, s62, v5
    v_add_u32 v165, s63, v1
    s_waitcnt vmcnt(2)
    ds_read_b128 a[0:3], v164 offset:32768
    ds_read_b128 a[4:7], v164 offset:33792
    ds_read_b128 a[8:11], v164 offset:34816
    ds_read_b128 a[12:15], v164 offset:35840
    ds_read_b128 a[16:19], v164 offset:36864
    ds_read_b128 a[20:23], v164 offset:37888
    ds_read_b128 a[24:27], v164 offset:38912
    ds_read_b128 a[28:31], v164 offset:39936
    ds_read_b128 a[32:35], v164 offset:40960
    ds_read_b128 a[36:39], v164 offset:41984
    ds_read_b128 a[40:43], v164 offset:43008
    ds_read_b128 a[44:47], v164 offset:44032
    ds_read_b128 a[48:51], v165 offset:0
    ds_read_b128 a[52:55], v165 offset:1024
    ds_read_b128 a[56:59], v165 offset:2048
    ds_read_b128 a[60:63], v165 offset:3072
    ds_read_b128 a[64:67], v165 offset:4096
    ds_read_b128 a[68:71], v165 offset:5120
    ds_read_b128 a[72:75], v165 offset:6144
    ds_read_b128 a[76:79], v165 offset:7168
    ds_read_b128 a[80:83], v165 offset:8192
    ds_read_b128 a[84:87], v165 offset:9216
    ds_read_b128 a[88:91], v165 offset:10240
    s_waitcnt lgkmcnt(0)
    s_cmp_lg_u32 s3, 0
    s_cbranch_scc1 kvs17_b
    s_waitcnt vmcnt(2)
    v_readfirstlane_b32 s5, v8
    s_nop 0
    s_cmp_lg_u32 s5, 15
    s_cbranch_scc1 kvs17_b
    s_mov_b32 s4, 7823360
    v_mov_b32 v8, 1
    v_lshlrev_b32 v9, 8, v0
    s_mov_b64 exec, 0xffff
    buffer_atomic_add v8, v9, s[36:39], s4 offen sc1
    s_mov_b64 exec, -1
kvs17_b:
    s_waitcnt vmcnt(0)
    s_barrier
    s_cmp_lg_u32 s3, 0
    s_cbranch_scc1 sig18
    s_lshl_b32 s4, s44, 8
    s_add_u32 s4, s4, 7827456
    v_mov_b32 v8, 1
    v_mov_b32 v9, 0
    s_mov_b64 exec, 1
    buffer_atomic_add v8, v9, s[36:39], s4 offen sc1
    s_mov_b64 exec, -1
sig18:
    s_sub_u32 s4, s3, 1
    s_cmp_ge_u32 s4, 2
    s_cbranch_scc1 bys19
    s_lshl_b32 s4, s4, 14
    s_add_u32 s51, s48, s4
    s_add_u32 s51, s51, 0
    s_add_u32 s4, s4, 0
    s_mov_b32 m0, s4
    s_nop 0
    buffer_load_dwordx4 v1, s[36:39], s51 offen offset:0 sc1 lds
    buffer_load_dwordx4 v1, s[36:39], s51 offen offset:1024 sc1 lds
    buffer_load_dwordx4 v1, s[36:39], s51 offen offset:2048 sc1 lds
    buffer_load_dwordx4 v1, s[36:39], s51 offen offset:3072 sc1 lds
    s_add_u32 s51, s51, 4096
    s_add_u32 s4, s4, 4096
    s_mov_b32 m0, s4
    s_nop 0
    buffer_load_dwordx4 v1, s[36:39], s51 offen offset:0 sc1 lds
    buffer_load_dwordx4 v1, s[36:39], s51 offen offset:1024 sc1 lds
    buffer_load_dwordx4 v1, s[36:39], s51 offen offset:2048 sc1 lds
    buffer_load_dwordx4 v1, s[36:39], s51 offen offset:3072 sc1 lds
    s_add_u32 s51, s51, 4096
    s_add_u32 s4, s4, 4096
    s_mov_b32 m0, s4
    s_nop 0
    buffer_load_dwordx4 v1, s[36:39], s51 offen offset:0 sc1 lds
    buffer_load_dwordx4 v1, s[36:39], s51 offen offset:1024 sc1 lds
    buffer_load_dwordx4 v1, s[36:39], s51 offen offset:2048 sc1 lds
    buffer_load_dwordx4 v1, s[36:39], s51 offen offset:3072 sc1 lds
    s_add_u32 s51, s51, 4096
    s_add_u32 s4, s4, 4096
    s_mov_b32 m0, s4
    s_nop 0
    buffer_load_dwordx4 v1, s[36:39], s51 offen offset:0 sc1 lds
    buffer_load_dwordx4 v1, s[36:39], s51 offen offset:1024 sc1 lds
    buffer_load_dwordx4 v1, s[36:39], s51 offen offset:2048 sc1 lds
    buffer_load_dwordx4 v1, s[36:39], s51 offen offset:3072 sc1 lds
bys19:
    buffer_load_dwordx4 a[92:95], v163, s[36:39], s46 offen sc1
    s_add_u32 s57, s57, 4096
    s_and_b32 s57, s57, 0x7fff
    s_add_u32 s46, s56, s57
    buffer_load_dwordx4 a[96:99], v160, s[36:39], s46 offen sc1
    buffer_load_dwordx4 a[100:103], v161, s[36:39], s46 offen sc1
    buffer_load_dwordx4 a[104:107], v162, s[36:39], s46 offen sc1
    buffer_load_dwordx4 a[108:111], v163, s[36:39], s46 offen sc1
    s_add_u32 s57, s57, 4096
    s_and_b32 s57, s57, 0x7fff
    s_add_u32 s46, s56, s57
    buffer_load_dwordx4 a[112:115], v160, s[36:39], s46 offen sc1
    buffer_load_dwordx4 a[116:119], v161, s[36:39], s46 offen sc1
    buffer_load_dwordx4 a[120:123], v162, s[36:39], s46 offen sc1
    buffer_load_dwordx4 a[124:127], v163, s[36:39], s46 offen sc1
    s_lshl_b32 s6, s44, 2
    s_lshr_b32 s7, s45, 2
    s_add_u32 s6, s6, s7
    s_and_b32 s7, s45, 3
    s_lshl_b32 s11, s6, 15
    s_lshl_b32 s12, s7, 13
    s_add_u32 s11, s11, s12
    s_lshl_b32 s12, s3, 11
    s_add_u32 s11, s11, s12
    s_add_u32 s12, s11, 11534336
    s_add_u32 s11, s11, 15728640
    buffer_load_dwordx4 v[120:123], v1, s[36:39], s12 offen sc1
    buffer_load_dwordx4 v[124:127], v1, s[36:39], s12 offen offset:1024 sc1
    s_lshl_b32 s13, s7, 2
    s_add_u32 s13, s13, s3
    s_lshl_b32 s13, s13, 14
    s_lshl_b32 s14, s6, 8
    s_add_u32 s13, s13, s14
    s_add_u32 s13, s13, 9175040
    v_min_u32 v7, 16, v2
    v_lshlrev_b32 v7, 5, v7
    v_lshl_add_u32 v7, v3, 4, v7
    s_mul_i32 s8, s3, 8704
    s_add_u32 s8, s8, 7929856
    s_lshl_b32 s9, s6, 15
    s_lshl_b32 s10, s3, 13
    s_add_u32 s9, s9, s10
    s_add_u32 s9, s9, 19922944
    s_lshl_b32 s10, s44, 1
    s_lshr_b32 s12, s45, 2
    s_add_u32 s10, s10, s12
    s_and_b32 s10, s10, 7
    s_cmp_lg_u32 s3, 0
    s_cbranch_scc1 wt20_done
    s_lshl_b32 s4, s44, 8
    s_add_u32 s4, s4, 7823360
    v_mul_u32_u24 v9, 4096, v0
    s_mov_b64 exec, 3
    s_mov_b32 s5, 0
wt20_loop:
    buffer_load_dword v8, v9, s[36:39], s4 offen sc1
    s_add_u32 s5, s5, 1
    s_waitcnt vmcnt(0)
    v_cmp_gt_u32 vcc, 16, v8
    s_cmp_gt_u32 s5, 0x40000
    s_cbranch_scc1 wt20_out
    s_nop 1
    s_cbranch_vccnz wt20_loop
wt20_out:
    s_mov_b64 exec, -1
wt20_done:
    s_barrier
    s_mul_i32 s12, s10, 1088
    s_add_u32 s12, s12, s8
    buffer_load_dwordx4 v[16:19], v7, s[36:39], s12 offen sc1
    buffer_load_dwordx4 v[20:23], v7, s[36:39], s12 offen offset:544 sc1
    s_lshl_b32 s14, s10, 10
    s_add_u32 s14, s14, s9
    buffer_load_dwordx4 a[128:131], v1, s[36:39], s14 offen sc1
    s_add_u32 s10, s10, 1
    s_and_b32 s10, s10, 7
    s_mul_i32 s12, s10, 1088
    s_add_u32 s12, s12, s8
    buffer_load_dwordx4 v[24:27], v7, s[36:39], s12 offen sc1
    buffer_load_dwordx4 v[28:31], v7, s[36:39], s12 offen offset:544 sc1
    s_lshl_b32 s14, s10, 10
    s_add_u32 s14, s14, s9
    buffer_load_dwordx4 a[132:135], v1, s[36:39], s14 offen sc1
    s_add_u32 s10, s10, 1
    s_and_b32 s10, s10, 7
    s_mul_i32 s12, s10, 1088
    s_add_u32 s12, s12, s8
    buffer_load_dwordx4 v[32:35], v7, s[36:39], s12 offen sc1
    buffer_load_dwordx4 v[36:39], v7, s[36:39], s12 offen offset:544 sc1
    s_lshl_b32 s14, s10, 10
    s_add_u32 s14, s14, s9
    buffer_load_dwordx4 a[136:139], v1, s[36:39], s14 offen sc1
    s_add_u32 s10, s10, 1
    s_and_b32 s10, s10, 7
    s_mul_i32 s12, s10, 1088
    s_add_u32 s12, s12, s8
    buffer_load_dwordx4 v[40:43], v7, s[36:39], s12 offen sc1
    buffer_load_dwordx4 v[44:47], v7, s[36:39], s12 offen offset:544 sc1
    s_lshl_b32 s14, s10, 10
    s_add_u32 s14, s14, s9
    buffer_load_dwordx4 a[140:143], v1, s[36:39], s14 offen sc1
    s_add_u32 s10, s10, 1
    s_and_b32 s10, s10, 7
    s_mul_i32 s12, s10, 1088
    s_add_u32 s12, s12, s8
    buffer_load_dwordx4 v[48:51], v7, s[36:39], s12 offen sc1
    buffer_load_dwordx4 v[52:55], v7, s[36:39], s12 offen offset:544 sc1
    s_lshl_b32 s14, s10, 10
    s_add_u32 s14, s14, s9
    buffer_load_dwordx4 a[144:147], v1, s[36:39], s14 offen sc1
    s_add_u32 s10, s10, 1
    s_and_b32 s10, s10, 7
    s_mul_i32 s12, s10, 1088
    s_add_u32 s12, s12, s8
    buffer_load_dwordx4 v[56:59], v7, s[36:39], s12 offen sc1
    buffer_load_dwordx4 v[60:63], v7, s[36:39], s12 offen offset:544 sc1
    s_lshl_b32 s14, s10, 10
    s_add_u32 s14, s14, s9
    buffer_load_dwordx4 a[148:151], v1, s[36:39], s14 offen sc1
    s_add_u32 s10, s10, 1
    s_and_b32 s10, s10, 7
    s_lshl_b32 s4, s3, 10
    s_add_u32 s4, s4, 98304
    v_add_u32 v4, s4, v1
    v_add_u32 v6, 98304, v1
    s_waitcnt vmcnt(15)
    s_mul_i32 s12, s10, 1088
    s_add_u32 s12, s12, s8
    buffer_load_dwordx4 v[64:67], v7, s[36:39], s12 offen sc1
    buffer_load_dwordx4 v[68:71], v7, s[36:39], s12 offen offset:544 sc1
    s_lshl_b32 s14, s10, 10
    s_add_u32 s14, s14, s9
    buffer_load_dwordx4 a[152:155], v1, s[36:39], s14 offen sc1
    s_add_u32 s10, s10, 1
    s_and_b32 s10, s10, 7
    v_cvt_pk_bf16_f32 v8, v16, v17
    v_cvt_pk_bf16_f32 v9, v18, v19
    v_cvt_pk_bf16_f32 v10, v20, v21
    v_cvt_pk_bf16_f32 v11, v22, v23
    s_nop 1
    v_mfma_f32_32x32x16_bf16 v[144:159], v[8:11], a[128:131], 0
    s_waitcnt vmcnt(15)
    s_mul_i32 s12, s10, 1088
    s_add_u32 s12, s12, s8
    buffer_load_dwordx4 v[72:75], v7, s[36:39], s12 offen sc1
    buffer_load_dwordx4 v[76:79], v7, s[36:39], s12 offen offset:544 sc1
    s_lshl_b32 s14, s10, 10
    s_add_u32 s14, s14, s9
    buffer_load_dwordx4 a[156:159], v1, s[36:39], s14 offen sc1
    v_cvt_pk_bf16_f32 v12, v24, v25
    v_cvt_pk_bf16_f32 v13, v26, v27
    v_cvt_pk_bf16_f32 v14, v28, v29
    v_cvt_pk_bf16_f32 v15, v30, v31
    s_nop 1
    v_mfma_f32_32x32x16_bf16 v[160:175], v[12:15], a[132:135], 0
    s_waitcnt vmcnt(15)
    v_cvt_pk_bf16_f32 v8, v32, v33
    v_cvt_pk_bf16_f32 v9, v34, v35
    v_cvt_pk_bf16_f32 v10, v36, v37
    v_cvt_pk_bf16_f32 v11, v38, v39
    v_add_f32 v152, 0x358637bd, v152
    v_rcp_f32 v152, v152
    s_nop 0
    v_mul_f32 v144, v144, v152
    v_mul_f32 v145, v145, v152
    v_mul_f32 v146, v146, v152
    v_mul_f32 v147, v147, v152
    v_mul_f32 v148, v148, v152
    v_mul_f32 v149, v149, v152
    v_mul_f32 v150, v150, v152
    v_mul_f32 v151, v151, v152
    v_cvt_pk_bf16_f32 v112, v144, v145
    v_cvt_pk_bf16_f32 v113, v146, v147
    v_cvt_pk_bf16_f32 v114, v148, v149
    v_cvt_pk_bf16_f32 v115, v150, v151
    ds_write_b128 v4, v[112:115] offset:0
    v_mfma_f32_32x32x16_bf16 v[144:159], v[8:11], a[136:139], 0
    s_waitcnt vmcnt(12)
    v_cvt_pk_bf16_f32 v12, v40, v41
    v_cvt_pk_bf16_f32 v13, v42, v43
    v_cvt_pk_bf16_f32 v14, v44, v45
    v_cvt_pk_bf16_f32 v15, v46, v47
    v_add_f32 v168, 0x358637bd, v168
    v_rcp_f32 v168, v168
    s_nop 0
    v_mul_f32 v160, v160, v168
    v_mul_f32 v161, v161, v168
    v_mul_f32 v162, v162, v168
    v_mul_f32 v163, v163, v168
    v_mul_f32 v164, v164, v168
    v_mul_f32 v165, v165, v168
    v_mul_f32 v166, v166, v168
    v_mul_f32 v167, v167, v168
    v_cvt_pk_bf16_f32 v116, v160, v161
    v_cvt_pk_bf16_f32 v117, v162, v163
    v_cvt_pk_bf16_f32 v118, v164, v165
    v_cvt_pk_bf16_f32 v119, v166, v167
    ds_write_b128 v4, v[116:119] offset:4096
    v_mfma_f32_32x32x16_bf16 v[160:175], v[12:15], a[140:143], 0
    s_waitcnt vmcnt(9)
    v_cvt_pk_bf16_f32 v8, v48, v49
    v_cvt_pk_bf16_f32 v9, v50, v51
    v_cvt_pk_bf16_f32 v10, v52, v53
    v_cvt_pk_bf16_f32 v11, v54, v55
    v_add_f32 v152, 0x358637bd, v152
    v_rcp_f32 v152, v152
    s_nop 0
    v_mul_f32 v144, v144, v152
    v_mul_f32 v145, v145, v152
    v_mul_f32 v146, v146, v152
    v_mul_f32 v147, v147, v152
    v_mul_f32 v148, v148, v152
    v_mul_f32 v149, v149, v152
    v_mul_f32 v150, v150, v152
    v_mul_f32 v151, v151, v152
    v_cvt_pk_bf16_f32 v112, v144, v145
    v_cvt_pk_bf16_f32 v113, v146, v147
    v_cvt_pk_bf16_f32 v114, v148, v149
    v_cvt_pk_bf16_f32 v115, v150, v151
    ds_write_b128 v4, v[112:115] offset:8192
    v_mfma_f32_32x32x16_bf16 v[144:159], v[8:11], a[144:147], 0
    s_waitcnt vmcnt(6)
    v_cvt_pk_bf16_f32 v12, v56, v57
    v_cvt_pk_bf16_f32 v13, v58, v59
    v_cvt_pk_bf16_f32 v14, v60, v61
    v_cvt_pk_bf16_f32 v15, v62, v63
    v_add_f32 v168, 0x358637bd, v168
    v_rcp_f32 v168, v168
    s_nop 0
    v_mul_f32 v160, v160, v168
    v_mul_f32 v161, v161, v168
    v_mul_f32 v162, v162, v168
    v_mul_f32 v163, v163, v168
    v_mul_f32 v164, v164, v168
    v_mul_f32 v165, v165, v168
    v_mul_f32 v166, v166, v168
    v_mul_f32 v167, v167, v168
    v_cvt_pk_bf16_f32 v116, v160, v161
    v_cvt_pk_bf16_f32 v117, v162, v163
    v_cvt_pk_bf16_f32 v118, v164, v165
    v_cvt_pk_bf16_f32 v119, v166, v167
    ds_write_b128 v4, v[116:119] offset:12288
    v_mfma_f32_32x32x16_bf16 v[160:175], v[12:15], a[148:151], 0
    s_waitcnt vmcnt(3)
    v_cvt_pk_bf16_f32 v8, v64, v65
    v_cvt_pk_bf16_f32 v9, v66, v67
    v_cvt_pk_bf16_f32 v10, v68, v69
    v_cvt_pk_bf16_f32 v11, v70, v71
    s_waitcnt lgkmcnt(0)
    s_barrier
    ds_read_b128 v[80:83], v6 offset:0
    ds_read_b128 v[84:87], v6 offset:1024
    ds_read_b128 v[88:91], v6 offset:2048
    ds_read_b128 v[92:95], v6 offset:3072
    ds_read_b128 v[96:99], v6 offset:4096
    ds_read_b128 v[100:103], v6 offset:5120
    s_waitcnt lgkmcnt(5)
    v_mfma_f32_32x32x16_bf16 v[128:143], a[0:3], v[80:83], 0
    ds_read_b128 v[104:107], v6 offset:6144
    v_add_f32 v152, 0x358637bd, v152
    v_rcp_f32 v152, v152
    s_nop 0
    v_mul_f32 v144, v144, v152
    s_waitcnt lgkmcnt(5)
    v_mfma_f32_32x32x16_bf16 v[128:143], a[4:7], v[84:87], v[128:143]
    ds_read_b128 v[108:111], v6 offset:7168
    v_mul_f32 v145, v145, v152
    v_mul_f32 v146, v146, v152
    v_mul_f32 v147, v147, v152
    v_mul_f32 v148, v148, v152
    v_mul_f32 v149, v149, v152
    s_waitcnt lgkmcnt(5)
    v_mfma_f32_32x32x16_bf16 v[128:143], a[8:11], v[88:91], v[128:143]
    ds_read_b128 v[80:83], v6 offset:8192
    s_add_u32 s51, s48, s50
    s_add_u32 s51, s51, 32768
    s_add_u32 m0, s50, 32768
    s_nop 0
    buffer_load_dwordx4 v1, s[36:39], s51 offen sc1 lds
    s_waitcnt lgkmcnt(5)
    v_mfma_f32_32x32x16_bf16 v[128:143], a[12:15], v[92:95], v[128:143]
    ds_read_b128 v[84:87], v6 offset:9216
    v_mul_f32 v150, v150, v152
    v_mul_f32 v151, v151, v152
    v_cvt_pk_bf16_f32 v112, v144, v145
    v_cvt_pk_bf16_f32 v113, v146, v147
    v_cvt_pk_bf16_f32 v114, v148, v149
    s_waitcnt lgkmcnt(5)
    v_mfma_f32_32x32x16_bf16 v[128:143], a[16:19], v[96:99], v[128:143]
    ds_read_b128 v[88:91], v6 offset:10240
    buffer_load_dwordx4 v1, s[36:39], s51 offen offset:1024 sc1 lds
    v_cvt_pk_bf16_f32 v115, v150, v151
    ds_write_b128 v4, v[112:115] offset:16384
    s_waitcnt lgkmcnt(6)
    v_mfma_f32_32x32x16_bf16 v[128:143], a[20:23], v[100:103], v[128:143]
    ds_read_b128 v[92:95], v6 offset:11264
    v_mfma_f32_32x32x16_bf16 v[144:159], v[8:11], a[152:155], 0
    s_waitcnt vmcnt(2)
    v_cvt_pk_bf16_f32 v12, v72, v73
    v_cvt_pk_bf16_f32 v13, v74, v75
    v_cvt_pk_bf16_f32 v14, v76, v77
    v_cvt_pk_bf16_f32 v15, v78, v79
    v_add_f32 v168, 0x358637bd, v168
    s_waitcnt lgkmcnt(6)
    v_mfma_f32_32x32x16_bf16 v[128:143], a[24:27], v[104:107], v[128:143]
    ds_read_b128 v[96:99], v6 offset:12288
    v_rcp_f32 v168, v168
    s_nop 0
    v_mul_f32 v160, v160, v168
    v_mul_f32 v161, v161, v168
    s_waitcnt lgkmcnt(6)
    v_mfma_f32_32x32x16_bf16 v[128:143], a[28:31], v[108:111], v[128:143]
    ds_read_b128 v[100:103], v6 offset:13312
    buffer_load_dwordx4 v1, s[36:39], s51 offen offset:2048 sc1 lds
    v_mul_f32 v162, v162, v168
    v_mul_f32 v163, v163, v168
    s_waitcnt lgkmcnt(6)
    v_mfma_f32_32x32x16_bf16 v[128:143], a[32:35], v[80:83], v[128:143]
    ds_read_b128 v[104:107], v6 offset:14336
    v_mul_f32 v164, v164, v168
    v_mul_f32 v165, v165, v168
    v_mul_f32 v166, v166, v168
    v_mul_f32 v167, v167, v168
    v_cvt_pk_bf16_f32 v116, v160, v161
    s_waitcnt lgkmcnt(6)
    v_mfma_f32_32x32x16_bf16 v[128:143], a[36:39], v[84:87], v[128:143]
    ds_read_b128 v[108:111], v6 offset:15360
    buffer_load_dwordx4 v1, s[36:39], s51 offen offset:3072 sc1 lds
    v_cvt_pk_bf16_f32 v117, v162, v163
    v_cvt_pk_bf16_f32 v118, v164, v165
    s_waitcnt lgkmcnt(6)
    v_mfma_f32_32x32x16_bf16 v[128:143], a[40:43], v[88:91], v[128:143]
    v_cvt_pk_bf16_f32 v119, v166, v167
    ds_write_b128 v4, v[116:119] offset:20480
    v_mfma_f32_32x32x16_bf16 v[160:175], v[12:15], a[156:159], 0
    v_add_f32 v152, 0x358637bd, v152
    v_rcp_f32 v152, v152
    s_nop 0
    v_mul_f32 v144, v144, v152
    v_mul_f32 v145, v145, v152
    s_waitcnt lgkmcnt(5)
    v_mfma_f32_32x32x16_bf16 v[128:143], a[44:47], v[92:95], v[128:143]
    v_mul_f32 v146, v146, v152
    v_mul_f32 v147, v147, v152
    v_mul_f32 v148, v148, v152
    v_mul_f32 v149, v149, v152
    v_mul_f32 v150, v150, v152
    v_mul_f32 v151, v151, v152
    s_waitcnt lgkmcnt(4)
    v_mfma_f32_32x32x16_bf16 v[128:143], a[48:51], v[96:99], v[128:143]
    s_add_u32 s51, s48, s50
    s_add_u32 s51, s51, 49152
    s_add_u32 m0, s50, 49152
    s_nop 0
    buffer_load_dwordx4 v1, s[36:39], s51 offen sc1 lds
    s_waitcnt lgkmcnt(3)
    v_mfma_f32_32x32x16_bf16 v[128:143], a[52:55], v[100:103], v[128:143]
    v_cvt_pk_bf16_f32 v112, v144, v145
    v_cvt_pk_bf16_f32 v113, v146, v147
    v_cvt_pk_bf16_f32 v114, v148, v149
    v_cvt_pk_bf16_f32 v115, v150, v151
    ds_write_b128 v4, v[112:115] offset:24576
    v_add_f32 v168, 0x358637bd, v168
    v_rcp_f32 v168, v168
    s_nop 0
    v_mul_f32 v160, v160, v168
    v_mul_f32 v161, v161, v168
    v_mul_f32 v162, v162, v168
    v_mul_f32 v163, v163, v168
    v_mul_f32 v164, v164, v168
    v_mul_f32 v165, v165, v168
    v_mul_f32 v166, v166, v168
    v_mul_f32 v167, v167, v168
    v_cvt_pk_bf16_f32 v116, v160, v161
    v_cvt_pk_bf16_f32 v117, v162, v163
    v_cvt_pk_bf16_f32 v118, v164, v165
    v_cvt_pk_bf16_f32 v119, v166, v167
    ds_write_b128 v4, v[116:119] offset:28672
    s_waitcnt lgkmcnt(0)
    s_barrier
    ds_read_b128 v[80:83], v6 offset:16384
    ds_read_b128 v[84:87], v6 offset:17408
    ds_read_b128 v[88:91], v6 offset:18432
    ds_read_b128 v[92:95], v6 offset:19456
    v_mfma_f32_32x32x16_bf16 v[128:143], a[56:59], v[104:107], v[128:143]
    ds_read_b128 v[96:99], v6 offset:20480
    buffer_load_dwordx4 v1, s[36:39], s51 offen offset:1024 sc1 lds
    v_mfma_f32_32x32x16_bf16 v[128:143], a[60:63], v[108:111], v[128:143]
    ds_read_b128 v[100:103], v6 offset:21504
    buffer_load_dwordx4 v1, s[36:39], s51 offen offset:2048 sc1 lds
    s_waitcnt lgkmcnt(5)
    v_mfma_f32_32x32x16_bf16 v[128:143], a[64:67], v[80:83], v[128:143]
    ds_read_b128 v[104:107], v6 offset:22528
    s_waitcnt lgkmcnt(5)
    v_mfma_f32_32x32x16_bf16 v[128:143], a[68:71], v[84:87], v[128:143]
    ds_read_b128 v[108:111], v6 offset:23552
    buffer_load_dwordx4 v1, s[36:39], s51 offen offset:3072 sc1 lds
    s_waitcnt lgkmcnt(5)
    v_mfma_f32_32x32x16_bf16 v[128:143], a[72:75], v[88:91], v[128:143]
    ds_read_b128 v[80:83], v6 offset:24576
    s_add_u32 s51, s48, s50
    s_add_u32 s51, s51, 65536
    s_add_u32 m0, s50, 65536
    s_nop 0
    buffer_load_dwordx4 v1, s[36:39], s51 offen sc1 lds
    s_waitcnt lgkmcnt(5)
    v_mfma_f32_32x32x16_bf16 v[128:143], a[76:79], v[92:95], v[128:143]
    ds_read_b128 v[84:87], v6 offset:25600
    s_waitcnt lgkmcnt(5)
    v_mfma_f32_32x32x16_bf16 v[128:143], a[80:83], v[96:99], v[128:143]
    ds_read_b128 v[88:91], v6 offset:26624
    buffer_load_dwordx4 v1, s[36:39], s51 offen offset:1024 sc1 lds
    s_waitcnt lgkmcnt(5)
    v_mfma_f32_32x32x16_bf16 v[128:143], a[84:87], v[100:103], v[128:143]
    ds_read_b128 v[92:95], v6 offset:27648
    buffer_load_dwordx4 v1, s[36:39], s51 offen offset:2048 sc1 lds
    s_waitcnt lgkmcnt(5)
    v_mfma_f32_32x32x16_bf16 v[128:143], a[88:91], v[104:107], v[128:143]
    ds_read_b128 v[96:99], v6 offset:28672
    s_waitcnt lgkmcnt(5)
    v_mfma_f32_32x32x16_bf16 v[128:143], a[92:95], v[108:111], v[128:143]
    ds_read_b128 v[100:103], v6 offset:29696
    buffer_load_dwordx4 v1, s[36:39], s51 offen offset:3072 sc1 lds
    s_waitcnt lgkmcnt(5)
    v_mfma_f32_32x32x16_bf16 v[128:143], a[96:99], v[80:83], v[128:143]
    ds_read_b128 v[104:107], v6 offset:30720
    s_add_u32 s51, s48, s50
    s_add_u32 s51, s51, 81920
    s_add_u32 m0, s50, 81920
    s_nop 0
    buffer_load_dwordx4 v1, s[36:39], s51 offen sc1 lds
    s_waitcnt lgkmcnt(5)
    v_mfma_f32_32x32x16_bf16 v[128:143], a[100:103], v[84:87], v[128:143]
    ds_read_b128 v[108:111], v6 offset:31744
    s_waitcnt lgkmcnt(5)
    v_mfma_f32_32x32x16_bf16 v[128:143], a[104:107], v[88:91], v[128:143]
    buffer_load_dwordx4 v1, s[36:39], s51 offen offset:1024 sc1 lds
    s_waitcnt lgkmcnt(4)
    v_mfma_f32_32x32x16_bf16 v[128:143], a[108:111], v[92:95], v[128:143]
    buffer_load_dwordx4 v1, s[36:39], s51 offen offset:2048 sc1 lds
    s_waitcnt lgkmcnt(3)
    v_mfma_f32_32x32x16_bf16 v[128:143], a[112:115], v[96:99], v[128:143]
    s_waitcnt lgkmcnt(2)
    v_mfma_f32_32x32x16_bf16 v[128:143], a[116:119], v[100:103], v[128:143]
    buffer_load_dwordx4 v1, s[36:39], s51 offen offset:3072 sc1 lds
    s_waitcnt lgkmcnt(1)
    v_mfma_f32_32x32x16_bf16 v[128:143], a[120:123], v[104:107], v[128:143]
    s_waitcnt lgkmcnt(0)
    v_mfma_f32_32x32x16_bf16 v[128:143], a[124:127], v[108:111], v[128:143]
    s_and_b32 s4, s45, 7
    s_mul_i32 s47, s4, 229376
    s_mul_i32 s4, s3, 57344
    s_add_u32 s47, s47, s4
    s_add_u32 s58, s47, 5767168
    s_and_b32 s59, s44, 0
    s_and_b32 s4, s45, 0
    s_add_u32 s4, s4, s59
    s_mul_i32 s60, s4, 11
    s_lshr_b32 s60, s60, 5
    s_mul_i32 s60, s60, 3
    s_sub_u32 s60, s4, s60
    s_lshl_b32 s59, s59, 13
    s_lshl_b32 s4, s60, 13
    s_add_u32 s4, s4, 0x8000
    s_mov_b32 s59, 45056
    s_add_u32 s47, s58, s59
    s_and_b32 s4, s3, 1
    s_lshl_b32 s4, s4, 10
    v_add_u32 v14, s4, v1
    v_xor_b32 v15, 0x400, v14
    v_lshlrev_b32 v8, 16, v120
    v_and_b32 v9, 0xffff0000, v120
    v_add_f32 v128, v128, v8
    v_add_f32 v129, v129, v9
    v_cvt_pk_bf16_f32 v120, v128, v129
    v_lshlrev_b32 v8, 16, v121
    v_and_b32 v9, 0xffff0000, v121
    v_add_f32 v130, v130, v8
    v_add_f32 v131, v131, v9
    v_cvt_pk_bf16_f32 v121, v130, v131
    v_lshlrev_b32 v8, 16, v122
    v_and_b32 v9, 0xffff0000, v122
    v_add_f32 v132, v132, v8
    v_add_f32 v133, v133, v9
    v_cvt_pk_bf16_f32 v122, v132, v133
    v_lshlrev_b32 v8, 16, v123
    v_and_b32 v9, 0xffff0000, v123
    v_add_f32 v134, v134, v8
    v_add_f32 v135, v135, v9
    v_cvt_pk_bf16_f32 v123, v134, v135
    v_lshlrev_b32 v8, 16, v124
    v_and_b32 v9, 0xffff0000, v124
    v_add_f32 v136, v136, v8
    v_add_f32 v137, v137, v9
    v_cvt_pk_bf16_f32 v124, v136, v137
    v_lshlrev_b32 v8, 16, v125
    v_and_b32 v9, 0xffff0000, v125
    v_add_f32 v138, v138, v8
    v_add_f32 v139, v139, v9
    v_cvt_pk_bf16_f32 v125, v138, v139
    v_lshlrev_b32 v8, 16, v126
    v_and_b32 v9, 0xffff0000, v126
    v_add_f32 v140, v140, v8
    v_add_f32 v141, v141, v9
    v_cvt_pk_bf16_f32 v126, v140, v141
    v_lshlrev_b32 v8, 16, v127
    v_and_b32 v9, 0xffff0000, v127
    v_add_f32 v142, v142, v8
    v_add_f32 v143, v143, v9
    v_cvt_pk_bf16_f32 v127, v142, v143
    buffer_store_dwordx4 v[120:123], v1, s[36:39], s11 offen sc1
    buffer_store_dwordx4 v[124:127], v1, s[36:39], s11 offen offset:1024 sc1
    v_mov_b32 v8, 0
    v_mov_b32 v9, 0
    v_mov_b32 v10, 0x3f803f80
    v_dot2_f32_bf16 v8, v120, v10, v8
    v_dot2_f32_bf16 v9, v120, v120, v9
    v_dot2_f32_bf16 v8, v121, v10, v8
    v_dot2_f32_bf16 v9, v121, v121, v9
    v_dot2_f32_bf16 v8, v122, v10, v8
    v_dot2_f32_bf16 v9, v122, v122, v9
    v_dot2_f32_bf16 v8, v123, v10, v8
    v_dot2_f32_bf16 v9, v123, v123, v9
    v_dot2_f32_bf16 v8, v124, v10, v8
    v_dot2_f32_bf16 v9, v124, v124, v9
    v_dot2_f32_bf16 v8, v125, v10, v8
    v_dot2_f32_bf16 v9, v125, v125, v9
    v_dot2_f32_bf16 v8, v126, v10, v8
    v_dot2_f32_bf16 v9, v126, v126, v9
    v_dot2_f32_bf16 v8, v127, v10, v8
    v_dot2_f32_bf16 v9, v127, v127, v9
    s_nop 1
    v_mov_b32 v10, v8
    v_mov_b32 v11, v8
    s_nop 1
    v_permlane32_swap_b32 v10, v11
    v_add_f32 v8, v10, v11
    v_mov_b32 v10, v9
    v_mov_b32 v11, v9
    s_nop 1
    v_permlane32_swap_b32 v10, v11
    v_add_f32 v9, v10, v11
    v_lshlrev_b32 v10, 3, v2
    s_mov_b32 exec_hi, 0
    buffer_store_dwordx2 v[8:9], v10, s[36:39], s13 offen sc1
    s_mov_b64 exec, -1
    s_waitcnt vmcnt(0)
    s_barrier
    s_cmp_lg_u32 s3, 0
    s_cbranch_scc1 sig21
    s_lshl_b32 s4, s44, 8
    s_add_u32 s4, s4, 7811072
    v_mov_b32 v8, 1
    v_mov_b32 v9, 0
    s_mov_b64 exec, 1
    buffer_atomic_add v8, v9, s[36:39], s4 offen sc1
    s_mov_b64 exec, -1
sig21:
    s_sub_u32 s4, s3, 1
    s_cmp_ge_u32 s4, 2
    s_cbranch_scc1 bys22
    s_lshl_b32 s4, s4, 14
    s_add_u32 s51, s48, s4
    s_add_u32 s51, s51, 98304
    s_add_u32 s4, s4, 98304
    s_mov_b32 m0, s4
    s_nop 0
    buffer_load_dwordx4 v1, s[36:39], s51 offen offset:0 sc1 lds
    buffer_load_dwordx4 v1, s[36:39], s51 offen offset:1024 sc1 lds
    buffer_load_dwordx4 v1, s[36:39], s51 offen offset:2048 sc1 lds
    buffer_load_dwordx4 v1, s[36:39], s51 offen offset:3072 sc1 lds
    s_add_u32 s51, s51, 4096
    s_add_u32 s4, s4, 4096
    s_mov_b32 m0, s4
    s_nop 0
    buffer_load_dwordx4 v1, s[36:39], s51 offen offset:0 sc1 lds
    buffer_load_dwordx4 v1, s[36:39], s51 offen offset:1024 sc1 lds
    buffer_load_dwordx4 v1, s[36:39], s51 offen offset:2048 sc1 lds
    buffer_load_dwordx4 v1, s[36:39], s51 offen offset:3072 sc1 lds
    s_add_u32 s51, s51, 4096
    s_add_u32 s4, s4, 4096
    s_mov_b32 m0, s4
    s_nop 0
    buffer_load_dwordx4 v1, s[36:39], s51 offen offset:0 sc1 lds
    buffer_load_dwordx4 v1, s[36:39], s51 offen offset:1024 sc1 lds
    buffer_load_dwordx4 v1, s[36:39], s51 offen offset:2048 sc1 lds
    buffer_load_dwordx4 v1, s[36:39], s51 offen offset:3072 sc1 lds
    s_add_u32 s51, s51, 4096
    s_add_u32 s4, s4, 4096
    s_mov_b32 m0, s4
    s_nop 0
    buffer_load_dwordx4 v1, s[36:39], s51 offen offset:0 sc1 lds
    buffer_load_dwordx4 v1, s[36:39], s51 offen offset:1024 sc1 lds
    buffer_load_dwordx4 v1, s[36:39], s51 offen offset:2048 sc1 lds
    buffer_load_dwordx4 v1, s[36:39], s51 offen offset:3072 sc1 lds
bys22:
    s_cmp_lg_u32 s3, 0
    s_cbranch_scc1 wt23_done
    s_lshl_b32 s4, s44, 8
    s_add_u32 s4, s4, 7811072
    v_mov_b32 v9, 0
    s_mov_b64 exec, 1
    s_mov_b32 s5, 0
wt23_loop:
    buffer_load_dword v8, v9, s[36:39], s4 offen sc1
    s_add_u32 s5, s5, 1
    s_waitcnt vmcnt(0)
    v_cmp_gt_u32 vcc, 16, v8
    s_cmp_gt_u32 s5, 0x40000
    s_cbranch_scc1 wt23_out
    s_nop 1
    s_cbranch_vccnz wt23_loop
wt23_out:
    s_mov_b64 exec, -1
wt23_done:
    s_barrier
    s_lshl_b32 s8, s44, 2
    s_add_u32 s8, s8, s3
    s_lshl_b32 s12, s8, 15
    s_add_u32 s12, s12, 15728640
    s_and_b32 s15, s45, 7
    s_lshl_b32 s15, s15, 12
    s_add_u32 s10, s12, s15
    buffer_load_dwordx4 a[0:3], v1, s[36:39], s10 offen offset:0 sc1
    buffer_load_dwordx4 a[4:7], v1, s[36:39], s10 offen offset:1024 sc1
    buffer_load_dwordx4 a[8:11], v1, s[36:39], s10 offen offset:2048 sc1
    buffer_load_dwordx4 a[12:15], v1, s[36:39], s10 offen offset:3072 sc1
    s_add_u32 s15, s15, 4096
    s_and_b32 s15, s15, 0x7fff
    s_add_u32 s10, s12, s15
    buffer_load_dwordx4 a[16:19], v1, s[36:39], s10 offen offset:0 sc1
    buffer_load_dwordx4 a[20:23], v1, s[36:39], s10 offen offset:1024 sc1
    buffer_load_dwordx4 a[24:27], v1, s[36:39], s10 offen offset:2048 sc1
    buffer_load_dwordx4 a[28:31], v1, s[36:39], s10 offen offset:3072 sc1
    s_add_u32 s15, s15, 4096
    s_and_b32 s15, s15, 0x7fff
    s_add_u32 s10, s12, s15
    buffer_load_dwordx4 a[32:35], v1, s[36:39], s10 offen offset:0 sc1
    buffer_load_dwordx4 a[36:39], v1, s[36:39], s10 offen offset:1024 sc1
    buffer_load_dwordx4 a[40:43], v1, s[36:39], s10 offen offset:2048 sc1
    v_lshlrev_b32 v9, 3, v2
    v_add_u32 v9, 147456, v9
    s_mul_i32 s13, s8, 114688
    s_lshr_b32 s14, s45, 2
    s_mul_i32 s14, s14, 28672
    s_add_u32 s13, s13, s14
    s_and_b32 s14, s45, 3
    s_lshl_b32 s14, s14, 10
    s_add_u32 s13, s13, s14
    s_add_u32 s61, s13, 29360128
    s_waitcnt vmcnt(10)
    s_barrier
    ds_read_b128 a[128:131], v1 offset:0
    ds_read_b128 a[132:135], v1 offset:1024
    ds_read_b128 a[136:139], v1 offset:2048
    ds_read_b128 a[140:143], v1 offset:3072
    ds_read_b128 a[144:147], v1 offset:4096
    ds_read_b128 a[148:151], v1 offset:5120
    ds_read_b128 a[152:155], v1 offset:6144
    s_waitcnt lgkmcnt(3)
    v_mfma_f32_32x32x16_bf16 v[64:79], a[128:131], a[0:3], 0
    ds_read_b128 a[156:159], v1 offset:7168
    buffer_load_dwordx4 a[44:47], v1, s[36:39], s10 offen offset:3072 sc1
    s_add_u32 s15, s15, 4096
    s_and_b32 s15, s15, 0x7fff
    s_add_u32 s10, s12, s15
    v_mfma_f32_32x32x16_bf16 v[80:95], a[132:135], a[0:3], 0
    ds_read_b128 a[128:131], v1 offset:8192
    s_waitcnt vmcnt(10)
    v_mfma_f32_32x32x16_bf16 v[64:79], a[136:139], a[4:7], v[64:79]
    ds_read_b128 a[132:135], v1 offset:9216
    buffer_load_dwordx4 a[48:51], v1, s[36:39], s10 offen offset:0 sc1
    v_mfma_f32_32x32x16_bf16 v[80:95], a[140:143], a[4:7], v[80:95]
    ds_read_b128 a[136:139], v1 offset:10240
    s_waitcnt lgkmcnt(3)
    s_waitcnt vmcnt(10)
    v_mfma_f32_32x32x16_bf16 v[64:79], a[144:147], a[8:11], v[64:79]
    ds_read_b128 a[140:143], v1 offset:11264
    buffer_load_dwordx4 a[52:55], v1, s[36:39], s10 offen offset:1024 sc1
    v_lshlrev_b32 v4, 17, v3
    v_lshl_add_u32 v4, v2, 3, v4
    s_lshl_b32 s9, s8, 8
    s_add_u32 s9, s9, 9175040
    buffer_load_dwordx2 v[16:17], v4, s[36:39], s9 offen sc1
    s_add_u32 s9, s9, 16384
    buffer_load_dwordx2 v[18:19], v4, s[36:39], s9 offen sc1
    s_add_u32 s9, s9, 16384
    v_mfma_f32_32x32x16_bf16 v[80:95], a[148:151], a[8:11], v[80:95]
    ds_read_b128 a[144:147], v1 offset:12288
    s_waitcnt vmcnt(12)
    v_mfma_f32_32x32x16_bf16 v[64:79], a[152:155], a[12:15], v[64:79]
    ds_read_b128 a[148:151], v1 offset:13312
    buffer_load_dwordx4 a[56:59], v1, s[36:39], s10 offen offset:2048 sc1
    v_mfma_f32_32x32x16_bf16 v[80:95], a[156:159], a[12:15], v[80:95]
    ds_read_b128 a[152:155], v1 offset:14336
    s_waitcnt lgkmcnt(3)
    s_waitcnt vmcnt(12)
    v_mfma_f32_32x32x16_bf16 v[64:79], a[128:131], a[16:19], v[64:79]
    ds_read_b128 a[156:159], v1 offset:15360
    buffer_load_dwordx4 a[60:63], v1, s[36:39], s10 offen offset:3072 sc1
    s_add_u32 s15, s15, 4096
    s_and_b32 s15, s15, 0x7fff
    s_add_u32 s10, s12, s15
    buffer_load_dwordx2 v[20:21], v4, s[36:39], s9 offen sc1
    s_add_u32 s9, s9, 16384
    buffer_load_dwordx2 v[22:23], v4, s[36:39], s9 offen sc1
    s_add_u32 s9, s9, 16384
    v_mfma_f32_32x32x16_bf16 v[80:95], a[132:135], a[16:19], v[80:95]
    ds_read_b128 a[128:131], v1 offset:16384
    s_waitcnt vmcnt(14)
    v_mfma_f32_32x32x16_bf16 v[64:79], a[136:139], a[20:23], v[64:79]
    ds_read_b128 a[132:135], v1 offset:17408
    buffer_load_dwordx4 a[64:67], v1, s[36:39], s10 offen offset:0 sc1
    v_mfma_f32_32x32x16_bf16 v[80:95], a[140:143], a[20:23], v[80:95]
    ds_read_b128 a[136:139], v1 offset:18432
    s_waitcnt lgkmcnt(3)
    s_waitcnt vmcnt(14)
    v_mfma_f32_32x32x16_bf16 v[64:79], a[144:147], a[24:27], v[64:79]
    ds_read_b128 a[140:143], v1 offset:19456
    buffer_load_dwordx4 a[68:71], v1, s[36:39], s10 offen offset:1024 sc1
    buffer_load_dwordx2 v[24:25], v4, s[36:39], s9 offen sc1
    s_add_u32 s9, s9, 16384
    buffer_load_dwordx2 v[26:27], v4, s[36:39], s9 offen sc1
    s_add_u32 s9, s9, 16384
    v_mfma_f32_32x32x16_bf16 v[80:95], a[148:151], a[24:27], v[80:95]
    ds_read_b128 a[144:147], v1 offset:20480
    s_waitcnt vmcnt(16)
    v_mfma_f32_32x32x16_bf16 v[64:79], a[152:155], a[28:31], v[64:79]
    ds_read_b128 a[148:151], v1 offset:21504
    buffer_load_dwordx4 a[72:75], v1, s[36:39], s10 offen offset:2048 sc1
    v_mfma_f32_32x32x16_bf16 v[80:95], a[156:159], a[28:31], v[80:95]
    ds_read_b128 a[152:155], v1 offset:22528
    s_waitcnt lgkmcnt(3)
    s_waitcnt vmcnt(16)
    v_mfma_f32_32x32x16_bf16 v[64:79], a[128:131], a[32:35], v[64:79]
    ds_read_b128 a[156:159], v1 offset:23552
    buffer_load_dwordx4 a[76:79], v1, s[36:39], s10 offen offset:3072 sc1
    s_add_u32 s15, s15, 4096
    s_and_b32 s15, s15, 0x7fff
    s_add_u32 s10, s12, s15
    buffer_load_dwordx2 v[28:29], v4, s[36:39], s9 offen sc1
    s_add_u32 s9, s9, 16384
    buffer_load_dwordx2 v[30:31], v4, s[36:39], s9 offen sc1
    v_mfma_f32_32x32x16_bf16 v[80:95], a[132:135], a[32:35], v[80:95]
    ds_read_b128 a[128:131], v1 offset:24576
    s_waitcnt vmcnt(18)
    v_mfma_f32_32x32x16_bf16 v[64:79], a[136:139], a[36:39], v[64:79]
    ds_read_b128 a[132:135], v1 offset:25600
    buffer_load_dwordx4 a[80:83], v1, s[36:39], s10 offen offset:0 sc1
    v_mfma_f32_32x32x16_bf16 v[80:95], a[140:143], a[36:39], v[80:95]
    ds_read_b128 a[136:139], v1 offset:26624
    s_waitcnt lgkmcnt(3)
    s_waitcnt vmcnt(18)
    v_mfma_f32_32x32x16_bf16 v[64:79], a[144:147], a[40:43], v[64:79]
    ds_read_b128 a[140:143], v1 offset:27648
    buffer_load_dwordx4 a[84:87], v1, s[36:39], s10 offen offset:1024 sc1
    v_mfma_f32_32x32x16_bf16 v[80:95], a[148:151], a[40:43], v[80:95]
    ds_read_b128 a[144:147], v1 offset:28672
    s_waitcnt vmcnt(18)
    v_mfma_f32_32x32x16_bf16 v[64:79], a[152:155], a[44:47], v[64:79]
    ds_read_b128 a[148:151], v1 offset:29696
    buffer_load_dwordx4 a[88:91], v1, s[36:39], s10 offen offset:2048 sc1
    v_mfma_f32_32x32x16_bf16 v[80:95], a[156:159], a[44:47], v[80:95]
    ds_read_b128 a[152:155], v1 offset:30720
    s_waitcnt lgkmcnt(3)
    s_waitcnt vmcnt(18)
    v_mfma_f32_32x32x16_bf16 v[64:79], a[128:131], a[48:51], v[64:79]
    ds_read_b128 a[156:159], v1 offset:31744
    buffer_load_dwordx4 a[92:95], v1, s[36:39], s10 offen offset:3072 sc1
    s_add_u32 s15, s15, 4096
    s_and_b32 s15, s15, 0x7fff
    s_add_u32 s10, s12, s15
    v_mfma_f32_32x32x16_bf16 v[80:95], a[132:135], a[48:51], v[80:95]
    s_barrier
    ds_read_b128 a[128:131], v1 offset:32768
    s_waitcnt vmcnt(18)
    v_mfma_f32_32x32x16_bf16 v[64:79], a[136:139], a[52:55], v[64:79]
    ds_read_b128 a[132:135], v1 offset:33792
    buffer_load_dwordx4 a[96:99], v1, s[36:39], s10 offen offset:0 sc1
    v_mfma_f32_32x32x16_bf16 v[80:95], a[140:143], a[52:55], v[80:95]
    ds_read_b128 a[136:139], v1 offset:34816
    s_waitcnt lgkmcnt(3)
    s_waitcnt vmcnt(16)
    v_mfma_f32_32x32x16_bf16 v[64:79], a[144:147], a[56:59], v[64:79]
    ds_read_b128 a[140:143], v1 offset:35840
    buffer_load_dwordx4 a[100:103], v1, s[36:39], s10 offen offset:1024 sc1
    v_mfma_f32_32x32x16_bf16 v[80:95], a[148:151], a[56:59], v[80:95]
    ds_read_b128 a[144:147], v1 offset:36864
    s_waitcnt vmcnt(16)
    v_mfma_f32_32x32x16_bf16 v[64:79], a[152:155], a[60:63], v[64:79]
    ds_read_b128 a[148:151], v1 offset:37888
    buffer_load_dwordx4 a[104:107], v1, s[36:39], s10 offen offset:2048 sc1
    v_mfma_f32_32x32x16_bf16 v[80:95], a[156:159], a[60:63], v[80:95]
    ds_read_b128 a[152:155], v1 offset:38912
    s_waitcnt lgkmcnt(3)
    s_waitcnt vmcnt(14)
    v_mfma_f32_32x32x16_bf16 v[64:79], a[128:131], a[64:67], v[64:79]
    ds_read_b128 a[156:159], v1 offset:39936
    buffer_load_dwordx4 a[108:111], v1, s[36:39], s10 offen offset:3072 sc1
    s_add_u32 s15, s15, 4096
    s_and_b32 s15, s15, 0x7fff
    s_add_u32 s10, s12, s15
    v_mfma_f32_32x32x16_bf16 v[80:95], a[132:135], a[64:67], v[80:95]
    ds_read_b128 a[128:131], v1 offset:40960
    s_waitcnt vmcnt(14)
    v_mfma_f32_32x32x16_bf16 v[64:79], a[136:139], a[68:71], v[64:79]
    ds_read_b128 a[132:135], v1 offset:41984
    buffer_load_dwordx4 a[112:115], v1, s[36:39], s10 offen offset:0 sc1
    v_mfma_f32_32x32x16_bf16 v[80:95], a[140:143], a[68:71], v[80:95]
    ds_read_b128 a[136:139], v1 offset:43008
    s_waitcnt lgkmcnt(3)
    s_waitcnt vmcnt(12)
    v_mfma_f32_32x32x16_bf16 v[64:79], a[144:147], a[72:75], v[64:79]
    ds_read_b128 a[140:143], v1 offset:44032
    buffer_load_dwordx4 a[116:119], v1, s[36:39], s10 offen offset:1024 sc1
    v_mfma_f32_32x32x16_bf16 v[80:95], a[148:151], a[72:75], v[80:95]
    ds_read_b128 a[144:147], v1 offset:45056
    s_waitcnt vmcnt(12)
    v_mfma_f32_32x32x16_bf16 v[64:79], a[152:155], a[76:79], v[64:79]
    ds_read_b128 a[148:151], v1 offset:46080
    buffer_load_dwordx4 a[120:123], v1, s[36:39], s10 offen offset:2048 sc1
    v_mfma_f32_32x32x16_bf16 v[80:95], a[156:159], a[76:79], v[80:95]
    ds_read_b128 a[152:155], v1 offset:47104
    s_waitcnt lgkmcnt(3)
    s_waitcnt vmcnt(10)
    v_mfma_f32_32x32x16_bf16 v[64:79], a[128:131], a[80:83], v[64:79]
    ds_read_b128 a[156:159], v1 offset:48128
    buffer_load_dwordx4 a[124:127], v1, s[36:39], s10 offen offset:3072 sc1
    v_add_f32 v16, v16, v24
    v_add_f32 v17, v17, v25
    v_mfma_f32_32x32x16_bf16 v[80:95], a[132:135], a[80:83], v[80:95]
    s_barrier
    ds_read_b128 a[128:131], v1 offset:49152
    v_add_f32 v18, v18, v26
    v_add_f32 v19, v19, v27
    v_add_f32 v20, v20, v28
    v_add_f32 v21, v21, v29
    s_waitcnt vmcnt(10)
    v_mfma_f32_32x32x16_bf16 v[64:79], a[136:139], a[84:87], v[64:79]
    ds_read_b128 a[132:135], v1 offset:50176
    v_add_f32 v22, v22, v30
    v_add_f32 v23, v23, v31
    v_add_f32 v16, v16, v20
    v_add_f32 v17, v17, v21
    v_add_f32 v18, v18, v22
    v_mfma_f32_32x32x16_bf16 v[80:95], a[140:143], a[84:87], v[80:95]
    ds_read_b128 a[136:139], v1 offset:51200
    s_add_u32 s51, s48, s50
    s_add_u32 s51, s51, 131072
    s_add_u32 m0, s50, 0
    s_nop 0
    buffer_load_dwordx4 v1, s[36:39], s51 offen sc1 lds
    s_waitcnt lgkmcnt(3)
    s_waitcnt vmcnt(10)
    v_mfma_f32_32x32x16_bf16 v[64:79], a[144:147], a[88:91], v[64:79]
    ds_read_b128 a[140:143], v1 offset:52224
    v_add_f32 v19, v19, v23
    v_add_f32 v16, v16, v18
    v_add_f32 v17, v17, v19
    v_mov_b32 v8, v16
    v_mov_b32 v4, v16
    v_mfma_f32_32x32x16_bf16 v[80:95], a[148:151], a[88:91], v[80:95]
    ds_read_b128 a[144:147], v1 offset:53248
    buffer_load_dwordx4 v1, s[36:39], s51 offen offset:1024 sc1 lds
    v_permlane32_swap_b32 v8, v4
    v_add_f32 v16, v8, v4
    s_waitcnt vmcnt(10)
    v_mfma_f32_32x32x16_bf16 v[64:79], a[152:155], a[92:95], v[64:79]
    ds_read_b128 a[148:151], v1 offset:54272
    v_mov_b32 v8, v17
    v_mov_b32 v4, v17
    s_nop 1
    v_permlane32_swap_b32 v8, v4
    v_add_f32 v17, v8, v4
    v_mul_f32 v6, 0x3b000000, v16
    v_mfma_f32_32x32x16_bf16 v[80:95], a[156:159], a[92:95], v[80:95]
    ds_read_b128 a[152:155], v1 offset:55296
    buffer_load_dwordx4 v1, s[36:39], s51 offen offset:2048 sc1 lds
    v_mul_f32 v17, 0x3b000000, v17
    s_waitcnt lgkmcnt(3)
    s_waitcnt vmcnt(10)
    v_mfma_f32_32x32x16_bf16 v[64:79], a[128:131], a[96:99], v[64:79]
    ds_read_b128 a[156:159], v1 offset:56320
    v_fma_f32 v17, -v6, v6, v17
    v_max_f32 v17, 0, v17
    v_add_f32 v17, 0x3727c5ac, v17
    v_rsq_f32 v7, v17
    v_mfma_f32_32x32x16_bf16 v[80:95], a[132:135], a[96:99], v[80:95]
    ds_read_b128 a[128:131], v1 offset:57344
    buffer_load_dwordx4 v1, s[36:39], s51 offen offset:3072 sc1 lds
    v_sub_f32 v42, 0, v6
    v_cndmask_b32 v42, 0, v42, s[52:53]
    s_waitcnt vmcnt(10)
    v_mfma_f32_32x32x16_bf16 v[64:79], a[136:139], a[100:103], v[64:79]
    ds_read_b128 a[132:135], v1 offset:58368
    v_cvt_pk_bf16_f32 v40, v42, v42
    v_lshlrev_b32 v43, 16, v40
    v_sub_f32 v43, v42, v43
    v_cvt_pk_bf16_f32 v41, v43, 0
    v_mov_b32 v42, 0
    v_mfma_f32_32x32x16_bf16 v[80:95], a[140:143], a[100:103], v[80:95]
    ds_read_b128 a[136:139], v1 offset:59392
    s_add_u32 s51, s48, s50
    s_add_u32 s51, s51, 147456
    s_add_u32 m0, s50, 16384
    s_nop 0
    buffer_load_dwordx4 v1, s[36:39], s51 offen sc1 lds
    s_waitcnt lgkmcnt(3)
    s_waitcnt vmcnt(10)
    v_mfma_f32_32x32x16_bf16 v[64:79], a[144:147], a[104:107], v[64:79]
    ds_read_b128 a[140:143], v1 offset:60416
    v_mov_b32 v43, 0
    v_mul_f32 v10, 0xc0135761, v7
    v_mul_f32 v13, v7, v7
    v_mul_f32 v11, 0x3d372713, v13
    v_mul_f32 v11, v11, v10
    v_mfma_f32_32x32x16_bf16 v[80:95], a[148:151], a[104:107], v[80:95]
    ds_read_b128 a[144:147], v1 offset:61440
    v_rcp_f32 v12, v13
    s_waitcnt vmcnt(9)
    v_mfma_f32_32x32x16_bf16 v[64:79], a[152:155], a[108:111], v[64:79]
    ds_read_b128 a[148:151], v1 offset:62464
    buffer_load_dwordx4 v1, s[36:39], s51 offen offset:1024 sc1 lds
    v_mfma_f32_32x32x16_bf16 v[80:95], a[156:159], a[108:111], v[80:95]
    ds_read_b128 a[152:155], v1 offset:63488
    s_waitcnt lgkmcnt(3)
    s_waitcnt vmcnt(9)
    v_mfma_f32_32x32x16_bf16 v[64:79], a[128:131], a[112:115], v[64:79]
    ds_read_b128 a[156:159], v1 offset:64512
    buffer_load_dwordx4 v1, s[36:39], s51 offen offset:2048 sc1 lds
    v_mfma_f32_32x32x16_bf16 v[80:95], a[132:135], a[112:115], v[80:95]
    ds_read_b64 a[128:129], v9 offset:0
    s_waitcnt vmcnt(9)
    v_mfma_f32_32x32x16_bf16 v[64:79], a[136:139], a[116:119], v[64:79]
    ds_read_b64 a[132:133], v9 offset:256
    buffer_load_dwordx4 v1, s[36:39], s51 offen offset:3072 sc1 lds
    v_mfma_f32_32x32x16_bf16 v[80:95], a[140:143], a[116:119], v[80:95]
    s_barrier
    ds_read_b128 a[136:139], v5 offset:0
    s_waitcnt lgkmcnt(3)
    s_waitcnt vmcnt(9)
    v_mfma_f32_32x32x16_bf16 v[64:79], a[144:147], a[120:123], v[64:79]
    ds_read_b128 a[140:143], v5 offset:1024
    s_add_u32 s51, s48, s50
    s_add_u32 s51, s51, 163840
    s_add_u32 m0, s50, 32768
    s_nop 0
    buffer_load_dwordx4 v1, s[36:39], s51 offen sc1 lds
    v_mfma_f32_32x32x16_bf16 v[80:95], a[148:151], a[120:123], v[80:95]
    ds_read_b128 a[144:147], v5 offset:2048
    s_waitcnt vmcnt(9)
    v_mfma_f32_32x32x16_bf16 v[64:79], a[152:155], a[124:127], v[64:79]
    ds_read_b128 a[148:151], v5 offset:3072
    buffer_load_dwordx4 v1, s[36:39], s51 offen offset:1024 sc1 lds
    v_mfma_f32_32x32x16_bf16 v[80:95], a[156:159], a[124:127], v[80:95]
    ds_read_b128 a[152:155], v5 offset:4096
    s_waitcnt lgkmcnt(3)
    v_mfma_f32_32x32x16_bf16 v[64:79], a[128:131], v[40:43], v[64:79]
    ds_read_b128 a[156:159], v5 offset:5120
    v_mfma_f32_32x32x16_bf16 v[80:95], a[132:135], v[40:43], v[80:95]
    ds_read_b128 a[128:131], v5 offset:6144
    buffer_load_dwordx4 v1, s[36:39], s51 offen offset:2048 sc1 lds
    v_mfma_f32_32x32x16_bf16 v[96:111], a[136:139], a[0:3], 0
    ds_read_b128 a[132:135], v5 offset:7168
    v_mfma_f32_32x32x16_bf16 v[96:111], a[140:143], a[4:7], v[96:111]
    ds_read_b128 a[136:139], v5 offset:8192
    buffer_load_dwordx4 v1, s[36:39], s51 offen offset:3072 sc1 lds
    s_waitcnt lgkmcnt(3)
    v_mfma_f32_32x32x16_bf16 v[96:111], a[144:147], a[8:11], v[96:111]
    ds_read_b128 a[140:143], v5 offset:9216
    v_mul_f32 v16, v64, v64
    v_mul_f32 v17, v65, v65
    v_fma_f32 v16, v16, v11, v10
    v_fma_f32 v17, v17, v11, v10
    v_mul_f32 v16, v16, v64
    v_mfma_f32_32x32x16_bf16 v[96:111], a[148:151], a[12:15], v[96:111]
    ds_read_b128 a[144:147], v5 offset:10240
    buffer_load_dwordx4 v[128:131], v14, s[36:39], s47 offen offset:0 sc1
    v_mul_f32 v17, v17, v65
    v_exp_f32 v16, v16
    v_mfma_f32_32x32x16_bf16 v[96:111], a[152:155], a[16:19], v[96:111]
    ds_read_b128 a[148:151], v5 offset:11264
    v_exp_f32 v17, v17
    v_mul_f32 v64, v64, v72
    v_mul_f32 v65, v65, v73
    v_fma_f32 v16, v16, v12, v12
    v_mfma_f32_32x32x16_bf16 v[96:111], a[156:159], a[20:23], v[96:111]
    ds_read_b128 a[152:155], v5 offset:12288
    buffer_load_dwordx4 v[132:135], v15, s[36:39], s47 offen offset:0 sc1
    v_fma_f32 v17, v17, v12, v12
    s_waitcnt lgkmcnt(3)
    v_mfma_f32_32x32x16_bf16 v[96:111], a[128:131], a[24:27], v[96:111]
    ds_read_b128 a[156:159], v5 offset:13312
    v_rcp_f32 v16, v16
    v_rcp_f32 v17, v17
    v_mul_f32 v64, v64, v16
    v_mfma_f32_32x32x16_bf16 v[96:111], a[132:135], a[28:31], v[96:111]
    ds_read_b128 a[128:131], v5 offset:14336
    buffer_load_dwordx4 v[136:139], v14, s[36:39], s47 offen offset:2048 sc1
    v_mul_f32 v65, v65, v17
    v_cvt_pk_bf16_f32 v32, v64, v65
    v_mfma_f32_32x32x16_bf16 v[96:111], a[136:139], a[32:35], v[96:111]
    ds_read_b128 a[132:135], v5 offset:15360
    v_mul_f32 v16, v66, v66
    v_mul_f32 v17, v67, v67
    v_fma_f32 v16, v16, v11, v10
    v_fma_f32 v17, v17, v11, v10
    v_mul_f32 v16, v16, v66
    v_mfma_f32_32x32x16_bf16 v[96:111], a[140:143], a[36:39], v[96:111]
    s_barrier
    ds_read_b128 a[136:139], v5 offset:16384
    v_mul_f32 v17, v17, v67
    v_exp_f32 v16, v16
    s_waitcnt lgkmcnt(3)
    v_mfma_f32_32x32x16_bf16 v[96:111], a[144:147], a[40:43], v[96:111]
    ds_read_b128 a[140:143], v5 offset:17408
    buffer_load_dwordx4 v[140:143], v15, s[36:39], s47 offen offset:2048 sc1
    s_add_u32 s59, s59, 4096
    s_cmp_eq_u32 s59, 0xe000
    s_cselect_b32 s59, 0x8000, s59
    s_add_u32 s47, s58, s59
    v_mfma_f32_32x32x16_bf16 v[96:111], a[148:151], a[44:47], v[96:111]
    ds_read_b128 a[144:147], v5 offset:18432
    v_exp_f32 v17, v17
    v_mul_f32 v66, v66, v74
    v_mul_f32 v67, v67, v75
    v_fma_f32 v16, v16, v12, v12
    v_mfma_f32_32x32x16_bf16 v[96:111], a[152:155], a[48:51], v[96:111]
    ds_read_b128 a[148:151], v5 offset:19456
    s_add_u32 s51, s48, s50
    s_add_u32 s51, s51, 180224
    s_add_u32 m0, s50, 49152
    s_nop 0
    buffer_load_dwordx4 v1, s[36:39], s51 offen sc1 lds
    v_mfma_f32_32x32x16_bf16 v[96:111], a[156:159], a[52:55], v[96:111]
    ds_read_b128 a[152:155], v5 offset:20480
    v_fma_f32 v17, v17, v12, v12
    v_rcp_f32 v16, v16
    v_rcp_f32 v17, v17
    s_waitcnt lgkmcnt(3)
    v_mfma_f32_32x32x16_bf16 v[96:111], a[128:131], a[56:59], v[96:111]
    ds_read_b128 a[156:159], v5 offset:21504
    buffer_load_dwordx4 v1, s[36:39], s51 offen offset:1024 sc1 lds
    v_mul_f32 v66, v66, v16
    v_mul_f32 v67, v67, v17
    v_mfma_f32_32x32x16_bf16 v[96:111], a[132:135], a[60:63], v[96:111]
    ds_read_b128 a[128:131], v5 offset:22528
    v_cvt_pk_bf16_f32 v33, v66, v67
    v_mul_f32 v16, v68, v68
    v_mul_f32 v17, v69, v69
    v_fma_f32 v16, v16, v11, v10
    v_fma_f32 v17, v17, v11, v10
    v_mfma_f32_32x32x16_bf16 v[96:111], a[136:139], a[64:67], v[96:111]
    ds_read_b128 a[132:135], v5 offset:23552
    buffer_load_dwordx4 v1, s[36:39], s51 offen offset:2048 sc1 lds
    v_mul_f32 v16, v16, v68
    v_mul_f32 v17, v17, v69
    v_mfma_f32_32x32x16_bf16 v[96:111], a[140:143], a[68:71], v[96:111]
    ds_read_b128 a[136:139], v5 offset:24576
    v_exp_f32 v16, v16
    v_exp_f32 v17, v17
    s_waitcnt lgkmcnt(3)
    v_mfma_f32_32x32x16_bf16 v[96:111], a[144:147], a[72:75], v[96:111]
    ds_read_b128 a[140:143], v5 offset:25600
    buffer_load_dwordx4 v1, s[36:39], s51 offen offset:3072 sc1 lds
    v_mul_f32 v68, v68, v76
    v_mul_f32 v69, v69, v77
    v_mfma_f32_32x32x16_bf16 v[96:111], a[148:151], a[76:79], v[96:111]
    ds_read_b128 a[144:147], v5 offset:26624
    v_fma_f32 v16, v16, v12, v12
    v_fma_f32 v17, v17, v12, v12
    v_rcp_f32 v16, v16
    v_rcp_f32 v17, v17
    v_mfma_f32_32x32x16_bf16 v[96:111], a[152:155], a[80:83], v[96:111]
    ds_read_b128 a[148:151], v5 offset:27648
    v_mul_f32 v68, v68, v16
    v_mul_f32 v69, v69, v17
    v_cvt_pk_bf16_f32 v34, v68, v69
    v_mul_f32 v16, v70, v70
    v_mul_f32 v17, v71, v71
    v_mfma_f32_32x32x16_bf16 v[96:111], a[156:159], a[84:87], v[96:111]
    ds_read_b128 a[152:155], v5 offset:28672
    buffer_load_dwordx4 v[144:147], v14, s[36:39], s47 offen offset:0 sc1
    v_fma_f32 v16, v16, v11, v10
    s_waitcnt lgkmcnt(3)
    v_mfma_f32_32x32x16_bf16 v[96:111], a[128:131], a[88:91], v[96:111]
    ds_read_b128 a[156:159], v5 offset:29696
    v_fma_f32 v17, v17, v11, v10
    v_mul_f32 v16, v16, v70
    v_mul_f32 v17, v17, v71
    v_exp_f32 v16, v16
    v_mfma_f32_32x32x16_bf16 v[96:111], a[132:135], a[92:95], v[96:111]
    ds_read_b128 a[128:131], v5 offset:30720
    buffer_load_dwordx4 v[148:151], v15, s[36:39], s47 offen offset:0 sc1
    v_exp_f32 v17, v17
    v_mfma_f32_32x32x16_bf16 v[96:111], a[136:139], a[96:99], v[96:111]
    ds_read_b128 a[132:135], v5 offset:31744
    v_mul_f32 v70, v70, v78
    v_mul_f32 v71, v71, v79
    v_fma_f32 v16, v16, v12, v12
    v_fma_f32 v17, v17, v12, v12
    v_rcp_f32 v16, v16
    v_mfma_f32_32x32x16_bf16 v[96:111], a[140:143], a[100:103], v[96:111]
    ds_read_b64 a[136:137], v9 offset:512
    buffer_load_dwordx4 v[152:155], v14, s[36:39], s47 offen offset:2048 sc1
    v_rcp_f32 v17, v17
    s_waitcnt lgkmcnt(3)
    v_mfma_f32_32x32x16_bf16 v[96:111], a[144:147], a[104:107], v[96:111]
    s_barrier
    ds_read_b128 a[140:143], v5 offset:32768
    v_mul_f32 v70, v70, v16
    v_mul_f32 v71, v71, v17
    v_cvt_pk_bf16_f32 v35, v70, v71
    buffer_store_dwordx4 v[32:35], v1, s[36:39], s61 offen sc1
    s_add_u32 s61, s61, 4096
    v_mfma_f32_32x32x16_bf16 v[96:111], a[148:151], a[108:111], v[96:111]
    ds_read_b128 a[144:147], v5 offset:33792
    s_add_u32 s51, s48, s50
    s_add_u32 s51, s51, 196608
    s_add_u32 m0, s50, 65536
    s_nop 0
    buffer_load_dwordx4 v1, s[36:39], s51 offen sc1 lds
    v_mfma_f32_32x32x16_bf16 v[96:111], a[152:155], a[112:115], v[96:111]
    ds_read_b128 a[148:151], v5 offset:34816
    v_mul_f32 v16, v80, v80
    v_mul_f32 v17, v81, v81
    v_fma_f32 v16, v16, v11, v10
    v_fma_f32 v17, v17, v11, v10
    v_mul_f32 v16, v16, v80
    v_mfma_f32_32x32x16_bf16 v[96:111], a[156:159], a[116:119], v[96:111]
    ds_read_b128 a[152:155], v5 offset:35840
    buffer_load_dwordx4 v1, s[36:39], s51 offen offset:1024 sc1 lds
    v_mul_f32 v17, v17, v81
    s_waitcnt lgkmcnt(3)
    v_mfma_f32_32x32x16_bf16 v[96:111], a[128:131], a[120:123], v[96:111]
    ds_read_b128 a[156:159], v5 offset:36864
    v_exp_f32 v16, v16
    v_exp_f32 v17, v17
    v_mul_f32 v80, v80, v88
    v_mfma_f32_32x32x16_bf16 v[96:111], a[132:135], a[124:127], v[96:111]
    ds_read_b128 a[128:131], v5 offset:37888
    v_mul_f32 v81, v81, v89
    v_fma_f32 v16, v16, v12, v12
    v_fma_f32 v17, v17, v12, v12
    v_rcp_f32 v16, v16
    v_mfma_f32_32x32x16_bf16 v[96:111], a[136:139], v[40:43], v[96:111]
    ds_read_b128 a[132:135], v5 offset:38912
    buffer_load_dwordx4 v1, s[36:39], s51 offen offset:2048 sc1 lds
    v_rcp_f32 v17, v17
    v_mfma_f32_32x32x16_bf16 v[112:127], a[140:143], a[0:3], 0
    ds_read_b128 a[136:139], v5 offset:39936
    v_mul_f32 v80, v80, v16
    v_mul_f32 v81, v81, v17
    v_cvt_pk_bf16_f32 v36, v80, v81
    v_mul_f32 v16, v82, v82
    s_waitcnt lgkmcnt(3)
    v_mfma_f32_32x32x16_bf16 v[112:127], a[144:147], a[4:7], v[112:127]
    ds_read_b128 a[140:143], v5 offset:40960
    buffer_load_dwordx4 v1, s[36:39], s51 offen offset:3072 sc1 lds
    v_mul_f32 v17, v83, v83
    v_fma_f32 v16, v16, v11, v10
    v_mfma_f32_32x32x16_bf16 v[112:127], a[148:151], a[8:11], v[112:127]
    ds_read_b128 a[144:147], v5 offset:41984
    v_fma_f32 v17, v17, v11, v10
    v_mul_f32 v16, v16, v82
    v_mul_f32 v17, v17, v83
    v_exp_f32 v16, v16
    v_mfma_f32_32x32x16_bf16 v[112:127], a[152:155], a[12:15], v[112:127]
    ds_read_b128 a[148:151], v5 offset:43008
    buffer_load_dwordx4 v[156:159], v15, s[36:39], s47 offen offset:2048 sc1
    s_add_u32 s59, s59, 4096
    s_add_u32 s47, s58, s59
    v_mfma_f32_32x32x16_bf16 v[112:127], a[156:159], a[16:19], v[112:127]
    ds_read_b128 a[152:155], v5 offset:44032
    v_exp_f32 v17, v17
    v_mul_f32 v82, v82, v90
    v_mul_f32 v83, v83, v91
    s_waitcnt lgkmcnt(3)
    v_mfma_f32_32x32x16_bf16 v[112:127], a[128:131], a[20:23], v[112:127]
    ds_read_b128 a[156:159], v5 offset:45056
    buffer_load_dwordx4 v[160:163], v14, s[36:39], s47 offen offset:0 sc1
    v_fma_f32 v16, v16, v12, v12
    v_fma_f32 v17, v17, v12, v12
    v_mfma_f32_32x32x16_bf16 v[112:127], a[132:135], a[24:27], v[112:127]
    ds_read_b128 a[128:131], v5 offset:46080
    v_rcp_f32 v16, v16
    v_rcp_f32 v17, v17
    v_mul_f32 v82, v82, v16
    v_mfma_f32_32x32x16_bf16 v[112:127], a[136:139], a[28:31], v[112:127]
    ds_read_b128 a[132:135], v5 offset:47104
    buffer_load_dwordx4 v[164:167], v15, s[36:39], s47 offen offset:0 sc1
    v_mul_f32 v83, v83, v17
    v_cvt_pk_bf16_f32 v37, v82, v83
    v_mfma_f32_32x32x16_bf16 v[112:127], a[140:143], a[32:35], v[112:127]
    ds_read_b128 a[136:139], v5 offset:48128
    v_mul_f32 v16, v84, v84
    v_mul_f32 v17, v85, v85
    v_fma_f32 v16, v16, v11, v10
    v_fma_f32 v17, v17, v11, v10
    s_waitcnt lgkmcnt(3)
    v_mfma_f32_32x32x16_bf16 v[112:127], a[144:147], a[36:39], v[112:127]
    s_barrier
    ds_read_b128 a[140:143], v5 offset:49152
    v_mul_f32 v16, v16, v84
    v_mul_f32 v17, v17, v85
    v_exp_f32 v16, v16
    v_mfma_f32_32x32x16_bf16 v[112:127], a[148:151], a[40:43], v[112:127]
    ds_read_b128 a[144:147], v5 offset:50176
    buffer_load_dwordx4 v[168:171], v14, s[36:39], s47 offen offset:2048 sc1
    v_exp_f32 v17, v17
    v_mfma_f32_32x32x16_bf16 v[112:127], a[152:155], a[44:47], v[112:127]
    ds_read_b128 a[148:151], v5 offset:51200
    v_mul_f32 v84, v84, v92
    v_mul_f32 v85, v85, v93
    v_fma_f32 v16, v16, v12, v12
    v_fma_f32 v17, v17, v12, v12
    v_rcp_f32 v16, v16
    v_mfma_f32_32x32x16_bf16 v[112:127], a[156:159], a[48:51], v[112:127]
    ds_read_b128 a[152:155], v5 offset:52224
    s_add_u32 s51, s48, s50
    s_add_u32 s51, s51, 212992
    s_add_u32 m0, s50, 81920
    s_nop 0
    buffer_load_dwordx4 v1, s[36:39], s51 offen sc1 lds
    s_waitcnt lgkmcnt(3)
    v_mfma_f32_32x32x16_bf16 v[112:127], a[128:131], a[52:55], v[112:127]
    ds_read_b128 a[156:159], v5 offset:53248
    v_rcp_f32 v17, v17
    v_mul_f32 v84, v84, v16
    v_mul_f32 v85, v85, v17
    v_cvt_pk_bf16_f32 v38, v84, v85
    v_mfma_f32_32x32x16_bf16 v[112:127], a[132:135], a[56:59], v[112:127]
    ds_read_b128 a[128:131], v5 offset:54272
    buffer_load_dwordx4 v1, s[36:39], s51 offen offset:1024 sc1 lds
    v_mul_f32 v16, v86, v86
    v_mul_f32 v17, v87, v87
    v_mfma_f32_32x32x16_bf16 v[112:127], a[136:139], a[60:63], v[112:127]
    ds_read_b128 a[132:135], v5 offset:55296
    v_fma_f32 v16, v16, v11, v10
    v_fma_f32 v17, v17, v11, v10
    v_mul_f32 v16, v16, v86
    v_mul_f32 v17, v17, v87
    v_exp_f32 v16, v16
    v_mfma_f32_32x32x16_bf16 v[112:127], a[140:143], a[64:67], v[112:127]
    ds_read_b128 a[136:139], v5 offset:56320
    buffer_load_dwordx4 v1, s[36:39], s51 offen offset:2048 sc1 lds
    v_exp_f32 v17, v17
    s_waitcnt lgkmcnt(3)
    v_mfma_f32_32x32x16_bf16 v[112:127], a[144:147], a[68:71], v[112:127]
    ds_read_b128 a[140:143], v5 offset:57344
    v_mul_f32 v86, v86, v94
    v_mul_f32 v87, v87, v95
    v_fma_f32 v16, v16, v12, v12
    v_fma_f32 v17, v17, v12, v12
    v_rcp_f32 v16, v16
    v_mfma_f32_32x32x16_bf16 v[112:127], a[148:151], a[72:75], v[112:127]
    ds_read_b128 a[144:147], v5 offset:58368
    buffer_load_dwordx4 v1, s[36:39], s51 offen offset:3072 sc1 lds
    v_rcp_f32 v17, v17
    v_mfma_f32_32x32x16_bf16 v[112:127], a[152:155], a[76:79], v[112:127]
    ds_read_b128 a[148:151], v5 offset:59392
    v_mul_f32 v86, v86, v16
    v_mul_f32 v87, v87, v17
    v_cvt_pk_bf16_f32 v39, v86, v87
    buffer_store_dwordx4 v[36:39], v1, s[36:39], s61 offen sc1
    s_add_u32 s61, s61, 4096
    v_mfma_f32_32x32x16_bf16 v[112:127], a[156:159], a[80:83], v[112:127]
    ds_read_b128 a[152:155], v5 offset:60416
    v_mul_f32 v16, v96, v96
    v_mul_f32 v17, v97, v97
    v_fma_f32 v16, v16, v11, v10
    v_fma_f32 v17, v17, v11, v10
    s_waitcnt lgkmcnt(3)
    v_mfma_f32_32x32x16_bf16 v[112:127], a[128:131], a[84:87], v[112:127]
    ds_read_b128 a[156:159], v5 offset:61440
    buffer_load_dwordx4 v[172:175], v15, s[36:39], s47 offen offset:2048 sc1
    v_mul_f32 v16, v16, v96
    v_mul_f32 v17, v17, v97
    v_mfma_f32_32x32x16_bf16 v[112:127], a[132:135], a[88:91], v[112:127]
    ds_read_b128 a[128:131], v5 offset:62464
    v_exp_f32 v16, v16
    v_exp_f32 v17, v17
    v_mul_f32 v96, v96, v104
    v_mfma_f32_32x32x16_bf16 v[112:127], a[136:139], a[92:95], v[112:127]
    ds_read_b128 a[132:135], v5 offset:63488
    v_mul_f32 v97, v97, v105
    v_fma_f32 v16, v16, v12, v12
    v_fma_f32 v17, v17, v12, v12
    v_rcp_f32 v16, v16
    v_mfma_f32_32x32x16_bf16 v[112:127], a[140:143], a[96:99], v[112:127]
    ds_read_b128 a[136:139], v5 offset:64512
    v_rcp_f32 v17, v17
    v_mul_f32 v96, v96, v16
    v_mul_f32 v97, v97, v17
    s_waitcnt lgkmcnt(3)
    v_mfma_f32_32x32x16_bf16 v[112:127], a[144:147], a[100:103], v[112:127]
    ds_read_b64 a[140:141], v9 offset:768
    v_cvt_pk_bf16_f32 v32, v96, v97
    v_mul_f32 v16, v98, v98
    v_mul_f32 v17, v99, v99
    v_fma_f32 v16, v16, v11, v10
    v_fma_f32 v17, v17, v11, v10
    v_mfma_f32_32x32x16_bf16 v[112:127], a[148:151], a[104:107], v[112:127]
    s_waitcnt vmcnt(34)
    s_barrier
    ds_read_b128 a[144:147], v1 offset:0
    v_mul_f32 v16, v16, v98
    v_mul_f32 v17, v17, v99
    v_exp_f32 v16, v16
    v_mfma_f32_32x32x16_bf16 v[112:127], a[152:155], a[108:111], v[112:127]
    ds_read_b128 a[148:151], v1 offset:1024
    v_exp_f32 v17, v17
    v_mul_f32 v98, v98, v106
    v_mul_f32 v99, v99, v107
    v_fma_f32 v16, v16, v12, v12
    v_mfma_f32_32x32x16_bf16 v[112:127], a[156:159], a[112:115], v[112:127]
    ds_read_b128 a[152:155], v1 offset:2048
    v_fma_f32 v17, v17, v12, v12
    v_rcp_f32 v16, v16
    v_rcp_f32 v17, v17
    s_waitcnt lgkmcnt(3)
    v_mfma_f32_32x32x16_bf16 v[112:127], a[128:131], a[116:119], v[112:127]
    ds_read_b128 a[156:159], v1 offset:3072
    v_mul_f32 v98, v98, v16
    v_mul_f32 v99, v99, v17
    v_cvt_pk_bf16_f32 v33, v98, v99
    v_mul_f32 v16, v100, v100
    v_mul_f32 v17, v101, v101
    v_mfma_f32_32x32x16_bf16 v[112:127], a[132:135], a[120:123], v[112:127]
    ds_read_b128 a[128:131], v1 offset:4096
    v_fma_f32 v16, v16, v11, v10
    v_fma_f32 v17, v17, v11, v10
    v_mul_f32 v16, v16, v100
    v_mul_f32 v17, v17, v101
    v_exp_f32 v16, v16
    v_mfma_f32_32x32x16_bf16 v[112:127], a[136:139], a[124:127], v[112:127]
    ds_read_b128 a[132:135], v1 offset:5120
    v_exp_f32 v17, v17
    v_mul_f32 v100, v100, v108
    v_mul_f32 v101, v101, v109
    v_fma_f32 v16, v16, v12, v12
    v_mfma_f32_32x32x16_bf16 v[112:127], a[140:143], v[40:43], v[112:127]
    ds_read_b128 a[136:139], v1 offset:6144
    v_fma_f32 v17, v17, v12, v12
    v_rcp_f32 v16, v16
    v_rcp_f32 v17, v17
    s_waitcnt lgkmcnt(3)
    v_mfma_f32_32x32x16_bf16 v[64:79], a[144:147], a[0:3], 0
    ds_read_b128 a[140:143], v1 offset:7168
    v_mul_f32 v100, v100, v16
    v_mul_f32 v101, v101, v17
    v_cvt_pk_bf16_f32 v34, v100, v101
    v_mul_f32 v16, v102, v102
    v_mul_f32 v17, v103, v103
    v_mfma_f32_32x32x16_bf16 v[64:79], a[148:151], a[4:7], v[64:79]
    ds_read_b128 a[144:147], v1 offset:8192
    v_fma_f32 v16, v16, v11, v10
    v_fma_f32 v17, v17, v11, v10
    v_mul_f32 v16, v16, v102
    v_mul_f32 v17, v17, v103
    v_exp_f32 v16, v16
    v_mfma_f32_32x32x16_bf16 v[64:79], a[152:155], a[8:11], v[64:79]
    ds_read_b128 a[148:151], v1 offset:9216
    v_exp_f32 v17, v17
    v_mul_f32 v102, v102, v110
    v_mul_f32 v103, v103, v111
    v_fma_f32 v16, v16, v12, v12
    v_mfma_f32_32x32x16_bf16 v[64:79], a[156:159], a[12:15], v[64:79]
    ds_read_b128 a[152:155], v1 offset:10240
    v_fma_f32 v17, v17, v12, v12
    v_rcp_f32 v16, v16
    v_rcp_f32 v17, v17
    s_waitcnt lgkmcnt(3)
    v_mfma_f32_32x32x16_bf16 v[64:79], a[128:131], a[16:19], v[64:79]
    ds_read_b128 a[156:159], v1 offset:11264
    v_mul_f32 v102, v102, v16
    v_mul_f32 v103, v103, v17
    v_cvt_pk_bf16_f32 v35, v102, v103
    buffer_store_dwordx4 v[32:35], v1, s[36:39], s61 offen sc1
    s_add_u32 s61, s61, 4096
    v_mfma_f32_32x32x16_bf16 v[64:79], a[132:135], a[20:23], v[64:79]
    ds_read_b128 a[128:131], v1 offset:12288
    v_mul_f32 v16, v112, v112
    v_mul_f32 v17, v113, v113
    v_fma_f32 v16, v16, v11, v10
    v_fma_f32 v17, v17, v11, v10
    v_mul_f32 v16, v16, v112
    v_mfma_f32_32x32x16_bf16 v[64:79], a[136:139], a[24:27], v[64:79]
    ds_read_b128 a[132:135], v1 offset:13312
    v_mul_f32 v17, v17, v113
    v_exp_f32 v16, v16
    v_exp_f32 v17, v17
    v_mfma_f32_32x32x16_bf16 v[64:79], a[140:143], a[28:31], v[64:79]
    ds_read_b128 a[136:139], v1 offset:14336
    v_mul_f32 v112, v112, v120
    v_mul_f32 v113, v113, v121
    v_fma_f32 v16, v16, v12, v12
    v_fma_f32 v17, v17, v12, v12
    s_waitcnt lgkmcnt(3)
    v_mfma_f32_32x32x16_bf16 v[64:79], a[144:147], a[32:35], v[64:79]
    ds_read_b128 a[140:143], v1 offset:15360
    v_rcp_f32 v16, v16
    v_rcp_f32 v17, v17
    v_mul_f32 v112, v112, v16
    v_mfma_f32_32x32x16_bf16 v[64:79], a[148:151], a[36:39], v[64:79]
    s_waitcnt vmcnt(31)
    s_barrier
    ds_read_b128 a[144:147], v1 offset:16384
    v_mul_f32 v113, v113, v17
    v_cvt_pk_bf16_f32 v36, v112, v113
    v_mul_f32 v16, v114, v114
    v_mfma_f32_32x32x16_bf16 v[64:79], a[152:155], a[40:43], v[64:79]
    ds_read_b128 a[148:151], v1 offset:17408
    v_mul_f32 v17, v115, v115
    v_fma_f32 v16, v16, v11, v10
    v_fma_f32 v17, v17, v11, v10
    v_mul_f32 v16, v16, v114
    v_mul_f32 v17, v17, v115
    v_mfma_f32_32x32x16_bf16 v[64:79], a[156:159], a[44:47], v[64:79]
    ds_read_b128 a[152:155], v1 offset:18432
    v_exp_f32 v16, v16
    v_exp_f32 v17, v17
    s_waitcnt lgkmcnt(3)
    v_mfma_f32_32x32x16_bf16 v[64:79], a[128:131], a[48:51], v[64:79]
    ds_read_b128 a[156:159], v1 offset:19456
    v_mul_f32 v114, v114, v122
    v_mul_f32 v115, v115, v123
    v_fma_f32 v16, v16, v12, v12
    v_fma_f32 v17, v17, v12, v12
    v_rcp_f32 v16, v16
    v_mfma_f32_32x32x16_bf16 v[64:79], a[132:135], a[52:55], v[64:79]
    ds_read_b128 a[128:131], v1 offset:20480
    v_rcp_f32 v17, v17
    v_mul_f32 v114, v114, v16
    v_mul_f32 v115, v115, v17
    v_cvt_pk_bf16_f32 v37, v114, v115
    v_mfma_f32_32x32x16_bf16 v[64:79], a[136:139], a[56:59], v[64:79]
    ds_read_b128 a[132:135], v1 offset:21504
    v_mul_f32 v16, v116, v116
    v_mul_f32 v17, v117, v117
    v_fma_f32 v16, v16, v11, v10
    v_fma_f32 v17, v17, v11, v10
    v_mul_f32 v16, v16, v116
    v_mfma_f32_32x32x16_bf16 v[64:79], a[140:143], a[60:63], v[64:79]
    ds_read_b128 a[136:139], v1 offset:22528
    v_mul_f32 v17, v17, v117
    v_exp_f32 v16, v16
    v_exp_f32 v17, v17
    s_waitcnt lgkmcnt(3)
    v_mfma_f32_32x32x16_bf16 v[64:79], a[144:147], a[64:67], v[64:79]
    ds_read_b128 a[140:143], v1 offset:23552
    v_mul_f32 v116, v116, v124
    v_mul_f32 v117, v117, v125
    v_fma_f32 v16, v16, v12, v12
    v_fma_f32 v17, v17, v12, v12
    v_rcp_f32 v16, v16
    v_mfma_f32_32x32x16_bf16 v[64:79], a[148:151], a[68:71], v[64:79]
    ds_read_b128 a[144:147], v1 offset:24576
    v_rcp_f32 v17, v17
    v_mul_f32 v116, v116, v16
    v_mul_f32 v117, v117, v17
    v_cvt_pk_bf16_f32 v38, v116, v117
    v_mfma_f32_32x32x16_bf16 v[64:79], a[152:155], a[72:75], v[64:79]
    ds_read_b128 a[148:151], v1 offset:25600
    v_mul_f32 v16, v118, v118
    v_mul_f32 v17, v119, v119
    v_fma_f32 v16, v16, v11, v10
    v_fma_f32 v17, v17, v11, v10
    v_mul_f32 v16, v16, v118
    v_mfma_f32_32x32x16_bf16 v[64:79], a[156:159], a[76:79], v[64:79]
    ds_read_b128 a[152:155], v1 offset:26624
    v_mul_f32 v17, v17, v119
    v_exp_f32 v16, v16
    v_exp_f32 v17, v17
    s_waitcnt lgkmcnt(3)
    v_mfma_f32_32x32x16_bf16 v[64:79], a[128:131], a[80:83], v[64:79]
    ds_read_b128 a[156:159], v1 offset:27648
    v_mul_f32 v118, v118, v126
    v_mul_f32 v119, v119, v127
    v_fma_f32 v16, v16, v12, v12
    v_fma_f32 v17, v17, v12, v12
    v_rcp_f32 v16, v16
    v_mfma_f32_32x32x16_bf16 v[64:79], a[132:135], a[84:87], v[64:79]
    ds_read_b128 a[128:131], v1 offset:28672
    v_rcp_f32 v17, v17
    v_mul_f32 v118, v118, v16
    v_mul_f32 v119, v119, v17
    v_cvt_pk_bf16_f32 v39, v118, v119
    v_mfma_f32_32x32x16_bf16 v[64:79], a[136:139], a[88:91], v[64:79]
    ds_read_b128 a[132:135], v1 offset:29696
    buffer_store_dwordx4 v[36:39], v1, s[36:39], s61 offen sc1
    s_add_u32 s61, s61, 4096
    v_mfma_f32_32x32x16_bf16 v[64:79], a[140:143], a[92:95], v[64:79]
    ds_read_b128 a[136:139], v1 offset:30720
    s_waitcnt lgkmcnt(3)
    v_mfma_f32_32x32x16_bf16 v[64:79], a[144:147], a[96:99], v[64:79]
    ds_read_b128 a[140:143], v1 offset:31744
    v_mfma_f32_32x32x16_bf16 v[64:79], a[148:151], a[100:103], v[64:79]
    ds_read_b64 a[144:145], v9 offset:1024
    v_mfma_f32_32x32x16_bf16 v[64:79], a[152:155], a[104:107], v[64:79]
    s_waitcnt vmcnt(28)
    s_barrier
    ds_read_b128 a[148:151], v1 offset:32768
    v_mfma_f32_32x32x16_bf16 v[64:79], a[156:159], a[108:111], v[64:79]
    ds_read_b128 a[152:155], v1 offset:33792
    s_waitcnt lgkmcnt(3)
    v_mfma_f32_32x32x16_bf16 v[64:79], a[128:131], a[112:115], v[64:79]
    ds_read_b128 a[156:159], v1 offset:34816
    v_mfma_f32_32x32x16_bf16 v[64:79], a[132:135], a[116:119], v[64:79]
    ds_read_b128 a[128:131], v1 offset:35840
    v_mfma_f32_32x32x16_bf16 v[64:79], a[136:139], a[120:123], v[64:79]
    ds_read_b128 a[132:135], v1 offset:36864
    v_mfma_f32_32x32x16_bf16 v[64:79], a[140:143], a[124:127], v[64:79]
    ds_read_b128 a[136:139], v1 offset:37888
    s_waitcnt lgkmcnt(3)
    v_mfma_f32_32x32x16_bf16 v[64:79], a[144:147], v[40:43], v[64:79]
    ds_read_b128 a[140:143], v1 offset:38912
    v_mfma_f32_32x32x16_bf16 v[80:95], a[148:151], a[0:3], 0
    ds_read_b128 a[144:147], v1 offset:39936
    v_mfma_f32_32x32x16_bf16 v[80:95], a[152:155], a[4:7], v[80:95]
    ds_read_b128 a[148:151], v1 offset:40960
    v_mfma_f32_32x32x16_bf16 v[80:95], a[156:159], a[8:11], v[80:95]
    ds_read_b128 a[152:155], v1 offset:41984
    s_waitcnt lgkmcnt(3)
    v_mfma_f32_32x32x16_bf16 v[80:95], a[128:131], a[12:15], v[80:95]
    ds_read_b128 a[156:159], v1 offset:43008
    s_nop 1
    v_mul_f32 v16, v64, v64
    v_mul_f32 v17, v65, v65
    v_fma_f32 v16, v16, v11, v10
    v_fma_f32 v17, v17, v11, v10
    v_mul_f32 v16, v16, v64
    v_mfma_f32_32x32x16_bf16 v[80:95], a[132:135], a[16:19], v[80:95]
    ds_read_b128 a[128:131], v1 offset:44032
    v_mul_f32 v17, v17, v65
    v_exp_f32 v16, v16
    v_exp_f32 v17, v17
    v_mfma_f32_32x32x16_bf16 v[80:95], a[136:139], a[20:23], v[80:95]
    ds_read_b128 a[132:135], v1 offset:45056
    v_mul_f32 v64, v64, v72
    v_mul_f32 v65, v65, v73
    v_fma_f32 v16, v16, v12, v12
    v_fma_f32 v17, v17, v12, v12
    v_rcp_f32 v16, v16
    v_mfma_f32_32x32x16_bf16 v[80:95], a[140:143], a[24:27], v[80:95]
    ds_read_b128 a[136:139], v1 offset:46080
    v_rcp_f32 v17, v17
    v_mul_f32 v64, v64, v16
    v_mul_f32 v65, v65, v17
    s_waitcnt lgkmcnt(3)
    v_mfma_f32_32x32x16_bf16 v[80:95], a[144:147], a[28:31], v[80:95]
    ds_read_b128 a[140:143], v1 offset:47104
    v_cvt_pk_bf16_f32 v32, v64, v65
    v_mul_f32 v16, v66, v66
    v_mul_f32 v17, v67, v67
    v_fma_f32 v16, v16, v11, v10
    v_fma_f32 v17, v17, v11, v10
    v_mfma_f32_32x32x16_bf16 v[80:95], a[148:151], a[32:35], v[80:95]
    ds_read_b128 a[144:147], v1 offset:48128
    v_mul_f32 v16, v16, v66
    v_mul_f32 v17, v17, v67
    v_exp_f32 v16, v16
    v_exp_f32 v17, v17
    v_mfma_f32_32x32x16_bf16 v[80:95], a[152:155], a[36:39], v[80:95]
    s_waitcnt vmcnt(20)
    s_barrier
    ds_read_b128 a[148:151], v1 offset:49152
    v_mul_f32 v66, v66, v74
    v_mul_f32 v67, v67, v75
    v_fma_f32 v16, v16, v12, v12
    v_mfma_f32_32x32x16_bf16 v[80:95], a[156:159], a[40:43], v[80:95]
    ds_read_b128 a[152:155], v1 offset:50176
    v_fma_f32 v17, v17, v12, v12
    v_rcp_f32 v16, v16
    v_rcp_f32 v17, v17
    s_waitcnt lgkmcnt(3)
    v_mfma_f32_32x32x16_bf16 v[80:95], a[128:131], a[44:47], v[80:95]
    ds_read_b128 a[156:159], v1 offset:51200
    v_mul_f32 v66, v66, v16
    v_mul_f32 v67, v67, v17
    v_cvt_pk_bf16_f32 v33, v66, v67
    v_mul_f32 v16, v68, v68
    v_mul_f32 v17, v69, v69
    v_mfma_f32_32x32x16_bf16 v[80:95], a[132:135], a[48:51], v[80:95]
    ds_read_b128 a[128:131], v1 offset:52224
    v_fma_f32 v16, v16, v11, v10
    v_fma_f32 v17, v17, v11, v10
    v_mul_f32 v16, v16, v68
    v_mul_f32 v17, v17, v69
    v_exp_f32 v16, v16
    v_mfma_f32_32x32x16_bf16 v[80:95], a[136:139], a[52:55], v[80:95]
    ds_read_b128 a[132:135], v1 offset:53248
    v_exp_f32 v17, v17
    v_mul_f32 v68, v68, v76
    v_mul_f32 v69, v69, v77
    v_fma_f32 v16, v16, v12, v12
    v_mfma_f32_32x32x16_bf16 v[80:95], a[140:143], a[56:59], v[80:95]
    ds_read_b128 a[136:139], v1 offset:54272
    v_fma_f32 v17, v17, v12, v12
    v_rcp_f32 v16, v16
    v_rcp_f32 v17, v17
    s_waitcnt lgkmcnt(3)
    v_mfma_f32_32x32x16_bf16 v[80:95], a[144:147], a[60:63], v[80:95]
    ds_read_b128 a[140:143], v1 offset:55296
    v_mul_f32 v68, v68, v16
    v_mul_f32 v69, v69, v17
    v_cvt_pk_bf16_f32 v34, v68, v69
    v_mul_f32 v16, v70, v70
    v_mul_f32 v17, v71, v71
    v_mfma_f32_32x32x16_bf16 v[80:95], a[148:151], a[64:67], v[80:95]
    ds_read_b128 a[144:147], v1 offset:56320
    v_fma_f32 v16, v16, v11, v10
    v_fma_f32 v17, v17, v11, v10
    v_mul_f32 v16, v16, v70
    v_mul_f32 v17, v17, v71
    v_exp_f32 v16, v16
    v_mfma_f32_32x32x16_bf16 v[80:95], a[152:155], a[68:71], v[80:95]
    ds_read_b128 a[148:151], v1 offset:57344
    v_exp_f32 v17, v17
    v_mul_f32 v70, v70, v78
    v_mul_f32 v71, v71, v79
    v_fma_f32 v16, v16, v12, v12
    v_mfma_f32_32x32x16_bf16 v[80:95], a[156:159], a[72:75], v[80:95]
    ds_read_b128 a[152:155], v1 offset:58368
    v_fma_f32 v17, v17, v12, v12
    v_rcp_f32 v16, v16
    v_rcp_f32 v17, v17
    s_waitcnt lgkmcnt(3)
    v_mfma_f32_32x32x16_bf16 v[80:95], a[128:131], a[76:79], v[80:95]
    ds_read_b128 a[156:159], v1 offset:59392
    v_mul_f32 v70, v70, v16
    v_mul_f32 v71, v71, v17
    v_cvt_pk_bf16_f32 v35, v70, v71
    buffer_store_dwordx4 v[32:35], v1, s[36:39], s61 offen sc1
    s_add_u32 s61, s61, 4096
    v_mfma_f32_32x32x16_bf16 v[80:95], a[132:135], a[80:83], v[80:95]
    ds_read_b128 a[128:131], v1 offset:60416
    v_mfma_f32_32x32x16_bf16 v[80:95], a[136:139], a[84:87], v[80:95]
    ds_read_b128 a[132:135], v1 offset:61440
    v_mfma_f32_32x32x16_bf16 v[80:95], a[140:143], a[88:91], v[80:95]
    ds_read_b128 a[136:139], v1 offset:62464
    s_waitcnt lgkmcnt(3)
    v_mfma_f32_32x32x16_bf16 v[80:95], a[144:147], a[92:95], v[80:95]
    ds_read_b128 a[140:143], v1 offset:63488
    v_mfma_f32_32x32x16_bf16 v[80:95], a[148:151], a[96:99], v[80:95]
    ds_read_b128 a[144:147], v1 offset:64512
    v_mfma_f32_32x32x16_bf16 v[80:95], a[152:155], a[100:103], v[80:95]
    ds_read_b64 a[148:149], v9 offset:1280
    v_mfma_f32_32x32x16_bf16 v[80:95], a[156:159], a[104:107], v[80:95]
    s_waitcnt vmcnt(13)
    s_waitcnt vmcnt(1)
    s_barrier
    s_cmp_lg_u32 s3, 0
    s_cbranch_scc1 sq24
    s_lshl_b32 s4, s44, 8
    s_lshr_b32 s5, s45, 2
    s_lshl_b32 s5, s5, 5
    s_add_u32 s4, s4, s5
    s_add_u32 s4, s4, 7815168
    v_mov_b32 v8, 1
    s_mov_b64 exec, 1
    buffer_atomic_add v8, off, s[36:39], s4 sc1
    s_mov_b64 exec, -1
sq24:
    ds_read_b128 a[152:155], v5 offset:0
    s_waitcnt lgkmcnt(3)
    v_mfma_f32_32x32x16_bf16 v[80:95], a[128:131], a[108:111], v[80:95]
    ds_read_b128 a[156:159], v5 offset:1024
    v_mfma_f32_32x32x16_bf16 v[80:95], a[132:135], a[112:115], v[80:95]
    ds_read_b128 a[128:131], v5 offset:2048
    v_mfma_f32_32x32x16_bf16 v[80:95], a[136:139], a[116:119], v[80:95]
    ds_read_b128 a[132:135], v5 offset:3072
    v_mfma_f32_32x32x16_bf16 v[80:95], a[140:143], a[120:123], v[80:95]
    ds_read_b128 a[136:139], v5 offset:4096
    s_waitcnt lgkmcnt(3)
    v_mfma_f32_32x32x16_bf16 v[80:95], a[144:147], a[124:127], v[80:95]
    ds_read_b128 a[140:143], v5 offset:5120
    v_mfma_f32_32x32x16_bf16 v[80:95], a[148:151], v[40:43], v[80:95]
    ds_read_b128 a[144:147], v5 offset:6144
    v_mfma_f32_32x32x16_bf16 v[96:111], a[152:155], a[0:3], 0
    ds_read_b128 a[148:151], v5 offset:7168
    v_mfma_f32_32x32x16_bf16 v[96:111], a[156:159], a[4:7], v[96:111]
    ds_read_b128 a[152:155], v5 offset:8192
    s_waitcnt lgkmcnt(3)
    v_mfma_f32_32x32x16_bf16 v[96:111], a[128:131], a[8:11], v[96:111]
    ds_read_b128 a[156:159], v5 offset:9216
    v_mfma_f32_32x32x16_bf16 v[96:111], a[132:135], a[12:15], v[96:111]
    ds_read_b128 a[128:131], v5 offset:10240
    s_nop 1
    v_mul_f32 v16, v80, v80
    v_mul_f32 v17, v81, v81
    v_fma_f32 v16, v16, v11, v10
    v_fma_f32 v17, v17, v11, v10
    v_mul_f32 v16, v16, v80
    v_mfma_f32_32x32x16_bf16 v[96:111], a[136:139], a[16:19], v[96:111]
    ds_read_b128 a[132:135], v5 offset:11264
    v_mul_f32 v17, v17, v81
    v_exp_f32 v16, v16
    v_exp_f32 v17, v17
    v_mfma_f32_32x32x16_bf16 v[96:111], a[140:143], a[20:23], v[96:111]
    ds_read_b128 a[136:139], v5 offset:12288
    v_mul_f32 v80, v80, v88
    v_mul_f32 v81, v81, v89
    v_fma_f32 v16, v16, v12, v12
    v_fma_f32 v17, v17, v12, v12
    s_waitcnt lgkmcnt(3)
    v_mfma_f32_32x32x16_bf16 v[96:111], a[144:147], a[24:27], v[96:111]
    ds_read_b128 a[140:143], v5 offset:13312
    v_rcp_f32 v16, v16
    v_rcp_f32 v17, v17
    v_mul_f32 v80, v80, v16
    v_mfma_f32_32x32x16_bf16 v[96:111], a[148:151], a[28:31], v[96:111]
    ds_read_b128 a[144:147], v5 offset:14336
    v_mul_f32 v81, v81, v17
    v_cvt_pk_bf16_f32 v36, v80, v81
    v_mul_f32 v16, v82, v82
    v_mul_f32 v17, v83, v83
    v_fma_f32 v16, v16, v11, v10
    v_mfma_f32_32x32x16_bf16 v[96:111], a[152:155], a[32:35], v[96:111]
    ds_read_b128 a[148:151], v5 offset:15360
    v_fma_f32 v17, v17, v11, v10
    v_mul_f32 v16, v16, v82
    v_mul_f32 v17, v17, v83
    v_exp_f32 v16, v16
    v_mfma_f32_32x32x16_bf16 v[96:111], a[156:159], a[36:39], v[96:111]
    s_barrier
    ds_read_b128 a[152:155], v5 offset:16384
    v_exp_f32 v17, v17
    v_mul_f32 v82, v82, v90
    s_waitcnt lgkmcnt(3)
    v_mfma_f32_32x32x16_bf16 v[96:111], a[128:131], a[40:43], v[96:111]
    ds_read_b128 a[156:159], v5 offset:17408
    v_mul_f32 v83, v83, v91
    v_fma_f32 v16, v16, v12, v12
    v_fma_f32 v17, v17, v12, v12
    v_rcp_f32 v16, v16
    v_mfma_f32_32x32x16_bf16 v[96:111], a[132:135], a[44:47], v[96:111]
    ds_read_b128 a[128:131], v5 offset:18432
    v_rcp_f32 v17, v17
    v_mul_f32 v82, v82, v16
    v_mul_f32 v83, v83, v17
    v_cvt_pk_bf16_f32 v37, v82, v83
    v_mfma_f32_32x32x16_bf16 v[96:111], a[136:139], a[48:51], v[96:111]
    ds_read_b128 a[132:135], v5 offset:19456
    v_mul_f32 v16, v84, v84
    v_mul_f32 v17, v85, v85
    v_fma_f32 v16, v16, v11, v10
    v_fma_f32 v17, v17, v11, v10
    v_mul_f32 v16, v16, v84
    v_mfma_f32_32x32x16_bf16 v[96:111], a[140:143], a[52:55], v[96:111]
    ds_read_b128 a[136:139], v5 offset:20480
    v_mul_f32 v17, v17, v85
    v_exp_f32 v16, v16
    v_exp_f32 v17, v17
    s_waitcnt lgkmcnt(3)
    v_mfma_f32_32x32x16_bf16 v[96:111], a[144:147], a[56:59], v[96:111]
    ds_read_b128 a[140:143], v5 offset:21504
    v_mul_f32 v84, v84, v92
    v_mul_f32 v85, v85, v93
    v_fma_f32 v16, v16, v12, v12
    v_fma_f32 v17, v17, v12, v12
    v_rcp_f32 v16, v16
    v_mfma_f32_32x32x16_bf16 v[96:111], a[148:151], a[60:63], v[96:111]
    ds_read_b128 a[144:147], v5 offset:22528
    v_rcp_f32 v17, v17
    v_mul_f32 v84, v84, v16
    v_mul_f32 v85, v85, v17
    v_cvt_pk_bf16_f32 v38, v84, v85
    v_mfma_f32_32x32x16_bf16 v[96:111], a[152:155], a[64:67], v[96:111]
    ds_read_b128 a[148:151], v5 offset:23552
    v_mul_f32 v16, v86, v86
    v_mul_f32 v17, v87, v87
    v_fma_f32 v16, v16, v11, v10
    v_fma_f32 v17, v17, v11, v10
    v_mul_f32 v16, v16, v86
    v_mfma_f32_32x32x16_bf16 v[96:111], a[156:159], a[68:71], v[96:111]
    ds_read_b128 a[152:155], v5 offset:24576
    v_mul_f32 v17, v17, v87
    v_exp_f32 v16, v16
    v_exp_f32 v17, v17
    s_waitcnt lgkmcnt(3)
    v_mfma_f32_32x32x16_bf16 v[96:111], a[128:131], a[72:75], v[96:111]
    ds_read_b128 a[156:159], v5 offset:25600
    v_mul_f32 v86, v86, v94
    v_mul_f32 v87, v87, v95
    v_fma_f32 v16, v16, v12, v12
    v_fma_f32 v17, v17, v12, v12
    v_rcp_f32 v16, v16
    v_mfma_f32_32x32x16_bf16 v[96:111], a[132:135], a[76:79], v[96:111]
    ds_read_b128 a[128:131], v5 offset:26624
    v_rcp_f32 v17, v17
    v_mul_f32 v86, v86, v16
    v_mul_f32 v87, v87, v17
    v_cvt_pk_bf16_f32 v39, v86, v87
    v_mfma_f32_32x32x16_bf16 v[96:111], a[136:139], a[80:83], v[96:111]
    ds_read_b128 a[132:135], v5 offset:27648
    buffer_store_dwordx4 v[36:39], v1, s[36:39], s61 offen sc1
    s_add_u32 s61, s61, 4096
    v_mfma_f32_32x32x16_bf16 v[96:111], a[140:143], a[84:87], v[96:111]
    ds_read_b128 a[136:139], v5 offset:28672
    s_waitcnt lgkmcnt(3)
    v_mfma_f32_32x32x16_bf16 v[96:111], a[144:147], a[88:91], v[96:111]
    ds_read_b128 a[140:143], v5 offset:29696
    v_mfma_f32_32x32x16_bf16 v[96:111], a[148:151], a[92:95], v[96:111]
    ds_read_b128 a[144:147], v5 offset:30720
    v_mfma_f32_32x32x16_bf16 v[96:111], a[152:155], a[96:99], v[96:111]
    ds_read_b128 a[148:151], v5 offset:31744
    v_mfma_f32_32x32x16_bf16 v[96:111], a[156:159], a[100:103], v[96:111]
    ds_read_b64 a[152:153], v9 offset:1536
    s_waitcnt lgkmcnt(3)
    v_mfma_f32_32x32x16_bf16 v[96:111], a[128:131], a[104:107], v[96:111]
    v_mfma_f32_32x32x16_bf16 v[96:111], a[132:135], a[108:111], v[96:111]
    v_mfma_f32_32x32x16_bf16 v[96:111], a[136:139], a[112:115], v[96:111]
    v_mfma_f32_32x32x16_bf16 v[96:111], a[140:143], a[116:119], v[96:111]
    s_waitcnt lgkmcnt(0)
    v_mfma_f32_32x32x16_bf16 v[96:111], a[144:147], a[120:123], v[96:111]
    v_mfma_f32_32x32x16_bf16 v[96:111], a[148:151], a[124:127], v[96:111]
    v_mfma_f32_32x32x16_bf16 v[96:111], a[152:155], v[40:43], v[96:111]
    s_lshl_b32 s54, s44, 8
    s_lshl_b32 s4, s3, 5
    s_add_u32 s54, s54, s4
    s_add_u32 s54, s54, 7815168
    buffer_load_dword v4, off, s[36:39], s54 sc1
    s_nop 6
    v_mul_f32 v16, v96, v96
    v_mul_f32 v17, v97, v97
    v_fma_f32 v16, v16, v11, v10
    v_fma_f32 v17, v17, v11, v10
    v_mul_f32 v16, v16, v96
    v_mul_f32 v17, v17, v97
    v_exp_f32 v16, v16
    v_exp_f32 v17, v17
    v_mul_f32 v96, v96, v104
    v_mul_f32 v97, v97, v105
    v_fma_f32 v16, v16, v12, v12
    v_fma_f32 v17, v17, v12, v12
    v_rcp_f32 v16, v16
    v_rcp_f32 v17, v17
    v_mul_f32 v96, v96, v16
    v_mul_f32 v97, v97, v17
    v_cvt_pk_bf16_f32 v32, v96, v97
    v_mul_f32 v16, v98, v98
    v_mul_f32 v17, v99, v99
    v_fma_f32 v16, v16, v11, v10
    v_fma_f32 v17, v17, v11, v10
    v_mul_f32 v16, v16, v98
    v_mul_f32 v17, v17, v99
    v_exp_f32 v16, v16
    v_exp_f32 v17, v17
    v_mul_f32 v98, v98, v106
    v_mul_f32 v99, v99, v107
    v_fma_f32 v16, v16, v12, v12
    v_fma_f32 v17, v17, v12, v12
    v_rcp_f32 v16, v16
    v_rcp_f32 v17, v17
    v_mul_f32 v98, v98, v16
    v_mul_f32 v99, v99, v17
    v_cvt_pk_bf16_f32 v33, v98, v99
    v_mul_f32 v16, v100, v100
    v_mul_f32 v17, v101, v101
    v_fma_f32 v16, v16, v11, v10
    v_fma_f32 v17, v17, v11, v10
    v_mul_f32 v16, v16, v100
    v_mul_f32 v17, v17, v101
    v_exp_f32 v16, v16
    v_exp_f32 v17, v17
    v_mul_f32 v100, v100, v108
    v_mul_f32 v101, v101, v109
    v_fma_f32 v16, v16, v12, v12
    v_fma_f32 v17, v17, v12, v12
    v_rcp_f32 v16, v16
    v_rcp_f32 v17, v17
    v_mul_f32 v100, v100, v16
    v_mul_f32 v101, v101, v17
    v_cvt_pk_bf16_f32 v34, v100, v101
    v_mul_f32 v16, v102, v102
    v_mul_f32 v17, v103, v103
    v_fma_f32 v16, v16, v11, v10
    v_fma_f32 v17, v17, v11, v10
    v_mul_f32 v16, v16, v102
    v_mul_f32 v17, v17, v103
    v_exp_f32 v16, v16
    v_exp_f32 v17, v17
    v_mul_f32 v102, v102, v110
    v_mul_f32 v103, v103, v111
    v_fma_f32 v16, v16, v12, v12
    v_fma_f32 v17, v17, v12, v12
    v_rcp_f32 v16, v16
    v_rcp_f32 v17, v17
    v_mul_f32 v102, v102, v16
    v_mul_f32 v103, v103, v17
    v_cvt_pk_bf16_f32 v35, v102, v103
    buffer_store_dwordx4 v[32:35], v1, s[36:39], s61 offen sc1
    s_add_u32 s61, s61, 4096
    s_waitcnt vmcnt(1)
    v_readfirstlane_b32 s4, v4
    s_mov_b32 s5, 0
    s_cmp_ge_u32 s4, 4
    s_cbranch_scc1 pc25_ok
pc25_loop:
    buffer_load_dword v4, off, s[36:39], s54 sc1
    s_add_u32 s5, s5, 1
    s_waitcnt vmcnt(0)
    v_readfirstlane_b32 s4, v4
    s_cmp_gt_u32 s5, 0x40000
    s_cbranch_scc1 pc25_ok
    s_cmp_lt_u32 s4, 4
    s_cbranch_scc1 pc25_loop
pc25_ok:
    s_lshl_b32 s6, s44, 1
    s_lshr_b32 s7, s45, 3
    s_add_u32 s6, s6, s7
    s_and_b32 s7, s45, 7
    s_lshr_b32 s11, s3, 1
    s_lshl_b32 s12, s6, 1
    s_add_u32 s11, s11, s12
    s_and_b32 s12, s3, 1
    s_lshl_b32 s13, s7, 1
    s_add_u32 s12, s12, s13
    s_lshl_b32 s13, s11, 15
    s_lshl_b32 s14, s12, 11
    s_add_u32 s13, s13, s14
    s_add_u32 s14, s13, 15728640
    buffer_load_dwordx4 v[80:83], v1, s[36:39], s14 offen sc1
    buffer_load_dwordx4 v[84:87], v1, s[36:39], s14 offen offset:1024 sc1
    s_mul_i32 s10, s3, 28672
    s_add_u32 s10, s10, 29360128
    s_mul_i32 s8, s11, 114688
    s_add_u32 s8, s8, s10
    s_xor_b32 s9, s11, 1
    s_mul_i32 s9, s9, 114688
    s_add_u32 s9, s9, s10
    s_and_b32 s10, s44, 0
    s_add_u32 s10, s10, s7
    s_and_b32 s10, s10, 3
    s_lshl_b32 s10, s10, 12
    s_add_u32 s6, s9, s10
    s_lshl_b32 s55, s60, 12
    s_add_u32 s55, s55, 0x4000
    s_lshl_b32 s13, s11, 15
    s_lshl_b32 s14, s12, 6
    s_add_u32 s13, s13, s14
    v_lshlrev_b32 v6, 10, v2
    v_lshl_add_u32 v6, v3, 4, v6
    buffer_load_dwordx4 a[0:3], v1, s[36:39], s6 offen offset:0 sc1
    buffer_load_dwordx4 a[4:7], v1, s[36:39], s6 offen offset:1024 sc1
    buffer_load_dwordx4 a[8:11], v1, s[36:39], s6 offen offset:2048 sc1
    buffer_load_dwordx4 a[12:15], v1, s[36:39], s6 offen offset:3072 sc1
    s_add_u32 s10, s10, 4096
    s_and_b32 s10, s10, 0x3fff
    s_add_u32 s6, s9, s10
    buffer_load_dwordx4 a[16:19], v1, s[36:39], s6 offen offset:0 sc1
    buffer_load_dwordx4 a[20:23], v1, s[36:39], s6 offen offset:1024 sc1
    buffer_load_dwordx4 a[24:27], v1, s[36:39], s6 offen offset:2048 sc1
    buffer_load_dwordx4 a[28:31], v1, s[36:39], s6 offen offset:3072 sc1
    s_add_u32 s10, s10, 4096
    s_and_b32 s10, s10, 0x3fff
    s_add_u32 s6, s9, s10
    buffer_load_dwordx4 a[32:35], v1, s[36:39], s6 offen offset:0 sc1
    buffer_load_dwordx4 a[36:39], v1, s[36:39], s6 offen offset:1024 sc1
    buffer_load_dwordx4 a[40:43], v1, s[36:39], s6 offen offset:2048 sc1
    buffer_load_dwordx4 a[44:47], v1, s[36:39], s6 offen offset:3072 sc1
    s_add_u32 s10, s10, 4096
    s_and_b32 s10, s10, 0x3fff
    s_add_u32 s6, s9, s10
    s_waitcnt vmcnt(11)
    s_barrier
    s_cmp_lg_u32 s3, 0
    s_cbranch_scc1 sq26
    s_lshl_b32 s4, s44, 8
    s_lshr_b32 s5, s45, 2
    s_lshl_b32 s5, s5, 5
    s_add_u32 s4, s4, s5
    s_add_u32 s4, s4, 7815296
    v_mov_b32 v8, 1
    s_mov_b64 exec, 1
    buffer_atomic_add v8, off, s[36:39], s4 sc1
    s_mov_b64 exec, -1
sq26:
    v_mfma_f32_32x32x16_bf16 v[48:63], a[160:163], a[0:3], 0
    buffer_load_dwordx4 a[48:51], v1, s[36:39], s6 offen offset:0 sc1
    v_mfma_f32_32x32x16_bf16 v[64:79], a[164:167], a[0:3], 0
    s_waitcnt vmcnt(11)
    v_mfma_f32_32x32x16_bf16 v[48:63], a[168:171], a[4:7], v[48:63]
    buffer_load_dwordx4 a[52:55], v1, s[36:39], s6 offen offset:1024 sc1
    v_mfma_f32_32x32x16_bf16 v[64:79], a[172:175], a[4:7], v[64:79]
    s_waitcnt vmcnt(11)
    v_mfma_f32_32x32x16_bf16 v[48:63], a[176:179], a[8:11], v[48:63]
    buffer_load_dwordx4 a[56:59], v1, s[36:39], s6 offen offset:2048 sc1
    v_mfma_f32_32x32x16_bf16 v[64:79], a[180:183], a[8:11], v[64:79]
    s_waitcnt vmcnt(11)
    v_mfma_f32_32x32x16_bf16 v[48:63], a[184:187], a[12:15], v[48:63]
    buffer_load_dwordx4 a[60:63], v1, s[36:39], s6 offen offset:3072 sc1
    s_add_u32 s10, s10, 4096
    s_and_b32 s10, s10, 0x3fff
    s_add_u32 s6, s8, s10
    v_mfma_f32_32x32x16_bf16 v[64:79], a[188:191], a[12:15], v[64:79]
    s_waitcnt vmcnt(11)
    v_mfma_f32_32x32x16_bf16 v[48:63], a[192:195], a[16:19], v[48:63]
    buffer_load_dwordx4 a[64:67], v1, s[36:39], s6 offen offset:0 sc1
    v_mfma_f32_32x32x16_bf16 v[64:79], a[196:199], a[16:19], v[64:79]
    s_waitcnt vmcnt(11)
    v_mfma_f32_32x32x16_bf16 v[48:63], a[200:203], a[20:23], v[48:63]
    buffer_load_dwordx4 a[68:71], v1, s[36:39], s6 offen offset:1024 sc1
    v_mfma_f32_32x32x16_bf16 v[64:79], a[204:207], a[20:23], v[64:79]
    s_waitcnt vmcnt(11)
    v_mfma_f32_32x32x16_bf16 v[48:63], a[208:211], a[24:27], v[48:63]
    buffer_load_dwordx4 a[72:75], v1, s[36:39], s6 offen offset:2048 sc1
    v_mfma_f32_32x32x16_bf16 v[64:79], a[212:215], a[24:27], v[64:79]
    s_waitcnt vmcnt(11)
    v_mfma_f32_32x32x16_bf16 v[48:63], a[216:219], a[28:31], v[48:63]
    buffer_load_dwordx4 a[76:79], v1, s[36:39], s6 offen offset:3072 sc1
    s_add_u32 s10, s10, 4096
    s_and_b32 s10, s10, 0x3fff
    s_add_u32 s6, s8, s10
    v_mfma_f32_32x32x16_bf16 v[64:79], a[220:223], a[28:31], v[64:79]
    s_waitcnt vmcnt(11)
    v_mfma_f32_32x32x16_bf16 v[48:63], a[224:227], a[32:35], v[48:63]
    buffer_load_dwordx4 a[80:83], v1, s[36:39], s6 offen offset:0 sc1
    v_mfma_f32_32x32x16_bf16 v[64:79], a[228:231], a[32:35], v[64:79]
    s_waitcnt vmcnt(11)
    v_mfma_f32_32x32x16_bf16 v[48:63], a[232:235], a[36:39], v[48:63]
    buffer_load_dwordx4 a[84:87], v1, s[36:39], s6 offen offset:1024 sc1
    v_mfma_f32_32x32x16_bf16 v[64:79], a[236:239], a[36:39], v[64:79]
    s_waitcnt vmcnt(11)
    v_mfma_f32_32x32x16_bf16 v[48:63], a[240:243], a[40:43], v[48:63]
    buffer_load_dwordx4 a[88:91], v1, s[36:39], s6 offen offset:2048 sc1
    v_mfma_f32_32x32x16_bf16 v[64:79], a[244:247], a[40:43], v[64:79]
    s_waitcnt vmcnt(11)
    v_mfma_f32_32x32x16_bf16 v[48:63], a[248:251], a[44:47], v[48:63]
    buffer_load_dwordx4 a[92:95], v1, s[36:39], s6 offen offset:3072 sc1
    s_add_u32 s10, s10, 4096
    s_and_b32 s10, s10, 0x3fff
    s_add_u32 s6, s8, s10
    v_mfma_f32_32x32x16_bf16 v[64:79], a[252:255], a[44:47], v[64:79]
    s_waitcnt vmcnt(11)
    v_mfma_f32_32x32x16_bf16 v[48:63], v[224:227], a[48:51], v[48:63]
    buffer_load_dwordx4 a[96:99], v1, s[36:39], s6 offen offset:0 sc1
    v_mfma_f32_32x32x16_bf16 v[64:79], v[228:231], a[48:51], v[64:79]
    s_waitcnt vmcnt(11)
    v_mfma_f32_32x32x16_bf16 v[48:63], v[232:235], a[52:55], v[48:63]
    buffer_load_dwordx4 a[100:103], v1, s[36:39], s6 offen offset:1024 sc1
    v_mfma_f32_32x32x16_bf16 v[64:79], v[236:239], a[52:55], v[64:79]
    s_waitcnt vmcnt(11)
    v_mfma_f32_32x32x16_bf16 v[48:63], v[240:243], a[56:59], v[48:63]
    buffer_load_dwordx4 a[104:107], v1, s[36:39], s6 offen offset:2048 sc1
    s_lshl_b32 s54, s44, 8
    s_lshl_b32 s4, s3, 5
    s_add_u32 s54, s54, s4
    s_add_u32 s54, s54, 7815296
    buffer_load_dword v104, off, s[36:39], s54 sc1
    v_mfma_f32_32x32x16_bf16 v[64:79], v[244:247], a[56:59], v[64:79]
    s_waitcnt vmcnt(12)
    v_mfma_f32_32x32x16_bf16 v[48:63], v[248:251], a[60:63], v[48:63]
    buffer_load_dwordx4 a[108:111], v1, s[36:39], s6 offen offset:3072 sc1
    s_add_u32 s10, s10, 4096
    s_and_b32 s10, s10, 0x3fff
    s_add_u32 s6, s8, s10
    v_mfma_f32_32x32x16_bf16 v[64:79], v[252:255], a[60:63], v[64:79]
    s_waitcnt vmcnt(12)
    v_mfma_f32_32x32x16_bf16 v[32:47], a[164:167], a[64:67], 0
    buffer_load_dwordx4 a[112:115], v1, s[36:39], s6 offen offset:0 sc1
    v_mfma_f32_32x32x16_bf16 v[16:31], a[160:163], a[64:67], 0
    s_waitcnt vmcnt(12)
    v_mfma_f32_32x32x16_bf16 v[32:47], a[172:175], a[68:71], v[32:47]
    buffer_load_dwordx4 a[116:119], v1, s[36:39], s6 offen offset:1024 sc1
    v_mfma_f32_32x32x16_bf16 v[16:31], a[168:171], a[68:71], v[16:31]
    s_waitcnt vmcnt(12)
    v_mfma_f32_32x32x16_bf16 v[32:47], a[180:183], a[72:75], v[32:47]
    buffer_load_dwordx4 a[120:123], v1, s[36:39], s6 offen offset:2048 sc1
    v_mfma_f32_32x32x16_bf16 v[16:31], a[176:179], a[72:75], v[16:31]
    s_waitcnt vmcnt(12)
    v_mfma_f32_32x32x16_bf16 v[32:47], a[188:191], a[76:79], v[32:47]
    buffer_load_dwordx4 a[124:127], v1, s[36:39], s6 offen offset:3072 sc1
    s_add_u32 s6, s9, s55
    s_add_u32 s55, s55, 4096
    s_cmp_eq_u32 s55, 0x7000
    s_cselect_b32 s55, 0x4000, s55
    v_mfma_f32_32x32x16_bf16 v[16:31], a[184:187], a[76:79], v[16:31]
    s_waitcnt vmcnt(12)
    v_mfma_f32_32x32x16_bf16 v[32:47], a[196:199], a[80:83], v[32:47]
    s_waitcnt vmcnt(5)
    v_readfirstlane_b32 s4, v104
    s_mov_b32 s5, 0
    s_cmp_ge_u32 s4, 4
    s_cbranch_scc1 pc27_ok
pc27_loop:
    buffer_load_dword v104, off, s[36:39], s54 sc1
    s_add_u32 s5, s5, 1
    s_waitcnt vmcnt(0)
    v_readfirstlane_b32 s4, v104
    s_cmp_gt_u32 s5, 0x40000
    s_cbranch_scc1 pc27_ok
    s_cmp_lt_u32 s4, 4
    s_cbranch_scc1 pc27_loop
pc27_ok:
    buffer_load_dwordx4 a[0:3], v1, s[36:39], s6 offen offset:0 sc1
    v_mfma_f32_32x32x16_bf16 v[16:31], a[192:195], a[80:83], v[16:31]
    v_mfma_f32_32x32x16_bf16 v[32:47], a[204:207], a[84:87], v[32:47]
    buffer_load_dwordx4 a[4:7], v1, s[36:39], s6 offen offset:1024 sc1
    v_mfma_f32_32x32x16_bf16 v[16:31], a[200:203], a[84:87], v[16:31]
    v_mfma_f32_32x32x16_bf16 v[32:47], a[212:215], a[88:91], v[32:47]
    buffer_load_dwordx4 a[8:11], v1, s[36:39], s6 offen offset:2048 sc1
    v_mfma_f32_32x32x16_bf16 v[16:31], a[208:211], a[88:91], v[16:31]
    v_mfma_f32_32x32x16_bf16 v[32:47], a[220:223], a[92:95], v[32:47]
    buffer_load_dwordx4 a[12:15], v1, s[36:39], s6 offen offset:3072 sc1
    s_add_u32 s6, s9, s55
    s_add_u32 s55, s55, 4096
    s_cmp_eq_u32 s55, 0x7000
    s_cselect_b32 s55, 0x4000, s55
    v_mfma_f32_32x32x16_bf16 v[16:31], a[216:219], a[92:95], v[16:31]
    v_mfma_f32_32x32x16_bf16 v[32:47], a[228:231], a[96:99], v[32:47]
    buffer_load_dwordx4 a[16:19], v1, s[36:39], s6 offen offset:0 sc1
    v_mfma_f32_32x32x16_bf16 v[16:31], a[224:227], a[96:99], v[16:31]
    v_mfma_f32_32x32x16_bf16 v[32:47], a[236:239], a[100:103], v[32:47]
    buffer_load_dwordx4 a[20:23], v1, s[36:39], s6 offen offset:1024 sc1
    v_mfma_f32_32x32x16_bf16 v[16:31], a[232:235], a[100:103], v[16:31]
    v_mfma_f32_32x32x16_bf16 v[32:47], a[244:247], a[104:107], v[32:47]
    buffer_load_dwordx4 a[24:27], v1, s[36:39], s6 offen offset:2048 sc1
    v_mfma_f32_32x32x16_bf16 v[16:31], a[240:243], a[104:107], v[16:31]
    s_waitcnt vmcnt(11)
    v_mfma_f32_32x32x16_bf16 v[32:47], a[252:255], a[108:111], v[32:47]
    buffer_load_dwordx4 a[28:31], v1, s[36:39], s6 offen offset:3072 sc1
    s_add_u32 s6, s9, s55
    s_add_u32 s55, s55, 4096
    s_cmp_eq_u32 s55, 0x7000
    s_cselect_b32 s55, 0x4000, s55
    v_mfma_f32_32x32x16_bf16 v[16:31], a[248:251], a[108:111], v[16:31]
    s_waitcnt vmcnt(11)
    v_mfma_f32_32x32x16_bf16 v[32:47], v[228:231], a[112:115], v[32:47]
    buffer_load_dwordx4 a[32:35], v1, s[36:39], s6 offen offset:0 sc1
    v_mfma_f32_32x32x16_bf16 v[16:31], v[224:227], a[112:115], v[16:31]
    s_waitcnt vmcnt(11)
    v_mfma_f32_32x32x16_bf16 v[32:47], v[236:239], a[116:119], v[32:47]
    buffer_load_dwordx4 a[36:39], v1, s[36:39], s6 offen offset:1024 sc1
    v_mfma_f32_32x32x16_bf16 v[16:31], v[232:235], a[116:119], v[16:31]
    s_waitcnt vmcnt(11)
    v_mfma_f32_32x32x16_bf16 v[32:47], v[244:247], a[120:123], v[32:47]
    buffer_load_dwordx4 a[40:43], v1, s[36:39], s6 offen offset:2048 sc1
    v_mfma_f32_32x32x16_bf16 v[16:31], v[240:243], a[120:123], v[16:31]
    s_waitcnt vmcnt(11)
    v_mfma_f32_32x32x16_bf16 v[32:47], v[252:255], a[124:127], v[32:47]
    buffer_load_dwordx4 a[44:47], v1, s[36:39], s6 offen offset:3072 sc1
    s_add_u32 s6, s8, s55
    s_add_u32 s55, s55, 4096
    s_cmp_eq_u32 s55, 0x7000
    s_cselect_b32 s55, 0x4000, s55
    v_mfma_f32_32x32x16_bf16 v[16:31], v[248:251], a[124:127], v[16:31]
    s_waitcnt vmcnt(11)
    v_mfma_f32_32x32x16_bf16 v[48:63], v[176:179], a[0:3], v[48:63]
    buffer_load_dwordx4 a[48:51], v1, s[36:39], s6 offen offset:0 sc1
    v_mfma_f32_32x32x16_bf16 v[64:79], v[180:183], a[0:3], v[64:79]
    s_waitcnt vmcnt(11)
    v_mfma_f32_32x32x16_bf16 v[48:63], v[184:187], a[4:7], v[48:63]
    buffer_load_dwordx4 a[52:55], v1, s[36:39], s6 offen offset:1024 sc1
    v_mfma_f32_32x32x16_bf16 v[64:79], v[188:191], a[4:7], v[64:79]
    s_waitcnt vmcnt(11)
    v_mfma_f32_32x32x16_bf16 v[48:63], v[192:195], a[8:11], v[48:63]
    buffer_load_dwordx4 a[56:59], v1, s[36:39], s6 offen offset:2048 sc1
    v_mfma_f32_32x32x16_bf16 v[64:79], v[196:199], a[8:11], v[64:79]
    s_waitcnt vmcnt(11)
    v_mfma_f32_32x32x16_bf16 v[48:63], v[200:203], a[12:15], v[48:63]
    buffer_load_dwordx4 a[60:63], v1, s[36:39], s6 offen offset:3072 sc1
    s_add_u32 s6, s8, s55
    s_add_u32 s55, s55, 4096
    s_cmp_eq_u32 s55, 0x7000
    s_cselect_b32 s55, 0x4000, s55
    v_mfma_f32_32x32x16_bf16 v[64:79], v[204:207], a[12:15], v[64:79]
    s_waitcnt vmcnt(11)
    v_mfma_f32_32x32x16_bf16 v[48:63], v[208:211], a[16:19], v[48:63]
    buffer_load_dwordx4 a[64:67], v1, s[36:39], s6 offen offset:0 sc1
    v_mfma_f32_32x32x16_bf16 v[64:79], v[212:215], a[16:19], v[64:79]
    s_waitcnt vmcnt(11)
    v_mfma_f32_32x32x16_bf16 v[48:63], v[216:219], a[20:23], v[48:63]
    buffer_load_dwordx4 a[68:71], v1, s[36:39], s6 offen offset:1024 sc1
    v_mfma_f32_32x32x16_bf16 v[64:79], v[220:223], a[20:23], v[64:79]
    s_waitcnt vmcnt(11)
    v_mfma_f32_32x32x16_bf16 v[48:63], v[128:131], a[24:27], v[48:63]
    buffer_load_dwordx4 a[72:75], v1, s[36:39], s6 offen offset:2048 sc1
    v_mfma_f32_32x32x16_bf16 v[64:79], v[132:135], a[24:27], v[64:79]
    s_waitcnt vmcnt(11)
    v_mfma_f32_32x32x16_bf16 v[48:63], v[136:139], a[28:31], v[48:63]
    buffer_load_dwordx4 a[76:79], v1, s[36:39], s6 offen offset:3072 sc1
    s_add_u32 s6, s8, s55
    s_add_u32 s55, s55, 4096
    s_cmp_eq_u32 s55, 0x7000
    s_cselect_b32 s55, 0x4000, s55
    v_mfma_f32_32x32x16_bf16 v[64:79], v[140:143], a[28:31], v[64:79]
    s_waitcnt vmcnt(11)
    v_mfma_f32_32x32x16_bf16 v[48:63], v[144:147], a[32:35], v[48:63]
    buffer_load_dwordx4 a[80:83], v1, s[36:39], s6 offen offset:0 sc1
    v_mfma_f32_32x32x16_bf16 v[64:79], v[148:151], a[32:35], v[64:79]
    s_waitcnt vmcnt(11)
    v_mfma_f32_32x32x16_bf16 v[48:63], v[152:155], a[36:39], v[48:63]
    buffer_load_dwordx4 a[84:87], v1, s[36:39], s6 offen offset:1024 sc1
    v_mfma_f32_32x32x16_bf16 v[64:79], v[156:159], a[36:39], v[64:79]
    s_waitcnt vmcnt(11)
    v_mfma_f32_32x32x16_bf16 v[48:63], v[160:163], a[40:43], v[48:63]
    buffer_load_dwordx4 a[88:91], v1, s[36:39], s6 offen offset:2048 sc1
    v_mfma_f32_32x32x16_bf16 v[64:79], v[164:167], a[40:43], v[64:79]
    s_waitcnt vmcnt(11)
    v_mfma_f32_32x32x16_bf16 v[48:63], v[168:171], a[44:47], v[48:63]
    buffer_load_dwordx4 a[92:95], v1, s[36:39], s6 offen offset:3072 sc1
    v_mfma_f32_32x32x16_bf16 v[64:79], v[172:175], a[44:47], v[64:79]
    s_waitcnt vmcnt(11)
    v_mfma_f32_32x32x16_bf16 v[32:47], v[180:183], a[48:51], v[32:47]
    v_mfma_f32_32x32x16_bf16 v[16:31], v[176:179], a[48:51], v[16:31]
    s_xor_b32 s4, s3, 2
    s_mul_i32 s4, s4, 12288
    s_add_u32 s4, s4, 102400
    v_add_u32 v4, s4, v1
    s_nop 2
    ds_write_b128 v4, v[48:51] offset:0
    ds_write_b128 v4, v[52:55] offset:1024
    s_waitcnt vmcnt(10)
    v_mfma_f32_32x32x16_bf16 v[32:47], v[188:191], a[52:55], v[32:47]
    ds_write_b128 v4, v[56:59] offset:2048
    ds_write_b128 v4, v[60:63] offset:3072
    s_xor_b32 s4, s3, 3
    s_mul_i32 s4, s4, 12288
    s_add_u32 s4, s4, 106496
    v_add_u32 v4, s4, v1
    v_mfma_f32_32x32x16_bf16 v[16:31], v[184:187], a[52:55], v[16:31]
    ds_write_b128 v4, v[64:67] offset:0
    ds_write_b128 v4, v[68:71] offset:1024
    ds_write_b128 v4, v[72:75] offset:2048
    ds_write_b128 v4, v[76:79] offset:3072
    s_mul_i32 s4, s3, 12288
    s_add_u32 s4, s4, 98304
    v_add_u32 v7, s4, v1
    s_waitcnt vmcnt(9)
    v_mfma_f32_32x32x16_bf16 v[32:47], v[196:199], a[56:59], v[32:47]
    v_mfma_f32_32x32x16_bf16 v[16:31], v[192:195], a[56:59], v[16:31]
    s_waitcnt vmcnt(8)
    v_mfma_f32_32x32x16_bf16 v[32:47], v[204:207], a[60:63], v[32:47]
    v_mfma_f32_32x32x16_bf16 v[16:31], v[200:203], a[60:63], v[16:31]
    s_waitcnt vmcnt(7)
    v_mfma_f32_32x32x16_bf16 v[32:47], v[212:215], a[64:67], v[32:47]
    v_mfma_f32_32x32x16_bf16 v[16:31], v[208:211], a[64:67], v[16:31]
    s_waitcnt vmcnt(6)
    v_mfma_f32_32x32x16_bf16 v[32:47], v[220:223], a[68:71], v[32:47]
    v_mfma_f32_32x32x16_bf16 v[16:31], v[216:219], a[68:71], v[16:31]
    s_waitcnt lgkmcnt(0)
    s_barrier
    ds_read_b128 v[48:51], v7 offset:4096
    ds_read_b128 v[52:55], v7 offset:5120
    ds_read_b128 v[56:59], v7 offset:6144
    ds_read_b128 v[60:63], v7 offset:7168
    s_waitcnt vmcnt(5)
    v_mfma_f32_32x32x16_bf16 v[32:47], v[132:135], a[72:75], v[32:47]
    ds_read_b128 v[64:67], v7 offset:8192
    ds_read_b128 v[68:71], v7 offset:9216
    ds_read_b128 v[72:75], v7 offset:10240
    ds_read_b128 v[76:79], v7 offset:11264
    s_waitcnt lgkmcnt(0)
    v_add_f32 v48, v48, v64
    v_mfma_f32_32x32x16_bf16 v[16:31], v[128:131], a[72:75], v[16:31]
    v_add_f32 v49, v49, v65
    v_add_f32 v50, v50, v66
    v_add_f32 v51, v51, v67
    v_add_f32 v52, v52, v68
    v_add_f32 v53, v53, v69
    v_add_f32 v54, v54, v70
    s_waitcnt vmcnt(4)
    v_mfma_f32_32x32x16_bf16 v[32:47], v[140:143], a[76:79], v[32:47]
    v_add_f32 v55, v55, v71
    v_add_f32 v56, v56, v72
    v_add_f32 v57, v57, v73
    v_add_f32 v58, v58, v74
    v_add_f32 v59, v59, v75
    v_add_f32 v60, v60, v76
    v_mfma_f32_32x32x16_bf16 v[16:31], v[136:139], a[76:79], v[16:31]
    v_add_f32 v61, v61, v77
    v_add_f32 v62, v62, v78
    v_add_f32 v63, v63, v79
    s_waitcnt vmcnt(3)
    v_mfma_f32_32x32x16_bf16 v[32:47], v[148:151], a[80:83], v[32:47]
    s_waitcnt vmcnt(2)
    v_mfma_f32_32x32x16_bf16 v[32:47], v[156:159], a[84:87], v[32:47]
    s_waitcnt vmcnt(1)
    v_mfma_f32_32x32x16_bf16 v[32:47], v[164:167], a[88:91], v[32:47]
    s_waitcnt vmcnt(0)
    v_mfma_f32_32x32x16_bf16 v[32:47], v[172:175], a[92:95], v[32:47]
    v_mfma_f32_32x32x16_bf16 v[16:31], v[144:147], a[80:83], v[16:31]
    v_mfma_f32_32x32x16_bf16 v[16:31], v[152:155], a[84:87], v[16:31]
    s_xor_b32 s4, s3, 1
    s_mul_i32 s4, s4, 12288
    s_add_u32 s4, s4, 98304
    v_add_u32 v4, s4, v1
    s_nop 5
    ds_write_b128 v4, v[32:35] offset:0
    ds_write_b128 v4, v[36:39] offset:1024
    v_mfma_f32_32x32x16_bf16 v[16:31], v[160:163], a[88:91], v[16:31]
    ds_write_b128 v4, v[40:43] offset:2048
    ds_write_b128 v4, v[44:47] offset:3072
    v_mfma_f32_32x32x16_bf16 v[16:31], v[168:171], a[92:95], v[16:31]
    s_waitcnt lgkmcnt(0)
    s_barrier
    ds_read_b128 v[88:91], v7 offset:0
    ds_read_b128 v[92:95], v7 offset:1024
    ds_read_b128 v[96:99], v7 offset:2048
    ds_read_b128 v[100:103], v7 offset:3072
    s_nop 5
    v_pk_add_f32 v[16:17], v[16:17], v[48:49]
    v_pk_add_f32 v[18:19], v[18:19], v[50:51]
    v_pk_add_f32 v[20:21], v[20:21], v[52:53]
    v_pk_add_f32 v[22:23], v[22:23], v[54:55]
    v_pk_add_f32 v[24:25], v[24:25], v[56:57]
    v_pk_add_f32 v[26:27], v[26:27], v[58:59]
    v_pk_add_f32 v[28:29], v[28:29], v[60:61]
    v_pk_add_f32 v[30:31], v[30:31], v[62:63]
    s_waitcnt lgkmcnt(3)
    v_pk_add_f32 v[16:17], v[16:17], v[88:89]
    v_pk_add_f32 v[18:19], v[18:19], v[90:91]
    s_waitcnt lgkmcnt(2)
    v_pk_add_f32 v[20:21], v[20:21], v[92:93]
    v_pk_add_f32 v[22:23], v[22:23], v[94:95]
    s_waitcnt lgkmcnt(1)
    v_pk_add_f32 v[24:25], v[24:25], v[96:97]
    v_pk_add_f32 v[26:27], v[26:27], v[98:99]
    s_waitcnt lgkmcnt(0)
    v_pk_add_f32 v[28:29], v[28:29], v[100:101]
    v_pk_add_f32 v[30:31], v[30:31], v[102:103]
    v_lshlrev_b32 v8, 16, v80
    v_and_b32 v9, 0xffff0000, v80
    v_add_f32 v16, v16, v8
    v_add_f32 v17, v17, v9
    v_cvt_pk_bf16_f32 v80, v16, v17
    v_lshlrev_b32 v8, 16, v81
    v_and_b32 v9, 0xffff0000, v81
    v_add_f32 v18, v18, v8
    v_add_f32 v19, v19, v9
    v_cvt_pk_bf16_f32 v81, v18, v19
    v_lshlrev_b32 v8, 16, v82
    v_and_b32 v9, 0xffff0000, v82
    v_add_f32 v20, v20, v8
    v_add_f32 v21, v21, v9
    v_cvt_pk_bf16_f32 v82, v20, v21
    v_lshlrev_b32 v8, 16, v83
    v_and_b32 v9, 0xffff0000, v83
    v_add_f32 v22, v22, v8
    v_add_f32 v23, v23, v9
    v_cvt_pk_bf16_f32 v83, v22, v23
    v_lshlrev_b32 v8, 16, v84
    v_and_b32 v9, 0xffff0000, v84
    v_add_f32 v24, v24, v8
    v_add_f32 v25, v25, v9
    v_cvt_pk_bf16_f32 v84, v24, v25
    v_lshlrev_b32 v8, 16, v85
    v_and_b32 v9, 0xffff0000, v85
    v_add_f32 v26, v26, v8
    v_add_f32 v27, v27, v9
    v_cvt_pk_bf16_f32 v85, v26, v27
    v_lshlrev_b32 v8, 16, v86
    v_and_b32 v9, 0xffff0000, v86
    v_add_f32 v28, v28, v8
    v_add_f32 v29, v29, v9
    v_cvt_pk_bf16_f32 v86, v28, v29
    v_lshlrev_b32 v8, 16, v87
    v_and_b32 v9, 0xffff0000, v87
    v_add_f32 v30, v30, v8
    v_add_f32 v31, v31, v9
    v_cvt_pk_bf16_f32 v87, v30, v31
    v_permlane32_swap_b32 v80, v82
    v_permlane32_swap_b32 v81, v83
    buffer_store_dwordx4 v[80:83], v6, s[40:43], s13 offen offset:0
    v_permlane32_swap_b32 v84, v86
    v_permlane32_swap_b32 v85, v87
    buffer_store_dwordx4 v[84:87], v6, s[40:43], s13 offen offset:32
mega_done:
    s_endpgm
mega_end:
.section .rodata,"a"
.p2align 6
.amdhsa_kernel mega_kernel
  .amdhsa_next_free_vgpr 512
  .amdhsa_next_free_sgpr 82
  .amdhsa_accum_offset 256
  .amdhsa_group_segment_fixed_size 0
  .amdhsa_kernarg_size 80
  .amdhsa_user_sgpr_count 2
  .amdhsa_user_sgpr_kernarg_segment_ptr 1
  .amdhsa_system_sgpr_workgroup_id_x 1
.end_amdhsa_kernel
```
